```python
import torch

def _softmax(x, axis=-1):
    return torch.softmax(x, dim=axis)
def _gelu(x):
    return torch.nn.functional.gelu(x, approximate="tanh")
def _silu(x):
    return torch.nn.functional.silu(x)
def _sigmoid(x):
    return torch.sigmoid(x)
def _layernorm(x, axis=-1, eps=1e-5):
    m = x.mean(dim=axis, keepdim=True)
    v = x.var(dim=axis, keepdim=True, unbiased=False)
    return (x - m) / torch.sqrt(v + eps)
def _scatter_add(tgt, idx, src, axis=0):
    return tgt.clone().index_add_(axis, idx, src)
def _segment_sum(src, seg, n):
    out = torch.zeros((n,) + src.shape[1:], dtype=src.dtype)
    return out.index_add_(0, seg, src)
def _pad(x, pw):
    flat = tuple(v for pair in reversed(pw) for v in pair)
    return torch.nn.functional.pad(x, flat)

kernel_name = 'parallel_sum__linear_attn_block__glu_gated_reglu__prompt'

def setup_inputs():

    _w = (lambda a: (lambda t: t.to(torch.bfloat16) if t.is_floating_point() else t)(torch.as_tensor(a)))
    def _A_setup():
        B, S, D = 1, 2048, 512
        return {
            "x": _w((lambda *s: torch.randn(*s, dtype=torch.bfloat16) * 0.05)(B, S, D)),
            "wqkv": _w((lambda *s: torch.randn(*s, dtype=torch.bfloat16) * 0.05)(D, 3 * D)),
            "wo": _w((lambda *s: torch.randn(*s, dtype=torch.bfloat16) * 0.05)(D, D)),
        }
    _A_in = _A_setup()

    def _B_setup():
        B, S, D, F = 1, 2048, 512, 1792
        return {
            "x": _w((lambda *s: torch.randn(*s, dtype=torch.bfloat16) * 0.05)(B, S, D)),
            "W_gate": _w((lambda *s: torch.randn(*s, dtype=torch.bfloat16) * 0.2)(D, F) * (2.0 / D) ** 0.5),
            "W_up": _w((lambda *s: torch.randn(*s, dtype=torch.bfloat16) * 0.2)(D, F) * (2.0 / D) ** 0.5),
            "W_down": _w((lambda *s: torch.randn(*s, dtype=torch.bfloat16) * 0.2)(F, D) * (1.0 / F) ** 0.5),
        }
    _B_in = _B_setup()

    return {
        "A_x": _A_in["x"],
        "A_wqkv": _A_in["wqkv"],
        "A_wo": _A_in["wo"],
        "B_x": _B_in["x"],
        "B_W_gate": _B_in["W_gate"],
        "B_W_up": _B_in["W_up"],
        "B_W_down": _B_in["W_down"],
    }

def reference(A_x, A_wqkv, A_wo, B_x, B_W_gate, B_W_up, B_W_down):
    def _A_ref(x, wqkv, wo):
        B, S, D = x.shape
        H = 32; Dh = D // H
        qkv = (lambda x, *d: x.permute(*d))((x @ wqkv).reshape(B, S, 3, H, Dh), 2, 0, 3, 1, 4)
        q, k, v = qkv[0], qkv[1], qkv[2]
        phi = lambda t: torch.where(t > 0, t + 1, torch.exp(t)) + 1e-6
        pq, pk = phi(q), phi(k)
        kv = torch.einsum("bhsd,bhse->bhde", pk, v)
        z = torch.einsum("bhsd->bhd", pk)
        num = torch.einsum("bhqd,bhde->bhqe", pq, kv)
        den = torch.einsum("bhqd,bhd->bhq", pq, z)[..., None] + 1e-6
        o = num / den
        return (lambda x, *d: x.permute(*d))(o, 0, 2, 1, 3).reshape(B, S, D) @ wo

    def _B_ref(x, W_gate, W_up, W_down):
        gate = torch.einsum("bsd,df->bsf", x, W_gate)
        up = torch.einsum("bsd,df->bsf", x, W_up)
        gate = gate * (lambda x, dt: x.to(dt))(gate > 0, gate.dtype)
        h = gate * up
        return torch.einsum("bsf,fd->bsd", h, W_down)

    x = A_x
    xn = _layernorm(x, axis=-1)
    return x + _A_ref(xn, A_wqkv, A_wo) + _B_ref(xn, B_W_gate, B_W_up, B_W_down)
```

```asm
; @launch grid=(256,1,1) block=(256,1,1) lds=163840
.amdgcn_target "amdgcn-amd-amdhsa--gfx950"
.text
.globl parallel_sum__linear_attn_block__glu_gated_reglu__prompt_kernel
.p2align 8
.type parallel_sum__linear_attn_block__glu_gated_reglu__prompt_kernel,@function
parallel_sum__linear_attn_block__glu_gated_reglu__prompt_kernel:
    s_cmp_ge_u32 s2, 256
    s_cbranch_scc1 L_end
    s_load_dwordx2 s[70:71], s[0:1], 0
    s_load_dwordx2 s[86:87], s[0:1], 72
    s_load_dwordx4 s[72:75], s[0:1], 8
    s_load_dwordx4 s[76:79], s[0:1], 32
    s_load_dwordx4 s[80:83], s[0:1], 48
    v_and_b32 v1, 63, v0
    v_lshrrev_b32 v24, 6, v0
    s_and_b32 s57, s2, 7
    s_lshr_b32 s58, s2, 3
    v_readfirstlane_b32 s36, v24
    s_lshr_b32 s39, s57, 1
    s_lshl_b32 s61, s57, 2
    s_and_b32 s59, s58, 3
    s_add_u32 s61, s61, s59
    s_lshr_b32 s62, s58, 2
    s_and_b32 s57, s57, 1
    s_lshl_b32 s57, s57, 3
    s_and_b32 s37, s58, 7
    s_add_u32 s37, s37, s57
    s_lshr_b32 s38, s58, 3
    s_lshl_b32 s93, s39, 2
    s_add_u32 s93, s93, s38
    s_lshl_b32 s97, s38, 1
    s_add_u32 s97, s97, s37
    s_and_b32 s97, s97, 7
    s_lshl_b32 s57, s37, 7
    s_lshl_b32 s58, s93, 3
    s_add_u32 s57, s57, s58
    s_lshl_b32 s58, s36, 1
    s_add_u32 s59, s57, s58
    s_lshl_b32 s57, s59, 10
    v_lshrrev_b32 v24, 5, v1
    v_lshlrev_b32 v24, 10, v24
    v_and_b32 v25, 31, v1
    v_lshl_add_u32 v24, v25, 5, v24
    v_mov_b32 v26, 0
    s_mov_b32 s58, 0xc30000
    s_lshl_b32 s54, s59, 4
    s_add_u32 s54, s54, 0xd00000
    v_lshrrev_b32 v28, 3, v1
    v_lshlrev_b32 v28, 10, v28
    v_and_b32 v29, 7, v1
    v_lshrrev_b32 v30, 4, v1
    v_xor_b32 v29, v29, v30
    v_lshl_add_u32 v72, v29, 4, v28
    s_lshl_b32 s58, s97, 7
    v_add_u32 v72, s58, v72
    v_xor_b32 v73, 64, v72
    v_add_u32 v74, 14336, v72
    v_add_u32 v73, 7168, v73
    v_add_u32 v75, 14336, v73
    s_mov_b32 s58, 0xc30000
    s_lshl_b32 s40, s36, 15
    s_waitcnt lgkmcnt(0)
    s_mov_b32 s4, s70
    s_mov_b32 s5, s71
    s_mov_b32 s6, 0x200000
    s_mov_b32 s7, 0x00020000
    s_mov_b32 s20, s86
    s_mov_b32 s21, s87
    s_mov_b32 s22, 0x10000000
    s_mov_b32 s23, 0x00020000
    buffer_load_dwordx4 v[32:35], v24, s[4:7], s57 offen
    buffer_load_dwordx4 v[36:39], v24, s[4:7], s57 offen offset:16
    buffer_load_dword v27, v26, s[20:23], s58 offen sc1
    s_getpc_b64 s[94:95]
L_pc_here:
    s_sub_u32 s94, s94, L_pc_here-parallel_sum__linear_attn_block__glu_gated_reglu__prompt_kernel
    s_subb_u32 s95, s95, 0
    s_lshr_b32 s59, s2, 3
    s_mul_i32 s59, s59, 0x600
    v_lshlrev_b32 v54, 7, v1
    v_min_u32 v54, 0x600, v54
    v_add_u32 v54, s59, v54
    global_load_dword v55, v54, s[94:95]
    s_lshl_b32 s98, s37, 2
    s_add_u32 s98, s98, s36
    s_lshl_b32 s98, s98, 15
    s_mov_b32 s99, s97
    s_mov_b32 s8, s72
    s_mov_b32 s9, s73
    s_mov_b32 s10, 0x180000
    s_mov_b32 s11, 0x00020000
    s_mov_b32 s28, s74
    s_mov_b32 s29, s75
    s_mov_b32 s30, 0x80000
    s_mov_b32 s31, 0x00020000
    s_mov_b32 s12, s76
    s_mov_b32 s13, s77
    s_mov_b32 s14, 0x1c0000
    s_mov_b32 s15, 0x00020000
    s_mov_b32 s16, s78
    s_mov_b32 s17, s79
    s_mov_b32 s18, 0x1c0000
    s_mov_b32 s19, 0x00020000
    s_mov_b32 s24, s80
    s_mov_b32 s25, s81
    s_mov_b32 s26, 0x1c0000
    s_mov_b32 s27, 0x00020000
    s_mov_b32 s32, s82
    s_mov_b32 s33, s83
    s_mov_b32 s34, 0x200000
    s_mov_b32 s35, 0x00020000
    s_lshl_b32 s68, s36, 13
    s_add_u32 s68, s68, 131072
    s_sub_u32 s69, 7, s97
    s_mov_b32 s41, 0x3fb8aa3b
    s_mov_b32 s42, 0x358637bd
    s_mov_b32 s43, 0x3f803f80
    s_mov_b32 s96, 0xffff0000
    s_mov_b32 s90, 229376
    s_mov_b32 s91, 0xffe78000
    s_mov_b32 s88, 196608
    s_mov_b32 s89, 0xffeb0000
    v_lshlrev_b32 v2, 4, v1
    s_cmp_ge_u32 s38, 2
    s_cbranch_scc1 L_cd
    s_mov_b32 s3, s54
    s_add_u32 m0, s40, 0
    s_add_u32 s99, s99, 1
    s_and_b32 s99, s99, 7
    s_movk_i32 s100, 128
    s_cmp_eq_u32 s99, 0
    s_cselect_b32 s100, 0xfffffc80, s100
    buffer_load_dwordx4 v72, s[4:7], s98 offen lds
    buffer_load_dwordx4 v73, s[4:7], s98 offen offset:1024 lds
    buffer_load_dwordx4 v74, s[4:7], s98 offen offset:2048 lds
    buffer_load_dwordx4 v75, s[4:7], s98 offen offset:3072 lds
    v_add_u32 v72, s100, v72
    v_add_u32 v73, s100, v73
    v_add_u32 v74, s100, v74
    v_add_u32 v75, s100, v75
    s_add_u32 m0, s40, 4096
    s_add_u32 s99, s99, 1
    s_and_b32 s99, s99, 7
    s_movk_i32 s100, 128
    s_cmp_eq_u32 s99, 0
    s_cselect_b32 s100, 0xfffffc80, s100
    buffer_load_dwordx4 v72, s[4:7], s98 offen lds
    buffer_load_dwordx4 v73, s[4:7], s98 offen offset:1024 lds
    buffer_load_dwordx4 v74, s[4:7], s98 offen offset:2048 lds
    buffer_load_dwordx4 v75, s[4:7], s98 offen offset:3072 lds
    v_add_u32 v72, s100, v72
    v_add_u32 v73, s100, v73
    v_add_u32 v74, s100, v74
    v_add_u32 v75, s100, v75
    s_add_u32 m0, s40, 8192
    s_add_u32 s99, s99, 1
    s_and_b32 s99, s99, 7
    s_movk_i32 s100, 128
    s_cmp_eq_u32 s99, 0
    s_cselect_b32 s100, 0xfffffc80, s100
    buffer_load_dwordx4 v72, s[4:7], s98 offen lds
    buffer_load_dwordx4 v73, s[4:7], s98 offen offset:1024 lds
    buffer_load_dwordx4 v74, s[4:7], s98 offen offset:2048 lds
    buffer_load_dwordx4 v75, s[4:7], s98 offen offset:3072 lds
    v_add_u32 v72, s100, v72
    v_add_u32 v73, s100, v73
    v_add_u32 v74, s100, v74
    v_add_u32 v75, s100, v75
    s_add_u32 m0, s40, 12288
    s_add_u32 s99, s99, 1
    s_and_b32 s99, s99, 7
    s_movk_i32 s100, 128
    s_cmp_eq_u32 s99, 0
    s_cselect_b32 s100, 0xfffffc80, s100
    buffer_load_dwordx4 v72, s[4:7], s98 offen lds
    buffer_load_dwordx4 v73, s[4:7], s98 offen offset:1024 lds
    buffer_load_dwordx4 v74, s[4:7], s98 offen offset:2048 lds
    buffer_load_dwordx4 v75, s[4:7], s98 offen offset:3072 lds
    v_add_u32 v72, s100, v72
    v_add_u32 v73, s100, v73
    v_add_u32 v74, s100, v74
    v_add_u32 v75, s100, v75
    s_waitcnt vmcnt(18)
    v_mov_b32 v28, 0
    v_mov_b32 v29, 0
    v_dot2_f32_bf16 v28, v32, s43, v28
    v_dot2_f32_bf16 v29, v32, v32, v29
    v_dot2_f32_bf16 v28, v33, s43, v28
    v_dot2_f32_bf16 v29, v33, v33, v29
    v_dot2_f32_bf16 v28, v34, s43, v28
    v_dot2_f32_bf16 v29, v34, v34, v29
    v_dot2_f32_bf16 v28, v35, s43, v28
    v_dot2_f32_bf16 v29, v35, v35, v29
    v_dot2_f32_bf16 v28, v36, s43, v28
    v_dot2_f32_bf16 v29, v36, v36, v29
    v_dot2_f32_bf16 v28, v37, s43, v28
    v_dot2_f32_bf16 v29, v37, v37, v29
    v_dot2_f32_bf16 v28, v38, s43, v28
    v_dot2_f32_bf16 v29, v38, v38, v29
    v_dot2_f32_bf16 v28, v39, s43, v28
    v_dot2_f32_bf16 v29, v39, v39, v29
    s_nop 1
    v_add_f32_dpp v28, v28, v28 row_ror:8 row_mask:0xf bank_mask:0xf
    v_add_f32_dpp v29, v29, v29 row_ror:8 row_mask:0xf bank_mask:0xf
    s_nop 1
    v_add_f32_dpp v28, v28, v28 row_ror:4 row_mask:0xf bank_mask:0xf
    v_add_f32_dpp v29, v29, v29 row_ror:4 row_mask:0xf bank_mask:0xf
    s_nop 1
    v_add_f32_dpp v28, v28, v28 row_ror:2 row_mask:0xf bank_mask:0xf
    v_add_f32_dpp v29, v29, v29 row_ror:2 row_mask:0xf bank_mask:0xf
    s_nop 1
    v_add_f32_dpp v28, v28, v28 row_ror:1 row_mask:0xf bank_mask:0xf
    v_add_f32_dpp v29, v29, v29 row_ror:1 row_mask:0xf bank_mask:0xf
    v_mov_b32 v30, v28
    v_mov_b32 v31, v29
    s_nop 1
    v_permlane16_swap_b32 v28, v30
    v_permlane16_swap_b32 v29, v31
    s_nop 1
    v_add_f32 v28, v28, v30
    v_add_f32 v29, v29, v31
    v_mul_f32 v28, 0x3b000000, v28
    v_mul_f32 v29, 0x3b000000, v29
    v_fma_f32 v29, -v28, v28, v29
    v_max_f32 v29, 0, v29
    v_add_f32 v29, 0x3727c5ac, v29
    v_rsq_f32 v29, v29
    s_nop 0
    v_mul_f32 v28, v28, v29
    v_sub_f32 v28, 0, v28
    s_waitcnt vmcnt(17)
    v_add_u32 v27, 64, v27
    v_or_b32 v27, 1, v27
    v_mov_b32 v40, v29
    v_mov_b32 v41, v27
    v_mov_b32 v42, v28
    v_mov_b32 v43, v27
    v_lshrrev_b32 v30, 5, v1
    v_lshlrev_b32 v30, 4, v30
    v_readfirstlane_b32 s60, v27
    s_mov_b64 s[94:95], exec
    s_mov_b32 exec_lo, 1
    s_mov_b32 exec_hi, 1
    buffer_store_dwordx4 v[40:43], v30, s[20:23], s3 offen sc1
    s_mov_b64 exec, s[94:95]
    s_add_u32 m0, s40, 16384
    s_add_u32 s99, s99, 1
    s_and_b32 s99, s99, 7
    s_movk_i32 s100, 128
    s_cmp_eq_u32 s99, 0
    s_cselect_b32 s100, 0xfffffc80, s100
    buffer_load_dwordx4 v72, s[4:7], s98 offen lds
    buffer_load_dwordx4 v73, s[4:7], s98 offen offset:1024 lds
    buffer_load_dwordx4 v74, s[4:7], s98 offen offset:2048 lds
    buffer_load_dwordx4 v75, s[4:7], s98 offen offset:3072 lds
    v_add_u32 v72, s100, v72
    v_add_u32 v73, s100, v73
    v_add_u32 v74, s100, v74
    v_add_u32 v75, s100, v75
    v_lshrrev_b32 v40, 3, v1
    v_lshrrev_b32 v42, 2, v1
    v_and_b32 v42, 4, v42
    v_and_b32 v41, 7, v1
    v_xor_b32 v41, v41, v42
    v_lshlrev_b32 v41, 4, v41
    v_lshl_add_u32 v3, v40, 10, v41
    s_movk_i32 s58, 3072
    s_movk_i32 s59, 3584
    s_mul_i32 s66, s97, 196608
    s_mul_i32 s64, s97, 229376
    v_mad_u32_u24 v4, v40, s58, v41
    v_mad_u32_u24 v5, v40, s59, v41
    v_add_u32 v4, s66, v4
    v_add_u32 v5, s64, v5
    v_xor_b32 v6, 32, v5
    s_mul_i32 s58, s36, 49152
    s_mul_i32 s59, s36, 57344
    s_lshl_b32 s65, s37, 2
    s_add_u32 s65, s65, s36
    s_mul_i32 s52, s65, 114688
    s_lshl_b32 s55, s65, 15
    s_add_u32 s55, s55, 0x800000
    s_lshl_b32 s67, s39, 1
    s_add_u32 s67, s67, s38
    s_lshl_b32 s56, s67, 12
    s_add_u32 s55, s55, s56
    s_lshl_b32 s56, s67, 2
    s_add_u32 s56, s56, s36
    s_lshl_b32 s56, s56, 15
    s_lshl_b32 s54, s37, 11
    s_add_u32 s56, s56, s54
    s_add_u32 s56, s56, 0xa00000
    s_lshl_b32 s57, s67, 7
    s_add_u32 s57, s57, s58
    s_add_u32 s44, s57, 1024
    s_add_u32 s45, s57, 24576
    s_add_u32 s46, s57, 0
    s_add_u32 s47, s57, 23552
    s_add_u32 s48, s57, 0
    s_add_u32 s49, s57, 23552
    s_mul_i32 s57, s39, 7
    s_add_u32 s57, s57, s38
    s_add_u32 m0, s40, 20480
    s_add_u32 s99, s99, 1
    s_and_b32 s99, s99, 7
    s_movk_i32 s100, 128
    s_cmp_eq_u32 s99, 0
    s_cselect_b32 s100, 0xfffffc80, s100
    buffer_load_dwordx4 v72, s[4:7], s98 offen lds
    buffer_load_dwordx4 v73, s[4:7], s98 offen offset:1024 lds
    buffer_load_dwordx4 v74, s[4:7], s98 offen offset:2048 lds
    buffer_load_dwordx4 v75, s[4:7], s98 offen offset:3072 lds
    v_add_u32 v72, s100, v72
    v_add_u32 v73, s100, v73
    v_add_u32 v74, s100, v74
    v_add_u32 v75, s100, v75
    s_lshl_b32 s54, s57, 12
    s_add_u32 s54, s54, s52
    s_lshl_b32 s57, s57, 7
    s_add_u32 s50, s57, s59
    s_add_u32 s51, s50, 27648
    s_mul_i32 s63, s36, 458752
    s_lshl_b32 s57, s62, 7
    s_add_u32 s63, s63, s57
    s_and_b32 s58, s61, 3
    s_lshl_b32 s58, s58, 3
    s_sub_u32 s101, 28, s58
    s_lshl_b32 s58, s58, 14
    v_add_u32 v3, s58, v3
    s_add_u32 s64, s63, 7168
    s_lshl_b32 s65, s36, 17
    s_add_u32 s65, s65, s57
    s_add_u32 s66, s65, 7168
    v_lshrrev_b32 v47, 5, v1
    v_lshlrev_b32 v40, 3, v47
    v_bfe_u32 v41, v1, 2, 2
    v_add_u32 v40, v40, v41
    v_lshl_add_u32 v47, v47, 2, v41
    v_bfe_u32 v41, v1, 4, 1
    v_bfe_u32 v42, v1, 1, 1
    v_bfe_u32 v43, v1, 3, 1
    v_and_b32 v44, 1, v1
    v_lshlrev_b32 v44, 3, v44
    v_lshl_add_u32 v45, v41, 1, v42
    v_lshlrev_b32 v46, 2, v43
    v_xor_b32 v46, 0, v46
    v_add_u32 v45, v45, v46
    v_lshl_add_u32 v45, v45, 4, v44
    v_lshl_add_u32 v12, v40, 7, v45
    v_add_u32 v13, 0x10000, v12
    v_add_u32 v64, 0x20000, v12
    v_lshl_add_u32 v45, v41, 1, v42
    v_lshlrev_b32 v46, 2, v43
    v_xor_b32 v46, 4, v46
    v_add_u32 v45, v45, v46
    v_lshl_add_u32 v45, v45, 4, v44
    v_lshl_add_u32 v14, v40, 7, v45
    v_add_u32 v15, 0x10000, v14
    v_add_u32 v65, 0x20000, v14
    s_add_u32 m0, s40, 24576
    s_add_u32 s99, s99, 1
    s_and_b32 s99, s99, 7
    s_movk_i32 s100, 128
    s_cmp_eq_u32 s99, 0
    s_cselect_b32 s100, 0xfffffc80, s100
    buffer_load_dwordx4 v72, s[4:7], s98 offen lds
    buffer_load_dwordx4 v73, s[4:7], s98 offen offset:1024 lds
    buffer_load_dwordx4 v74, s[4:7], s98 offen offset:2048 lds
    buffer_load_dwordx4 v75, s[4:7], s98 offen offset:3072 lds
    v_add_u32 v72, s100, v72
    v_add_u32 v73, s100, v73
    v_add_u32 v74, s100, v74
    v_add_u32 v75, s100, v75
    v_add_u32 v45, 0, v42
    v_lshlrev_b32 v46, 2, v43
    v_xor_b32 v45, v45, v46
    v_lshlrev_b32 v46, 1, v41
    v_xor_b32 v45, v45, v46
    v_lshl_add_u32 v45, v45, 4, v44
    v_lshl_add_u32 v45, v40, 7, v45
    v_lshl_add_u32 v16, v41, 11, v45
    v_add_u32 v17, 0x10000, v16
    v_add_u32 v66, 0x20000, v16
    v_add_u32 v45, 2, v42
    v_lshlrev_b32 v46, 2, v43
    v_xor_b32 v45, v45, v46
    v_lshlrev_b32 v46, 1, v41
    v_xor_b32 v45, v45, v46
    v_lshl_add_u32 v45, v45, 4, v44
    v_lshl_add_u32 v45, v40, 7, v45
    v_lshl_add_u32 v18, v41, 11, v45
    v_add_u32 v19, 0x10000, v18
    v_add_u32 v67, 0x20000, v18
    v_add_u32 v45, 4, v42
    v_lshlrev_b32 v46, 2, v43
    v_xor_b32 v45, v45, v46
    v_lshlrev_b32 v46, 1, v41
    v_xor_b32 v45, v45, v46
    v_lshl_add_u32 v45, v45, 4, v44
    v_lshl_add_u32 v45, v40, 7, v45
    v_lshl_add_u32 v20, v41, 11, v45
    v_add_u32 v21, 0x10000, v20
    v_add_u32 v68, 0x20000, v20
    v_add_u32 v45, 6, v42
    v_lshlrev_b32 v46, 2, v43
    v_xor_b32 v45, v45, v46
    v_lshlrev_b32 v46, 1, v41
    v_xor_b32 v45, v45, v46
    v_lshl_add_u32 v45, v45, 4, v44
    v_lshl_add_u32 v45, v40, 7, v45
    v_lshl_add_u32 v22, v41, 11, v45
    v_add_u32 v23, 0x10000, v22
    v_add_u32 v69, 0x20000, v22
    v_lshl_add_u32 v45, v41, 1, v42
    v_lshlrev_b32 v46, 2, v43
    v_xor_b32 v46, 0, v46
    s_add_u32 m0, s40, 28672
    s_add_u32 s99, s99, 1
    s_and_b32 s99, s99, 7
    s_movk_i32 s100, 128
    s_cmp_eq_u32 s99, 0
    s_cselect_b32 s100, 0xfffffc80, s100
    buffer_load_dwordx4 v72, s[4:7], s98 offen lds
    buffer_load_dwordx4 v73, s[4:7], s98 offen offset:1024 lds
    buffer_load_dwordx4 v74, s[4:7], s98 offen offset:2048 lds
    buffer_load_dwordx4 v75, s[4:7], s98 offen offset:3072 lds
    v_add_u32 v45, v45, v46
    v_lshl_add_u32 v45, v45, 4, v44
    v_lshl_add_u32 v8, v47, 7, v45
    v_lshl_add_u32 v45, v41, 1, v42
    v_lshlrev_b32 v46, 2, v43
    v_xor_b32 v46, 4, v46
    v_add_u32 v45, v45, v46
    v_lshl_add_u32 v45, v45, 4, v44
    v_lshl_add_u32 v9, v47, 7, v45
    v_add_u32 v10, s40, v8
    v_add_u32 v11, s40, v9
    v_add_u32 v8, s68, v8
    v_add_u32 v9, s68, v9
    v_and_b32 v40, 31, v1
    v_lshrrev_b32 v41, 5, v1
    v_bfe_u32 v42, v1, 1, 3
    v_xor_b32 v41, v41, v42
    v_lshlrev_b32 v40, 7, v40
    v_add_u32 v40, s40, v40
    v_xor_b32 v42, 0, v41
    v_lshl_add_u32 v76, v42, 4, v40
    v_xor_b32 v42, 2, v41
    v_lshl_add_u32 v77, v42, 4, v40
    v_xor_b32 v42, 4, v41
    v_lshl_add_u32 v78, v42, 4, v40
    v_xor_b32 v42, 6, v41
    v_lshl_add_u32 v79, v42, 4, v40
    v_mov_b32 v40, s42
    v_accvgpr_write_b32 a144, v40
    v_accvgpr_write_b32 a145, v40
    v_accvgpr_write_b32 a146, v40
    v_accvgpr_write_b32 a147, v40
    v_accvgpr_write_b32 a148, v40
    v_accvgpr_write_b32 a149, v40
    v_accvgpr_write_b32 a150, v40
    v_accvgpr_write_b32 a151, v40
    v_accvgpr_write_b32 a152, v40
    v_accvgpr_write_b32 a153, v40
    v_accvgpr_write_b32 a154, v40
    v_accvgpr_write_b32 a155, v40
    v_accvgpr_write_b32 a156, v40
    v_accvgpr_write_b32 a157, v40
    v_accvgpr_write_b32 a158, v40
    v_accvgpr_write_b32 a159, v40
    s_mul_i32 s59, s36, 6144
    s_add_u32 s59, s59, 131072
    s_add_u32 m0, s59, 0
    s_cmp_eq_u32 s69, 0
    s_cselect_b32 s92, s89, s88
    buffer_load_dwordx4 v4, s[8:11], s44 offen lds
    buffer_load_dwordx4 v4, s[8:11], s45 offen offset:1024 lds
    buffer_load_dwordx4 v4, s[8:11], s46 offen offset:2048 lds
    buffer_load_dwordx4 v4, s[8:11], s47 offen offset:3072 lds
    s_add_u32 m0, s59, 4096
    s_nop 0
    buffer_load_dwordx4 v4, s[8:11], s48 offen lds
    buffer_load_dwordx4 v4, s[8:11], s49 offen offset:1024 lds
    v_add_u32 v4, s92, v4
    v_and_b32 v36, 31, v1
    v_lshlrev_b32 v36, 4, v36
    s_lshr_b32 s58, s98, 6
    s_add_u32 s58, s58, 0xd00000
    s_mov_b32 s99, s58
    buffer_load_dwordx4 v[32:35], v36, s[20:23], s99 offen sc1
    s_waitcnt vmcnt(36)
    ds_read_b128 v[128:131], v76 offset:0
    ds_read_b128 v[132:135], v77 offset:0
    ds_read_b128 v[136:139], v78 offset:0
    ds_read_b128 v[140:143], v79 offset:0
    s_waitcnt vmcnt(32)
    ds_read_b128 v[144:147], v76 offset:4096
    ds_read_b128 v[148:151], v77 offset:4096
    ds_read_b128 v[152:155], v78 offset:4096
    ds_read_b128 v[156:159], v79 offset:4096
    s_waitcnt vmcnt(28)
    ds_read_b128 v[160:163], v76 offset:8192
    ds_read_b128 v[164:167], v77 offset:8192
    ds_read_b128 v[168:171], v78 offset:8192
    ds_read_b128 v[172:175], v79 offset:8192
    s_waitcnt vmcnt(24)
    ds_read_b128 v[176:179], v76 offset:12288
    ds_read_b128 v[180:183], v77 offset:12288
    ds_read_b128 v[184:187], v78 offset:12288
    ds_read_b128 v[188:191], v79 offset:12288
    s_waitcnt vmcnt(19)
    ds_read_b128 v[192:195], v76 offset:16384
    ds_read_b128 v[196:199], v77 offset:16384
    ds_read_b128 v[200:203], v78 offset:16384
    ds_read_b128 v[204:207], v79 offset:16384
    s_waitcnt vmcnt(15)
    ds_read_b128 v[208:211], v76 offset:20480
    ds_read_b128 v[212:215], v77 offset:20480
    ds_read_b128 v[216:219], v78 offset:20480
    ds_read_b128 v[220:223], v79 offset:20480
    s_waitcnt vmcnt(11)
    ds_read_b128 v[224:227], v76 offset:24576
    ds_read_b128 v[228:231], v77 offset:24576
    ds_read_b128 v[232:235], v78 offset:24576
    ds_read_b128 v[236:239], v79 offset:24576
    s_waitcnt vmcnt(7)
    ds_read_b128 v[240:243], v76 offset:28672
    ds_read_b128 v[244:247], v77 offset:28672
    ds_read_b128 v[248:251], v78 offset:28672
    ds_read_b128 v[252:255], v79 offset:28672
    s_waitcnt lgkmcnt(0)
    s_add_u32 m0, s40, 0
    s_cmp_eq_u32 s69, 1
    s_cselect_b32 s92, s89, s88
    buffer_load_dwordx4 v4, s[8:11], s44 offen lds
    buffer_load_dwordx4 v4, s[8:11], s45 offen offset:1024 lds
    buffer_load_dwordx4 v4, s[8:11], s46 offen offset:2048 lds
    buffer_load_dwordx4 v4, s[8:11], s47 offen offset:3072 lds
    s_add_u32 m0, s40, 4096
    s_nop 0
    buffer_load_dwordx4 v4, s[8:11], s48 offen lds
    buffer_load_dwordx4 v4, s[8:11], s49 offen offset:1024 lds
    v_add_u32 v4, s92, v4
    s_add_u32 m0, s40, 6144
    s_cmp_eq_u32 s69, 2
    s_cselect_b32 s92, s89, s88
    buffer_load_dwordx4 v4, s[8:11], s44 offen lds
    buffer_load_dwordx4 v4, s[8:11], s45 offen offset:1024 lds
    buffer_load_dwordx4 v4, s[8:11], s46 offen offset:2048 lds
    buffer_load_dwordx4 v4, s[8:11], s47 offen offset:3072 lds
    s_add_u32 m0, s40, 10240
    s_nop 0
    buffer_load_dwordx4 v4, s[8:11], s48 offen lds
    buffer_load_dwordx4 v4, s[8:11], s49 offen offset:1024 lds
    v_add_u32 v4, s92, v4
    s_waitcnt vmcnt(12)
    s_mov_b32 s3, 0
L_g1:
    v_xor_b32 v37, s60, v33
    v_xor_b32 v38, s60, v35
    v_or_b32 v37, v37, v38
    v_cmp_eq_u32 vcc, 0, v37
    s_nop 1
    s_cmp_eq_u64 vcc, -1
    s_cbranch_scc1 L_gok2
    s_sleep 2
    buffer_load_dwordx4 v[32:35], v36, s[20:23], s99 offen sc1
    s_waitcnt vmcnt(0)
    s_add_u32 s3, s3, 1
    s_cmp_lt_u32 s3, 20000
    s_cbranch_scc1 L_g1
L_gok2:
    v_mov_b32 v62, v32
    v_mov_b32 v63, v34
    v_lshlrev_b32 v24, 16, v128
    v_and_b32 v25, s96, v128
    v_lshlrev_b32 v26, 16, v129
    v_and_b32 v27, s96, v129
    v_fma_f32 v24, v24, v62, v63
    v_fma_f32 v25, v25, v62, v63
    v_fma_f32 v26, v26, v62, v63
    v_fma_f32 v27, v27, v62, v63
    v_cvt_pk_bf16_f32 v128, v24, v25
    v_cvt_pk_bf16_f32 v129, v26, v27
    v_lshlrev_b32 v28, 16, v130
    v_and_b32 v29, s96, v130
    v_lshlrev_b32 v30, 16, v131
    v_and_b32 v31, s96, v131
    v_fma_f32 v28, v28, v62, v63
    v_fma_f32 v29, v29, v62, v63
    v_fma_f32 v30, v30, v62, v63
    v_fma_f32 v31, v31, v62, v63
    v_cvt_pk_bf16_f32 v130, v28, v29
    v_cvt_pk_bf16_f32 v131, v30, v31
    s_barrier
    ds_read_b64_tr_b16 a[96:97], v64 offset:0
    ds_read_b64_tr_b16 a[98:99], v64 offset:512
    ds_read_b64_tr_b16 a[100:101], v65 offset:0
    ds_read_b64_tr_b16 a[102:103], v65 offset:512
    ds_read_b64_tr_b16 a[104:105], v64 offset:2048
    ds_read_b64_tr_b16 a[106:107], v64 offset:2560
    ds_read_b64_tr_b16 a[108:109], v65 offset:2048
    ds_read_b64_tr_b16 a[110:111], v65 offset:2560
    ds_read_b64_tr_b16 a[112:113], v64 offset:4096
    ds_read_b64_tr_b16 a[114:115], v64 offset:4608
    ds_read_b64_tr_b16 a[116:117], v65 offset:4096
    ds_read_b64_tr_b16 a[118:119], v65 offset:4608
    s_waitcnt lgkmcnt(6)
    v_mfma_f32_32x32x16_bf16 a[0:15], v[128:131], a[96:99], a[144:159]
    ds_read_b64_tr_b16 a[120:121], v64 offset:6144
    ds_read_b64_tr_b16 a[122:123], v64 offset:6656
    ds_read_b64_tr_b16 a[124:125], v65 offset:6144
    v_lshlrev_b32 v24, 16, v132
    v_and_b32 v25, s96, v132
    v_lshlrev_b32 v26, 16, v133
    v_and_b32 v27, s96, v133
    s_add_u32 m0, s40, 12288
    s_cmp_eq_u32 s69, 3
    s_cselect_b32 s92, s89, s88
    buffer_load_dwordx4 v4, s[8:11], s44 offen lds
    buffer_load_dwordx4 v4, s[8:11], s45 offen offset:1024 lds
    buffer_load_dwordx4 v4, s[8:11], s46 offen offset:2048 lds
    buffer_load_dwordx4 v4, s[8:11], s47 offen offset:3072 lds
    v_mfma_f32_32x32x16_bf16 a[16:31], v[128:131], a[100:103], a[144:159]
    ds_read_b64_tr_b16 a[126:127], v65 offset:6656
    ds_read_b64_tr_b16 a[128:129], v64 offset:8192
    v_fma_f32 v24, v24, v62, v63
    v_fma_f32 v25, v25, v62, v63
    v_fma_f32 v26, v26, v62, v63
    v_fma_f32 v27, v27, v62, v63
    v_mfma_f32_32x32x16_bf16 a[32:47], v[128:131], a[104:107], 0
    ds_read_b64_tr_b16 a[130:131], v64 offset:8704
    ds_read_b64_tr_b16 a[132:133], v65 offset:8192
    ds_read_b64_tr_b16 a[134:135], v65 offset:8704
    v_cvt_pk_bf16_f32 v132, v24, v25
    v_cvt_pk_bf16_f32 v133, v26, v27
    v_lshlrev_b32 v28, 16, v134
    v_and_b32 v29, s96, v134
    s_add_u32 m0, s40, 16384
    s_nop 0
    buffer_load_dwordx4 v4, s[8:11], s48 offen lds
    buffer_load_dwordx4 v4, s[8:11], s49 offen offset:1024 lds
    v_add_u32 v4, s92, v4
    s_waitcnt lgkmcnt(8)
    v_mfma_f32_32x32x16_bf16 a[48:63], v[128:131], a[108:111], 0
    ds_read_b64_tr_b16 a[136:137], v64 offset:10240
    ds_read_b64_tr_b16 a[138:139], v64 offset:10752
    v_lshlrev_b32 v30, 16, v135
    v_and_b32 v31, s96, v135
    v_fma_f32 v28, v28, v62, v63
    v_fma_f32 v29, v29, v62, v63
    v_mfma_f32_32x32x16_bf16 a[64:79], a[112:115], v[128:131], a[144:159]
    ds_read_b64_tr_b16 a[140:141], v65 offset:10240
    ds_read_b64_tr_b16 a[142:143], v65 offset:10752
    v_fma_f32 v30, v30, v62, v63
    v_fma_f32 v31, v31, v62, v63
    v_cvt_pk_bf16_f32 v134, v28, v29
    v_cvt_pk_bf16_f32 v135, v30, v31
    v_mfma_f32_32x32x16_bf16 a[80:95], a[116:119], v[128:131], a[144:159]
    s_waitcnt lgkmcnt(6)
    v_mfma_f32_32x32x16_bf16 a[0:15], v[132:135], a[120:123], a[0:15]
    ds_read_b64_tr_b16 a[96:97], v64 offset:12288
    ds_read_b64_tr_b16 a[98:99], v64 offset:12800
    ds_read_b64_tr_b16 a[100:101], v65 offset:12288
    v_lshlrev_b32 v24, 16, v136
    v_and_b32 v25, s96, v136
    v_lshlrev_b32 v26, 16, v137
    v_and_b32 v27, s96, v137
    s_add_u32 m0, s40, 18432
    s_cmp_eq_u32 s69, 4
    s_cselect_b32 s92, s89, s88
    buffer_load_dwordx4 v4, s[8:11], s44 offen lds
    buffer_load_dwordx4 v4, s[8:11], s45 offen offset:1024 lds
    buffer_load_dwordx4 v4, s[8:11], s46 offen offset:2048 lds
    buffer_load_dwordx4 v4, s[8:11], s47 offen offset:3072 lds
    v_mfma_f32_32x32x16_bf16 a[16:31], v[132:135], a[124:127], a[16:31]
    ds_read_b64_tr_b16 a[102:103], v65 offset:12800
    ds_read_b64_tr_b16 a[104:105], v64 offset:14336
    v_fma_f32 v24, v24, v62, v63
    v_fma_f32 v25, v25, v62, v63
    v_fma_f32 v26, v26, v62, v63
    v_fma_f32 v27, v27, v62, v63
    v_mfma_f32_32x32x16_bf16 a[32:47], v[132:135], a[128:131], a[32:47]
    ds_read_b64_tr_b16 a[106:107], v64 offset:14848
    ds_read_b64_tr_b16 a[108:109], v65 offset:14336
    ds_read_b64_tr_b16 a[110:111], v65 offset:14848
    v_cvt_pk_bf16_f32 v136, v24, v25
    v_cvt_pk_bf16_f32 v137, v26, v27
    v_lshlrev_b32 v28, 16, v138
    v_and_b32 v29, s96, v138
    s_add_u32 m0, s40, 30720
    s_nop 0
    buffer_load_dwordx4 v3, s[24:27], s63 offen lds
    buffer_load_dwordx4 v3, s[24:27], s64 offen offset:1024 lds
    s_waitcnt lgkmcnt(8)
    v_mfma_f32_32x32x16_bf16 a[48:63], v[132:135], a[132:135], a[48:63]
    ds_read_b64_tr_b16 a[112:113], v64 offset:16384
    ds_read_b64_tr_b16 a[114:115], v64 offset:16896
    v_lshlrev_b32 v30, 16, v139
    v_and_b32 v31, s96, v139
    v_fma_f32 v28, v28, v62, v63
    v_fma_f32 v29, v29, v62, v63
    v_mfma_f32_32x32x16_bf16 a[64:79], a[136:139], v[132:135], a[64:79]
    ds_read_b64_tr_b16 a[116:117], v65 offset:16384
    ds_read_b64_tr_b16 a[118:119], v65 offset:16896
    v_fma_f32 v30, v30, v62, v63
    v_fma_f32 v31, v31, v62, v63
    v_cvt_pk_bf16_f32 v138, v28, v29
    v_cvt_pk_bf16_f32 v139, v30, v31
    v_mfma_f32_32x32x16_bf16 a[80:95], a[140:143], v[132:135], a[80:95]
    s_waitcnt lgkmcnt(6)
    v_mfma_f32_32x32x16_bf16 a[0:15], v[136:139], a[96:99], a[0:15]
    ds_read_b64_tr_b16 a[120:121], v64 offset:18432
    ds_read_b64_tr_b16 a[122:123], v64 offset:18944
    ds_read_b64_tr_b16 a[124:125], v65 offset:18432
    v_lshlrev_b32 v24, 16, v140
    v_and_b32 v25, s96, v140
    v_lshlrev_b32 v26, 16, v141
    v_and_b32 v27, s96, v141
    v_mfma_f32_32x32x16_bf16 a[16:31], v[136:139], a[100:103], a[16:31]
    ds_read_b64_tr_b16 a[126:127], v65 offset:18944
    ds_read_b64_tr_b16 a[128:129], v64 offset:20480
    v_fma_f32 v24, v24, v62, v63
    v_fma_f32 v25, v25, v62, v63
    v_fma_f32 v26, v26, v62, v63
    v_fma_f32 v27, v27, v62, v63
    v_mfma_f32_32x32x16_bf16 a[32:47], v[136:139], a[104:107], a[32:47]
    ds_read_b64_tr_b16 a[130:131], v64 offset:20992
    ds_read_b64_tr_b16 a[132:133], v65 offset:20480
    v_cvt_pk_bf16_f32 v140, v24, v25
    v_cvt_pk_bf16_f32 v141, v26, v27
    v_lshlrev_b32 v28, 16, v142
    v_and_b32 v29, s96, v142
    s_waitcnt lgkmcnt(7)
    v_mfma_f32_32x32x16_bf16 a[48:63], v[136:139], a[108:111], a[48:63]
    s_waitcnt vmcnt(18)
    s_barrier
    ds_read_b64_tr_b16 a[134:135], v65 offset:20992
    ds_read_b64_tr_b16 a[136:137], v64 offset:22528
    ds_read_b64_tr_b16 a[138:139], v64 offset:23040
    v_lshlrev_b32 v30, 16, v143
    v_and_b32 v31, s96, v143
    v_fma_f32 v28, v28, v62, v63
    v_fma_f32 v29, v29, v62, v63
    s_add_u32 m0, s40, 22528
    s_nop 0
    buffer_load_dwordx4 v4, s[8:11], s48 offen lds
    buffer_load_dwordx4 v4, s[8:11], s49 offen offset:1024 lds
    v_add_u32 v4, s92, v4
    v_mfma_f32_32x32x16_bf16 a[64:79], a[112:115], v[136:139], a[64:79]
    ds_read_b64_tr_b16 a[140:141], v65 offset:22528
    ds_read_b64_tr_b16 a[142:143], v65 offset:23040
    v_fma_f32 v30, v30, v62, v63
    v_fma_f32 v31, v31, v62, v63
    v_cvt_pk_bf16_f32 v142, v28, v29
    v_cvt_pk_bf16_f32 v143, v30, v31
    v_mfma_f32_32x32x16_bf16 a[80:95], a[116:119], v[136:139], a[80:95]
    s_waitcnt lgkmcnt(6)
    v_mfma_f32_32x32x16_bf16 a[0:15], v[140:143], a[120:123], a[0:15]
    ds_read_b64_tr_b16 a[96:97], v12 offset:0
    ds_read_b64_tr_b16 a[98:99], v12 offset:512
    ds_read_b64_tr_b16 a[100:101], v14 offset:0
    v_lshlrev_b32 v24, 16, v144
    v_and_b32 v25, s96, v144
    v_lshlrev_b32 v26, 16, v145
    v_and_b32 v27, s96, v145
    s_add_u32 m0, s40, 24576
    s_cmp_eq_u32 s69, 5
    s_cselect_b32 s92, s89, s88
    buffer_load_dwordx4 v4, s[8:11], s44 offen lds
    buffer_load_dwordx4 v4, s[8:11], s45 offen offset:1024 lds
    buffer_load_dwordx4 v4, s[8:11], s46 offen offset:2048 lds
    buffer_load_dwordx4 v4, s[8:11], s47 offen offset:3072 lds
    v_mfma_f32_32x32x16_bf16 a[16:31], v[140:143], a[124:127], a[16:31]
    ds_read_b64_tr_b16 a[102:103], v14 offset:512
    ds_read_b64_tr_b16 a[104:105], v12 offset:2048
    v_fma_f32 v24, v24, v62, v63
    v_fma_f32 v25, v25, v62, v63
    v_fma_f32 v26, v26, v62, v63
    v_fma_f32 v27, v27, v62, v63
    v_mfma_f32_32x32x16_bf16 a[32:47], v[140:143], a[128:131], a[32:47]
    ds_read_b64_tr_b16 a[106:107], v12 offset:2560
    ds_read_b64_tr_b16 a[108:109], v14 offset:2048
    ds_read_b64_tr_b16 a[110:111], v14 offset:2560
    v_cvt_pk_bf16_f32 v144, v24, v25
    v_cvt_pk_bf16_f32 v145, v26, v27
    v_lshlrev_b32 v28, 16, v146
    v_and_b32 v29, s96, v146
    s_waitcnt lgkmcnt(8)
    v_mfma_f32_32x32x16_bf16 a[48:63], v[140:143], a[132:135], a[48:63]
    ds_read_b64_tr_b16 a[112:113], v12 offset:4096
    ds_read_b64_tr_b16 a[114:115], v12 offset:4608
    v_lshlrev_b32 v30, 16, v147
    v_and_b32 v31, s96, v147
    v_fma_f32 v28, v28, v62, v63
    v_fma_f32 v29, v29, v62, v63
    v_mfma_f32_32x32x16_bf16 a[64:79], a[136:139], v[140:143], a[64:79]
    ds_read_b64_tr_b16 a[116:117], v14 offset:4096
    ds_read_b64_tr_b16 a[118:119], v14 offset:4608
    v_fma_f32 v30, v30, v62, v63
    v_fma_f32 v31, v31, v62, v63
    v_cvt_pk_bf16_f32 v146, v28, v29
    v_cvt_pk_bf16_f32 v147, v30, v31
    v_mfma_f32_32x32x16_bf16 a[80:95], a[140:143], v[140:143], a[80:95]
    s_waitcnt lgkmcnt(6)
    v_mfma_f32_32x32x16_bf16 a[0:15], v[144:147], a[96:99], a[0:15]
    ds_read_b64_tr_b16 a[120:121], v12 offset:32768
    ds_read_b64_tr_b16 a[122:123], v12 offset:33280
    ds_read_b64_tr_b16 a[124:125], v14 offset:32768
    v_lshlrev_b32 v24, 16, v148
    v_and_b32 v25, s96, v148
    v_lshlrev_b32 v26, 16, v149
    v_and_b32 v27, s96, v149
    s_add_u32 m0, s40, 28672
    s_nop 0
    buffer_load_dwordx4 v4, s[8:11], s48 offen lds
    buffer_load_dwordx4 v4, s[8:11], s49 offen offset:1024 lds
    v_add_u32 v4, s92, v4
    v_mfma_f32_32x32x16_bf16 a[16:31], v[144:147], a[100:103], a[16:31]
    ds_read_b64_tr_b16 a[126:127], v14 offset:33280
    ds_read_b64_tr_b16 a[128:129], v12 offset:34816
    v_fma_f32 v24, v24, v62, v63
    v_fma_f32 v25, v25, v62, v63
    v_fma_f32 v26, v26, v62, v63
    v_fma_f32 v27, v27, v62, v63
    v_mfma_f32_32x32x16_bf16 a[32:47], v[144:147], a[104:107], a[32:47]
    ds_read_b64_tr_b16 a[130:131], v12 offset:35328
    ds_read_b64_tr_b16 a[132:133], v14 offset:34816
    ds_read_b64_tr_b16 a[134:135], v14 offset:35328
    v_cvt_pk_bf16_f32 v148, v24, v25
    v_cvt_pk_bf16_f32 v149, v26, v27
    v_lshlrev_b32 v28, 16, v150
    v_and_b32 v29, s96, v150
    s_waitcnt lgkmcnt(8)
    v_mfma_f32_32x32x16_bf16 a[48:63], v[144:147], a[108:111], a[48:63]
    ds_read_b64_tr_b16 a[136:137], v12 offset:36864
    ds_read_b64_tr_b16 a[138:139], v12 offset:37376
    v_lshlrev_b32 v30, 16, v151
    v_and_b32 v31, s96, v151
    v_fma_f32 v28, v28, v62, v63
    v_fma_f32 v29, v29, v62, v63
    v_mfma_f32_32x32x16_bf16 a[64:79], a[112:115], v[144:147], a[64:79]
    ds_read_b64_tr_b16 a[140:141], v14 offset:36864
    ds_read_b64_tr_b16 a[142:143], v14 offset:37376
    v_fma_f32 v30, v30, v62, v63
    v_fma_f32 v31, v31, v62, v63
    v_cvt_pk_bf16_f32 v150, v28, v29
    v_cvt_pk_bf16_f32 v151, v30, v31
    v_mfma_f32_32x32x16_bf16 a[80:95], a[116:119], v[144:147], a[80:95]
    s_waitcnt lgkmcnt(6)
    v_mfma_f32_32x32x16_bf16 a[0:15], v[148:151], a[120:123], a[0:15]
    ds_read_b64_tr_b16 a[96:97], v13 offset:0
    ds_read_b64_tr_b16 a[98:99], v13 offset:512
    ds_read_b64_tr_b16 a[100:101], v15 offset:0
    v_lshlrev_b32 v24, 16, v152
    v_and_b32 v25, s96, v152
    v_lshlrev_b32 v26, 16, v153
    v_and_b32 v27, s96, v153
    v_fma_f32 v24, v24, v62, v63
    v_mfma_f32_32x32x16_bf16 a[16:31], v[148:151], a[124:127], a[16:31]
    ds_read_b64_tr_b16 a[102:103], v15 offset:512
    ds_read_b64_tr_b16 a[104:105], v13 offset:2048
    v_fma_f32 v25, v25, v62, v63
    v_fma_f32 v26, v26, v62, v63
    v_fma_f32 v27, v27, v62, v63
    v_cvt_pk_bf16_f32 v152, v24, v25
    v_mfma_f32_32x32x16_bf16 a[32:47], v[148:151], a[128:131], a[32:47]
    ds_read_b64_tr_b16 a[106:107], v13 offset:2560
    ds_read_b64_tr_b16 a[108:109], v15 offset:2048
    ds_read_b64_tr_b16 a[110:111], v15 offset:2560
    v_cvt_pk_bf16_f32 v153, v26, v27
    v_lshlrev_b32 v28, 16, v154
    v_and_b32 v29, s96, v154
    v_lshlrev_b32 v30, 16, v155
    s_waitcnt lgkmcnt(8)
    v_mfma_f32_32x32x16_bf16 a[48:63], v[148:151], a[132:135], a[48:63]
    ds_read_b64_tr_b16 a[112:113], v13 offset:4096
    ds_read_b64_tr_b16 a[114:115], v13 offset:4608
    v_and_b32 v31, s96, v155
    v_fma_f32 v28, v28, v62, v63
    v_fma_f32 v29, v29, v62, v63
    v_fma_f32 v30, v30, v62, v63
    v_mfma_f32_32x32x16_bf16 a[64:79], a[136:139], v[148:151], a[64:79]
    ds_read_b64_tr_b16 a[116:117], v15 offset:4096
    ds_read_b64_tr_b16 a[118:119], v15 offset:4608
    v_fma_f32 v31, v31, v62, v63
    v_cvt_pk_bf16_f32 v154, v28, v29
    v_cvt_pk_bf16_f32 v155, v30, v31
    s_and_b32 s57, s37, 7
    s_lshl_b32 s57, s57, 2
    s_mul_i32 s57, s57, 57344
    s_add_u32 s57, s57, s50
    v_and_b32 v54, 15, v1
    v_mul_u32_u24 v54, 3584, v54
    buffer_load_dword v55, v54, s[12:15], s57 offen
    buffer_load_dword v55, v54, s[16:19], s57 offen
    v_mfma_f32_32x32x16_bf16 a[80:95], a[140:143], v[148:151], a[80:95]
    s_waitcnt lgkmcnt(6)
    v_mfma_f32_32x32x16_bf16 a[0:15], v[152:155], a[96:99], a[0:15]
    ds_read_b64_tr_b16 a[120:121], v13 offset:32768
    ds_read_b64_tr_b16 a[122:123], v13 offset:33280
    ds_read_b64_tr_b16 a[124:125], v15 offset:32768
    v_lshlrev_b32 v24, 16, v156
    v_and_b32 v25, s96, v156
    v_lshlrev_b32 v26, 16, v157
    v_and_b32 v27, s96, v157
    v_mfma_f32_32x32x16_bf16 a[16:31], v[152:155], a[100:103], a[16:31]
    ds_read_b64_tr_b16 a[126:127], v15 offset:33280
    ds_read_b64_tr_b16 a[128:129], v13 offset:34816
    v_fma_f32 v24, v24, v62, v63
    v_fma_f32 v25, v25, v62, v63
    v_fma_f32 v26, v26, v62, v63
    v_fma_f32 v27, v27, v62, v63
    v_mfma_f32_32x32x16_bf16 a[32:47], v[152:155], a[104:107], a[32:47]
    ds_read_b64_tr_b16 a[130:131], v13 offset:35328
    ds_read_b64_tr_b16 a[132:133], v15 offset:34816
    v_cvt_pk_bf16_f32 v156, v24, v25
    v_cvt_pk_bf16_f32 v157, v26, v27
    v_lshlrev_b32 v28, 16, v158
    v_and_b32 v29, s96, v158
    s_waitcnt lgkmcnt(7)
    v_mfma_f32_32x32x16_bf16 a[48:63], v[152:155], a[108:111], a[48:63]
    s_waitcnt vmcnt(22)
    s_barrier
    ds_read_b64_tr_b16 a[134:135], v15 offset:35328
    ds_read_b64_tr_b16 a[136:137], v13 offset:36864
    ds_read_b64_tr_b16 a[138:139], v13 offset:37376
    v_lshlrev_b32 v30, 16, v159
    v_and_b32 v31, s96, v159
    v_fma_f32 v28, v28, v62, v63
    v_fma_f32 v29, v29, v62, v63
    v_mfma_f32_32x32x16_bf16 a[64:79], a[112:115], v[152:155], a[64:79]
    ds_read_b64_tr_b16 a[140:141], v15 offset:36864
    ds_read_b64_tr_b16 a[142:143], v15 offset:37376
    v_fma_f32 v30, v30, v62, v63
    v_fma_f32 v31, v31, v62, v63
    v_cvt_pk_bf16_f32 v158, v28, v29
    v_cvt_pk_bf16_f32 v159, v30, v31
    v_mfma_f32_32x32x16_bf16 a[80:95], a[116:119], v[152:155], a[80:95]
    s_waitcnt lgkmcnt(6)
    v_mfma_f32_32x32x16_bf16 a[0:15], v[156:159], a[120:123], a[0:15]
    ds_read_b64_tr_b16 a[96:97], v12 offset:6144
    ds_read_b64_tr_b16 a[98:99], v12 offset:6656
    ds_read_b64_tr_b16 a[100:101], v14 offset:6144
    v_lshlrev_b32 v24, 16, v160
    v_and_b32 v25, s96, v160
    v_lshlrev_b32 v26, 16, v161
    v_and_b32 v27, s96, v161
    s_add_u32 m0, s68, 0
    v_add_u32 v3, 0x4000, v3
    buffer_load_dwordx4 v3, s[24:27], s63 offen lds
    buffer_load_dwordx4 v3, s[24:27], s64 offen offset:1024 lds
    v_mfma_f32_32x32x16_bf16 a[16:31], v[156:159], a[124:127], a[16:31]
    ds_read_b64_tr_b16 a[102:103], v14 offset:6656
    ds_read_b64_tr_b16 a[104:105], v12 offset:8192
    v_fma_f32 v24, v24, v62, v63
    v_fma_f32 v25, v25, v62, v63
    v_fma_f32 v26, v26, v62, v63
    v_fma_f32 v27, v27, v62, v63
    v_mfma_f32_32x32x16_bf16 a[32:47], v[156:159], a[128:131], a[32:47]
    ds_read_b64_tr_b16 a[106:107], v12 offset:8704
    ds_read_b64_tr_b16 a[108:109], v14 offset:8192
    ds_read_b64_tr_b16 a[110:111], v14 offset:8704
    v_cvt_pk_bf16_f32 v160, v24, v25
    v_cvt_pk_bf16_f32 v161, v26, v27
    v_lshlrev_b32 v28, 16, v162
    v_and_b32 v29, s96, v162
    s_waitcnt lgkmcnt(8)
    v_mfma_f32_32x32x16_bf16 a[48:63], v[156:159], a[132:135], a[48:63]
    ds_read_b64_tr_b16 a[112:113], v12 offset:10240
    ds_read_b64_tr_b16 a[114:115], v12 offset:10752
    v_lshlrev_b32 v30, 16, v163
    v_and_b32 v31, s96, v163
    v_fma_f32 v28, v28, v62, v63
    v_fma_f32 v29, v29, v62, v63
    v_mfma_f32_32x32x16_bf16 a[64:79], a[136:139], v[156:159], a[64:79]
    ds_read_b64_tr_b16 a[116:117], v14 offset:10240
    ds_read_b64_tr_b16 a[118:119], v14 offset:10752
    v_fma_f32 v30, v30, v62, v63
    v_fma_f32 v31, v31, v62, v63
    v_cvt_pk_bf16_f32 v162, v28, v29
    v_cvt_pk_bf16_f32 v163, v30, v31
    v_mfma_f32_32x32x16_bf16 a[80:95], a[140:143], v[156:159], a[80:95]
    s_waitcnt lgkmcnt(6)
    v_mfma_f32_32x32x16_bf16 a[0:15], v[160:163], a[96:99], a[0:15]
    ds_read_b64_tr_b16 a[120:121], v12 offset:38912
    ds_read_b64_tr_b16 a[122:123], v12 offset:39424
    ds_read_b64_tr_b16 a[124:125], v14 offset:38912
    v_lshlrev_b32 v24, 16, v164
    v_and_b32 v25, s96, v164
    v_lshlrev_b32 v26, 16, v165
    v_and_b32 v27, s96, v165
    s_add_u32 m0, s68, 2048
    v_add_u32 v3, 0x4000, v3
    buffer_load_dwordx4 v3, s[24:27], s63 offen lds
    buffer_load_dwordx4 v3, s[24:27], s64 offen offset:1024 lds
    v_mfma_f32_32x32x16_bf16 a[16:31], v[160:163], a[100:103], a[16:31]
    ds_read_b64_tr_b16 a[126:127], v14 offset:39424
    ds_read_b64_tr_b16 a[128:129], v12 offset:40960
    v_fma_f32 v24, v24, v62, v63
    v_fma_f32 v25, v25, v62, v63
    v_fma_f32 v26, v26, v62, v63
    v_fma_f32 v27, v27, v62, v63
    v_mfma_f32_32x32x16_bf16 a[32:47], v[160:163], a[104:107], a[32:47]
    ds_read_b64_tr_b16 a[130:131], v12 offset:41472
    ds_read_b64_tr_b16 a[132:133], v14 offset:40960
    ds_read_b64_tr_b16 a[134:135], v14 offset:41472
    v_cvt_pk_bf16_f32 v164, v24, v25
    v_cvt_pk_bf16_f32 v165, v26, v27
    v_lshlrev_b32 v28, 16, v166
    v_and_b32 v29, s96, v166
    s_waitcnt lgkmcnt(8)
    v_mfma_f32_32x32x16_bf16 a[48:63], v[160:163], a[108:111], a[48:63]
    ds_read_b64_tr_b16 a[136:137], v12 offset:43008
    ds_read_b64_tr_b16 a[138:139], v12 offset:43520
    v_lshlrev_b32 v30, 16, v167
    v_and_b32 v31, s96, v167
    v_fma_f32 v28, v28, v62, v63
    v_fma_f32 v29, v29, v62, v63
    v_mfma_f32_32x32x16_bf16 a[64:79], a[112:115], v[160:163], a[64:79]
    ds_read_b64_tr_b16 a[140:141], v14 offset:43008
    ds_read_b64_tr_b16 a[142:143], v14 offset:43520
    v_fma_f32 v30, v30, v62, v63
    v_fma_f32 v31, v31, v62, v63
    v_cvt_pk_bf16_f32 v166, v28, v29
    v_cvt_pk_bf16_f32 v167, v30, v31
    v_mfma_f32_32x32x16_bf16 a[80:95], a[116:119], v[160:163], a[80:95]
    s_waitcnt lgkmcnt(6)
    v_mfma_f32_32x32x16_bf16 a[0:15], v[164:167], a[120:123], a[0:15]
    ds_read_b64_tr_b16 a[96:97], v13 offset:6144
    ds_read_b64_tr_b16 a[98:99], v13 offset:6656
    ds_read_b64_tr_b16 a[100:101], v15 offset:6144
    v_lshlrev_b32 v24, 16, v168
    v_and_b32 v25, s96, v168
    v_lshlrev_b32 v26, 16, v169
    v_and_b32 v27, s96, v169
    v_fma_f32 v24, v24, v62, v63
    s_add_u32 m0, s68, 4096
    v_add_u32 v3, 0x4000, v3
    buffer_load_dwordx4 v3, s[24:27], s63 offen lds
    buffer_load_dwordx4 v3, s[24:27], s64 offen offset:1024 lds
    v_mfma_f32_32x32x16_bf16 a[16:31], v[164:167], a[124:127], a[16:31]
    ds_read_b64_tr_b16 a[102:103], v15 offset:6656
    ds_read_b64_tr_b16 a[104:105], v13 offset:8192
    v_fma_f32 v25, v25, v62, v63
    v_fma_f32 v26, v26, v62, v63
    v_fma_f32 v27, v27, v62, v63
    v_cvt_pk_bf16_f32 v168, v24, v25
    v_mfma_f32_32x32x16_bf16 a[32:47], v[164:167], a[128:131], a[32:47]
    ds_read_b64_tr_b16 a[106:107], v13 offset:8704
    ds_read_b64_tr_b16 a[108:109], v15 offset:8192
    ds_read_b64_tr_b16 a[110:111], v15 offset:8704
    v_cvt_pk_bf16_f32 v169, v26, v27
    v_lshlrev_b32 v28, 16, v170
    v_and_b32 v29, s96, v170
    v_lshlrev_b32 v30, 16, v171
    s_waitcnt lgkmcnt(8)
    v_mfma_f32_32x32x16_bf16 a[48:63], v[164:167], a[132:135], a[48:63]
    ds_read_b64_tr_b16 a[112:113], v13 offset:10240
    ds_read_b64_tr_b16 a[114:115], v13 offset:10752
    v_and_b32 v31, s96, v171
    v_fma_f32 v28, v28, v62, v63
    v_fma_f32 v29, v29, v62, v63
    v_fma_f32 v30, v30, v62, v63
    v_mfma_f32_32x32x16_bf16 a[64:79], a[136:139], v[164:167], a[64:79]
    ds_read_b64_tr_b16 a[116:117], v15 offset:10240
    ds_read_b64_tr_b16 a[118:119], v15 offset:10752
    v_fma_f32 v31, v31, v62, v63
    v_cvt_pk_bf16_f32 v170, v28, v29
    v_cvt_pk_bf16_f32 v171, v30, v31
    s_lshr_b32 s57, s2, 3
    s_lshl_b32 s57, s57, 2
    s_add_u32 s57, s57, s36
    s_lshl_b32 s57, s57, 12
    v_and_b32 v54, 31, v1
    v_lshlrev_b32 v54, 7, v54
    buffer_load_dword v55, v54, s[28:31], s57 offen
    v_mfma_f32_32x32x16_bf16 a[80:95], a[140:143], v[164:167], a[80:95]
    s_waitcnt lgkmcnt(6)
    v_mfma_f32_32x32x16_bf16 a[0:15], v[168:171], a[96:99], a[0:15]
    ds_read_b64_tr_b16 a[120:121], v13 offset:38912
    ds_read_b64_tr_b16 a[122:123], v13 offset:39424
    ds_read_b64_tr_b16 a[124:125], v15 offset:38912
    v_lshlrev_b32 v24, 16, v172
    v_and_b32 v25, s96, v172
    v_lshlrev_b32 v26, 16, v173
    v_and_b32 v27, s96, v173
    v_mfma_f32_32x32x16_bf16 a[16:31], v[168:171], a[100:103], a[16:31]
    ds_read_b64_tr_b16 a[126:127], v15 offset:39424
    ds_read_b64_tr_b16 a[128:129], v13 offset:40960
    v_fma_f32 v24, v24, v62, v63
    v_fma_f32 v25, v25, v62, v63
    v_fma_f32 v26, v26, v62, v63
    v_fma_f32 v27, v27, v62, v63
    v_mfma_f32_32x32x16_bf16 a[32:47], v[168:171], a[104:107], a[32:47]
    ds_read_b64_tr_b16 a[130:131], v13 offset:41472
    ds_read_b64_tr_b16 a[132:133], v15 offset:40960
    v_cvt_pk_bf16_f32 v172, v24, v25
    v_cvt_pk_bf16_f32 v173, v26, v27
    v_lshlrev_b32 v28, 16, v174
    v_and_b32 v29, s96, v174
    s_waitcnt lgkmcnt(7)
    v_mfma_f32_32x32x16_bf16 a[48:63], v[168:171], a[108:111], a[48:63]
    s_waitcnt vmcnt(23)
    s_barrier
    ds_read_b64_tr_b16 a[134:135], v15 offset:41472
    ds_read_b64_tr_b16 a[136:137], v13 offset:43008
    ds_read_b64_tr_b16 a[138:139], v13 offset:43520
    v_lshlrev_b32 v30, 16, v175
    v_and_b32 v31, s96, v175
    v_fma_f32 v28, v28, v62, v63
    v_fma_f32 v29, v29, v62, v63
    s_add_u32 m0, s68, 6144
    s_mov_b32 s59, 0x4000
    s_cmp_eq_u32 s101, 4
    s_cselect_b32 s59, 0xfff94000, s59
    v_add_u32 v3, s59, v3
    buffer_load_dwordx4 v3, s[24:27], s63 offen lds
    buffer_load_dwordx4 v3, s[24:27], s64 offen offset:1024 lds
    v_mfma_f32_32x32x16_bf16 a[64:79], a[112:115], v[168:171], a[64:79]
    ds_read_b64_tr_b16 a[140:141], v15 offset:43008
    ds_read_b64_tr_b16 a[142:143], v15 offset:43520
    v_fma_f32 v30, v30, v62, v63
    v_fma_f32 v31, v31, v62, v63
    v_cvt_pk_bf16_f32 v174, v28, v29
    v_cvt_pk_bf16_f32 v175, v30, v31
    v_mfma_f32_32x32x16_bf16 a[80:95], a[116:119], v[168:171], a[80:95]
    s_waitcnt lgkmcnt(6)
    v_mfma_f32_32x32x16_bf16 a[0:15], v[172:175], a[120:123], a[0:15]
    ds_read_b64_tr_b16 a[96:97], v12 offset:12288
    ds_read_b64_tr_b16 a[98:99], v12 offset:12800
    ds_read_b64_tr_b16 a[100:101], v14 offset:12288
    v_lshlrev_b32 v24, 16, v176
    v_and_b32 v25, s96, v176
    v_lshlrev_b32 v26, 16, v177
    v_and_b32 v27, s96, v177
    s_add_u32 m0, s40, 0
    s_cmp_eq_u32 s69, 6
    s_cselect_b32 s92, s89, s88
    buffer_load_dwordx4 v4, s[8:11], s44 offen lds
    buffer_load_dwordx4 v4, s[8:11], s45 offen offset:1024 lds
    buffer_load_dwordx4 v4, s[8:11], s46 offen offset:2048 lds
    buffer_load_dwordx4 v4, s[8:11], s47 offen offset:3072 lds
    v_mfma_f32_32x32x16_bf16 a[16:31], v[172:175], a[124:127], a[16:31]
    ds_read_b64_tr_b16 a[102:103], v14 offset:12800
    ds_read_b64_tr_b16 a[104:105], v12 offset:14336
    v_fma_f32 v24, v24, v62, v63
    v_fma_f32 v25, v25, v62, v63
    v_fma_f32 v26, v26, v62, v63
    v_fma_f32 v27, v27, v62, v63
    v_mfma_f32_32x32x16_bf16 a[32:47], v[172:175], a[128:131], a[32:47]
    ds_read_b64_tr_b16 a[106:107], v12 offset:14848
    ds_read_b64_tr_b16 a[108:109], v14 offset:14336
    ds_read_b64_tr_b16 a[110:111], v14 offset:14848
    v_cvt_pk_bf16_f32 v176, v24, v25
    v_cvt_pk_bf16_f32 v177, v26, v27
    v_lshlrev_b32 v28, 16, v178
    v_and_b32 v29, s96, v178
    s_waitcnt lgkmcnt(8)
    v_mfma_f32_32x32x16_bf16 a[48:63], v[172:175], a[132:135], a[48:63]
    ds_read_b64_tr_b16 a[112:113], v12 offset:16384
    ds_read_b64_tr_b16 a[114:115], v12 offset:16896
    v_lshlrev_b32 v30, 16, v179
    v_and_b32 v31, s96, v179
    v_fma_f32 v28, v28, v62, v63
    v_fma_f32 v29, v29, v62, v63
    v_mfma_f32_32x32x16_bf16 a[64:79], a[136:139], v[172:175], a[64:79]
    ds_read_b64_tr_b16 a[116:117], v14 offset:16384
    ds_read_b64_tr_b16 a[118:119], v14 offset:16896
    v_fma_f32 v30, v30, v62, v63
    v_fma_f32 v31, v31, v62, v63
    v_cvt_pk_bf16_f32 v178, v28, v29
    v_cvt_pk_bf16_f32 v179, v30, v31
    v_mfma_f32_32x32x16_bf16 a[80:95], a[140:143], v[172:175], a[80:95]
    s_waitcnt lgkmcnt(6)
    v_mfma_f32_32x32x16_bf16 a[0:15], v[176:179], a[96:99], a[0:15]
    ds_read_b64_tr_b16 a[120:121], v12 offset:45056
    ds_read_b64_tr_b16 a[122:123], v12 offset:45568
    ds_read_b64_tr_b16 a[124:125], v14 offset:45056
    v_lshlrev_b32 v24, 16, v180
    v_and_b32 v25, s96, v180
    v_lshlrev_b32 v26, 16, v181
    v_and_b32 v27, s96, v181
    s_waitcnt vmcnt(23)
    ds_read_b64_tr_b16 a[160:161], v10 offset:30720
    s_add_u32 m0, s40, 4096
    s_nop 0
    buffer_load_dwordx4 v4, s[8:11], s48 offen lds
    buffer_load_dwordx4 v4, s[8:11], s49 offen offset:1024 lds
    v_add_u32 v4, s92, v4
    v_mfma_f32_32x32x16_bf16 a[16:31], v[176:179], a[100:103], a[16:31]
    ds_read_b64_tr_b16 a[126:127], v14 offset:45568
    ds_read_b64_tr_b16 a[128:129], v12 offset:47104
    v_fma_f32 v24, v24, v62, v63
    v_fma_f32 v25, v25, v62, v63
    v_fma_f32 v26, v26, v62, v63
    v_fma_f32 v27, v27, v62, v63
    ds_read_b64_tr_b16 a[162:163], v10 offset:31744
    v_mfma_f32_32x32x16_bf16 a[32:47], v[176:179], a[104:107], a[32:47]
    ds_read_b64_tr_b16 a[130:131], v12 offset:47616
    ds_read_b64_tr_b16 a[132:133], v14 offset:47104
    ds_read_b64_tr_b16 a[134:135], v14 offset:47616
    v_cvt_pk_bf16_f32 v180, v24, v25
    v_cvt_pk_bf16_f32 v181, v26, v27
    v_lshlrev_b32 v28, 16, v182
    v_and_b32 v29, s96, v182
    ds_read_b64_tr_b16 a[164:165], v11 offset:30720
    s_waitcnt lgkmcnt(11)
    v_mfma_f32_32x32x16_bf16 a[48:63], v[176:179], a[108:111], a[48:63]
    ds_read_b64_tr_b16 a[136:137], v12 offset:49152
    ds_read_b64_tr_b16 a[138:139], v12 offset:49664
    v_lshlrev_b32 v30, 16, v183
    v_and_b32 v31, s96, v183
    v_fma_f32 v28, v28, v62, v63
    v_fma_f32 v29, v29, v62, v63
    ds_read_b64_tr_b16 a[166:167], v11 offset:31744
    v_mfma_f32_32x32x16_bf16 a[64:79], a[112:115], v[176:179], a[64:79]
    ds_read_b64_tr_b16 a[140:141], v14 offset:49152
    ds_read_b64_tr_b16 a[142:143], v14 offset:49664
    v_fma_f32 v30, v30, v62, v63
    v_fma_f32 v31, v31, v62, v63
    v_cvt_pk_bf16_f32 v182, v28, v29
    v_cvt_pk_bf16_f32 v183, v30, v31
    v_mfma_f32_32x32x16_bf16 a[80:95], a[116:119], v[176:179], a[80:95]
    s_waitcnt lgkmcnt(8)
    v_mfma_f32_32x32x16_bf16 a[0:15], v[180:183], a[120:123], a[0:15]
    ds_read_b64_tr_b16 a[96:97], v13 offset:12288
    ds_read_b64_tr_b16 a[98:99], v13 offset:12800
    ds_read_b64_tr_b16 a[100:101], v15 offset:12288
    v_lshlrev_b32 v24, 16, v184
    v_and_b32 v25, s96, v184
    v_lshlrev_b32 v26, 16, v185
    v_and_b32 v27, s96, v185
    s_waitcnt lgkmcnt(5)
    s_add_u32 m0, s40, 30720
    v_add_u32 v3, 0x4000, v3
    buffer_load_dwordx4 v3, s[24:27], s63 offen lds
    buffer_load_dwordx4 v3, s[24:27], s64 offen offset:1024 lds
    v_mfma_f32_32x32x16_bf16 a[16:31], v[180:183], a[124:127], a[16:31]
    ds_read_b64_tr_b16 a[102:103], v15 offset:12800
    ds_read_b64_tr_b16 a[104:105], v13 offset:14336
    v_fma_f32 v24, v24, v62, v63
    v_fma_f32 v25, v25, v62, v63
    v_fma_f32 v26, v26, v62, v63
    v_fma_f32 v27, v27, v62, v63
    v_mfma_f32_32x32x16_bf16 a[32:47], v[180:183], a[128:131], a[32:47]
    ds_read_b64_tr_b16 a[106:107], v13 offset:14848
    ds_read_b64_tr_b16 a[108:109], v15 offset:14336
    ds_read_b64_tr_b16 a[110:111], v15 offset:14848
    v_cvt_pk_bf16_f32 v184, v24, v25
    v_cvt_pk_bf16_f32 v185, v26, v27
    v_lshlrev_b32 v28, 16, v186
    v_and_b32 v29, s96, v186
    s_waitcnt lgkmcnt(8)
    v_mfma_f32_32x32x16_bf16 a[48:63], v[180:183], a[132:135], a[48:63]
    ds_read_b64_tr_b16 a[112:113], v13 offset:16384
    ds_read_b64_tr_b16 a[114:115], v13 offset:16896
    v_lshlrev_b32 v30, 16, v187
    v_and_b32 v31, s96, v187
    v_fma_f32 v28, v28, v62, v63
    v_fma_f32 v29, v29, v62, v63
    v_mfma_f32_32x32x16_bf16 a[64:79], a[136:139], v[180:183], a[64:79]
    ds_read_b64_tr_b16 a[116:117], v15 offset:16384
    ds_read_b64_tr_b16 a[118:119], v15 offset:16896
    v_fma_f32 v30, v30, v62, v63
    v_fma_f32 v31, v31, v62, v63
    v_cvt_pk_bf16_f32 v186, v28, v29
    v_cvt_pk_bf16_f32 v187, v30, v31
    v_mfma_f32_32x32x16_bf16 a[80:95], a[140:143], v[180:183], a[80:95]
    s_waitcnt lgkmcnt(6)
    v_mfma_f32_32x32x16_bf16 a[0:15], v[184:187], a[96:99], a[0:15]
    ds_read_b64_tr_b16 a[120:121], v13 offset:45056
    ds_read_b64_tr_b16 a[122:123], v13 offset:45568
    ds_read_b64_tr_b16 a[124:125], v15 offset:45056
    v_lshlrev_b32 v24, 16, v188
    v_and_b32 v25, s96, v188
    v_lshlrev_b32 v26, 16, v189
    v_and_b32 v27, s96, v189
    v_mfma_f32_32x32x16_bf16 a[16:31], v[184:187], a[100:103], a[16:31]
    ds_read_b64_tr_b16 a[126:127], v15 offset:45568
    ds_read_b64_tr_b16 a[128:129], v13 offset:47104
    v_fma_f32 v24, v24, v62, v63
    v_fma_f32 v25, v25, v62, v63
    v_fma_f32 v26, v26, v62, v63
    v_fma_f32 v27, v27, v62, v63
    v_mfma_f32_32x32x16_bf16 a[32:47], v[184:187], a[104:107], a[32:47]
    ds_read_b64_tr_b16 a[130:131], v13 offset:47616
    ds_read_b64_tr_b16 a[132:133], v15 offset:47104
    v_cvt_pk_bf16_f32 v188, v24, v25
    v_cvt_pk_bf16_f32 v189, v26, v27
    v_lshlrev_b32 v28, 16, v190
    v_and_b32 v29, s96, v190
    s_waitcnt lgkmcnt(7)
    v_mfma_f32_32x32x16_bf16 a[48:63], v[184:187], a[108:111], a[48:63]
    s_waitcnt vmcnt(25)
    s_barrier
    ds_read_b64_tr_b16 a[134:135], v15 offset:47616
    ds_read_b64_tr_b16 a[136:137], v13 offset:49152
    ds_read_b64_tr_b16 a[138:139], v13 offset:49664
    v_lshlrev_b32 v30, 16, v191
    v_and_b32 v31, s96, v191
    v_fma_f32 v28, v28, v62, v63
    v_fma_f32 v29, v29, v62, v63
    v_mfma_f32_32x32x16_bf16 a[64:79], a[112:115], v[184:187], a[64:79]
    ds_read_b64_tr_b16 a[140:141], v15 offset:49152
    ds_read_b64_tr_b16 a[142:143], v15 offset:49664
    v_fma_f32 v30, v30, v62, v63
    v_fma_f32 v31, v31, v62, v63
    v_cvt_pk_bf16_f32 v190, v28, v29
    v_cvt_pk_bf16_f32 v191, v30, v31
    v_mfma_f32_32x32x16_bf16 a[80:95], a[116:119], v[184:187], a[80:95]
    s_waitcnt lgkmcnt(6)
    v_mfma_f32_32x32x16_bf16 a[0:15], v[188:191], a[120:123], a[0:15]
    ds_read_b64_tr_b16 a[96:97], v12 offset:18432
    ds_read_b64_tr_b16 a[98:99], v12 offset:18944
    ds_read_b64_tr_b16 a[100:101], v14 offset:18432
    v_lshlrev_b32 v24, 16, v192
    v_and_b32 v25, s96, v192
    v_lshlrev_b32 v26, 16, v193
    v_and_b32 v27, s96, v193
    s_add_u32 m0, s40, 6144
    s_cmp_eq_u32 s69, 7
    s_cselect_b32 s92, s89, s88
    buffer_load_dwordx4 v4, s[8:11], s44 offen lds
    buffer_load_dwordx4 v4, s[8:11], s45 offen offset:1024 lds
    buffer_load_dwordx4 v4, s[8:11], s46 offen offset:2048 lds
    buffer_load_dwordx4 v4, s[8:11], s47 offen offset:3072 lds
    v_mfma_f32_32x32x16_bf16 a[16:31], v[188:191], a[124:127], a[16:31]
    ds_read_b64_tr_b16 a[102:103], v14 offset:18944
    ds_read_b64_tr_b16 a[104:105], v12 offset:20480
    v_fma_f32 v24, v24, v62, v63
    v_fma_f32 v25, v25, v62, v63
    v_fma_f32 v26, v26, v62, v63
    v_fma_f32 v27, v27, v62, v63
    v_mfma_f32_32x32x16_bf16 a[32:47], v[188:191], a[128:131], a[32:47]
    ds_read_b64_tr_b16 a[106:107], v12 offset:20992
    ds_read_b64_tr_b16 a[108:109], v14 offset:20480
    ds_read_b64_tr_b16 a[110:111], v14 offset:20992
    v_cvt_pk_bf16_f32 v192, v24, v25
    v_cvt_pk_bf16_f32 v193, v26, v27
    v_lshlrev_b32 v28, 16, v194
    v_and_b32 v29, s96, v194
    s_waitcnt lgkmcnt(8)
    v_mfma_f32_32x32x16_bf16 a[48:63], v[188:191], a[132:135], a[48:63]
    ds_read_b64_tr_b16 a[112:113], v12 offset:22528
    ds_read_b64_tr_b16 a[114:115], v12 offset:23040
    v_lshlrev_b32 v30, 16, v195
    v_and_b32 v31, s96, v195
    v_fma_f32 v28, v28, v62, v63
    v_fma_f32 v29, v29, v62, v63
    v_mfma_f32_32x32x16_bf16 a[64:79], a[136:139], v[188:191], a[64:79]
    ds_read_b64_tr_b16 a[116:117], v14 offset:22528
    ds_read_b64_tr_b16 a[118:119], v14 offset:23040
    v_fma_f32 v30, v30, v62, v63
    v_fma_f32 v31, v31, v62, v63
    v_cvt_pk_bf16_f32 v194, v28, v29
    v_cvt_pk_bf16_f32 v195, v30, v31
    v_mfma_f32_32x32x16_bf16 a[80:95], a[140:143], v[188:191], a[80:95]
    s_waitcnt lgkmcnt(6)
    v_mfma_f32_32x32x16_bf16 a[0:15], v[192:195], a[96:99], a[0:15]
    ds_read_b64_tr_b16 a[120:121], v12 offset:51200
    ds_read_b64_tr_b16 a[122:123], v12 offset:51712
    ds_read_b64_tr_b16 a[124:125], v14 offset:51200
    v_lshlrev_b32 v24, 16, v196
    v_and_b32 v25, s96, v196
    v_lshlrev_b32 v26, 16, v197
    v_and_b32 v27, s96, v197
    s_add_u32 m0, s40, 10240
    s_nop 0
    buffer_load_dwordx4 v4, s[8:11], s48 offen lds
    buffer_load_dwordx4 v4, s[8:11], s49 offen offset:1024 lds
    v_mfma_f32_32x32x16_bf16 a[16:31], v[192:195], a[100:103], a[16:31]
    ds_read_b64_tr_b16 a[126:127], v14 offset:51712
    ds_read_b64_tr_b16 a[128:129], v12 offset:53248
    v_fma_f32 v24, v24, v62, v63
    v_fma_f32 v25, v25, v62, v63
    v_fma_f32 v26, v26, v62, v63
    v_fma_f32 v27, v27, v62, v63
    v_mfma_f32_32x32x16_bf16 a[32:47], v[192:195], a[104:107], a[32:47]
    ds_read_b64_tr_b16 a[130:131], v12 offset:53760
    ds_read_b64_tr_b16 a[132:133], v14 offset:53248
    ds_read_b64_tr_b16 a[134:135], v14 offset:53760
    v_cvt_pk_bf16_f32 v196, v24, v25
    v_cvt_pk_bf16_f32 v197, v26, v27
    v_lshlrev_b32 v28, 16, v198
    v_and_b32 v29, s96, v198
    s_waitcnt lgkmcnt(8)
    v_mfma_f32_32x32x16_bf16 a[48:63], v[192:195], a[108:111], a[48:63]
    ds_read_b64_tr_b16 a[136:137], v12 offset:55296
    ds_read_b64_tr_b16 a[138:139], v12 offset:55808
    v_lshlrev_b32 v30, 16, v199
    v_and_b32 v31, s96, v199
    v_fma_f32 v28, v28, v62, v63
    v_fma_f32 v29, v29, v62, v63
    v_mfma_f32_32x32x16_bf16 a[64:79], a[112:115], v[192:195], a[64:79]
    ds_read_b64_tr_b16 a[140:141], v14 offset:55296
    ds_read_b64_tr_b16 a[142:143], v14 offset:55808
    v_fma_f32 v30, v30, v62, v63
    v_fma_f32 v31, v31, v62, v63
    v_cvt_pk_bf16_f32 v198, v28, v29
    v_cvt_pk_bf16_f32 v199, v30, v31
    v_mfma_f32_32x32x16_bf16 a[80:95], a[116:119], v[192:195], a[80:95]
    s_waitcnt lgkmcnt(6)
    v_mfma_f32_32x32x16_bf16 a[0:15], v[196:199], a[120:123], a[0:15]
    ds_read_b64_tr_b16 a[96:97], v13 offset:18432
    ds_read_b64_tr_b16 a[98:99], v13 offset:18944
    ds_read_b64_tr_b16 a[100:101], v15 offset:18432
    v_lshlrev_b32 v24, 16, v200
    v_and_b32 v25, s96, v200
    v_lshlrev_b32 v26, 16, v201
    v_and_b32 v27, s96, v201
    v_mfma_f32_32x32x16_bf16 a[16:31], v[196:199], a[124:127], a[16:31]
    ds_read_b64_tr_b16 a[102:103], v15 offset:18944
    ds_read_b64_tr_b16 a[104:105], v13 offset:20480
    v_fma_f32 v24, v24, v62, v63
    v_fma_f32 v25, v25, v62, v63
    v_fma_f32 v26, v26, v62, v63
    v_fma_f32 v27, v27, v62, v63
    v_mfma_f32_32x32x16_bf16 a[32:47], v[196:199], a[128:131], a[32:47]
    ds_read_b64_tr_b16 a[106:107], v13 offset:20992
    ds_read_b64_tr_b16 a[108:109], v15 offset:20480
    ds_read_b64_tr_b16 a[110:111], v15 offset:20992
    v_cvt_pk_bf16_f32 v200, v24, v25
    v_cvt_pk_bf16_f32 v201, v26, v27
    v_lshlrev_b32 v28, 16, v202
    v_and_b32 v29, s96, v202
    s_waitcnt lgkmcnt(8)
    v_mfma_f32_32x32x16_bf16 a[48:63], v[196:199], a[132:135], a[48:63]
    ds_read_b64_tr_b16 a[112:113], v13 offset:22528
    ds_read_b64_tr_b16 a[114:115], v13 offset:23040
    v_lshlrev_b32 v30, 16, v203
    v_and_b32 v31, s96, v203
    v_fma_f32 v28, v28, v62, v63
    v_fma_f32 v29, v29, v62, v63
    v_mfma_f32_32x32x16_bf16 a[64:79], a[136:139], v[196:199], a[64:79]
    ds_read_b64_tr_b16 a[116:117], v15 offset:22528
    ds_read_b64_tr_b16 a[118:119], v15 offset:23040
    v_fma_f32 v30, v30, v62, v63
    v_fma_f32 v31, v31, v62, v63
    v_cvt_pk_bf16_f32 v202, v28, v29
    v_cvt_pk_bf16_f32 v203, v30, v31
    v_mfma_f32_32x32x16_bf16 a[80:95], a[140:143], v[196:199], a[80:95]
    s_waitcnt lgkmcnt(6)
    v_mfma_f32_32x32x16_bf16 a[0:15], v[200:203], a[96:99], a[0:15]
    ds_read_b64_tr_b16 a[120:121], v13 offset:51200
    ds_read_b64_tr_b16 a[122:123], v13 offset:51712
    ds_read_b64_tr_b16 a[124:125], v15 offset:51200
    v_lshlrev_b32 v24, 16, v204
    v_and_b32 v25, s96, v204
    v_lshlrev_b32 v26, 16, v205
    v_and_b32 v27, s96, v205
    s_waitcnt vmcnt(21)
    ds_read_b64_tr_b16 a[168:169], v8 offset:0
    v_mfma_f32_32x32x16_bf16 a[16:31], v[200:203], a[100:103], a[16:31]
    ds_read_b64_tr_b16 a[126:127], v15 offset:51712
    ds_read_b64_tr_b16 a[128:129], v13 offset:53248
    v_fma_f32 v24, v24, v62, v63
    v_fma_f32 v25, v25, v62, v63
    v_fma_f32 v26, v26, v62, v63
    v_fma_f32 v27, v27, v62, v63
    ds_read_b64_tr_b16 a[170:171], v8 offset:1024
    v_mfma_f32_32x32x16_bf16 a[32:47], v[200:203], a[104:107], a[32:47]
    ds_read_b64_tr_b16 a[130:131], v13 offset:53760
    ds_read_b64_tr_b16 a[132:133], v15 offset:53248
    v_cvt_pk_bf16_f32 v204, v24, v25
    v_cvt_pk_bf16_f32 v205, v26, v27
    v_lshlrev_b32 v28, 16, v206
    v_and_b32 v29, s96, v206
    s_waitcnt lgkmcnt(9)
    v_mfma_f32_32x32x16_bf16 a[48:63], v[200:203], a[108:111], a[48:63]
    s_barrier
    ds_read_b64_tr_b16 a[134:135], v15 offset:53760
    ds_read_b64_tr_b16 a[136:137], v13 offset:55296
    ds_read_b64_tr_b16 a[138:139], v13 offset:55808
    v_lshlrev_b32 v30, 16, v207
    v_and_b32 v31, s96, v207
    v_fma_f32 v28, v28, v62, v63
    v_fma_f32 v29, v29, v62, v63
    ds_read_b64_tr_b16 a[172:173], v9 offset:0
    v_mfma_f32_32x32x16_bf16 a[64:79], a[112:115], v[200:203], a[64:79]
    ds_read_b64_tr_b16 a[140:141], v15 offset:55296
    ds_read_b64_tr_b16 a[142:143], v15 offset:55808
    v_fma_f32 v30, v30, v62, v63
    v_fma_f32 v31, v31, v62, v63
    v_cvt_pk_bf16_f32 v206, v28, v29
    v_cvt_pk_bf16_f32 v207, v30, v31
    ds_read_b64_tr_b16 a[174:175], v9 offset:1024
    v_mfma_f32_32x32x16_bf16 a[80:95], a[116:119], v[200:203], a[80:95]
    s_waitcnt lgkmcnt(8)
    v_mfma_f32_32x32x16_bf16 a[0:15], v[204:207], a[120:123], a[0:15]
    ds_read_b64_tr_b16 a[96:97], v12 offset:24576
    ds_read_b64_tr_b16 a[98:99], v12 offset:25088
    ds_read_b64_tr_b16 a[100:101], v14 offset:24576
    v_lshlrev_b32 v24, 16, v208
    v_and_b32 v25, s96, v208
    v_lshlrev_b32 v26, 16, v209
    v_and_b32 v27, s96, v209
    s_waitcnt vmcnt(19)
    ds_read_b64_tr_b16 a[176:177], v8 offset:2048
    s_add_u32 m0, s40, 12288
    s_cmp_eq_u32 s69, 0
    s_cselect_b32 s92, s91, s90
    buffer_load_dwordx4 v5, s[12:15], s50 offen lds
    buffer_load_dwordx4 v5, s[12:15], s51 offen offset:1024 lds
    v_add_u32 v5, s92, v5
    v_mfma_f32_32x32x16_bf16 a[16:31], v[204:207], a[124:127], a[16:31]
    ds_read_b64_tr_b16 a[102:103], v14 offset:25088
    ds_read_b64_tr_b16 a[104:105], v12 offset:26624
    v_fma_f32 v24, v24, v62, v63
    v_fma_f32 v25, v25, v62, v63
    v_fma_f32 v26, v26, v62, v63
    v_fma_f32 v27, v27, v62, v63
    ds_read_b64_tr_b16 a[178:179], v8 offset:3072
    v_mfma_f32_32x32x16_bf16 a[32:47], v[204:207], a[128:131], a[32:47]
    ds_read_b64_tr_b16 a[106:107], v12 offset:27136
    ds_read_b64_tr_b16 a[108:109], v14 offset:26624
    ds_read_b64_tr_b16 a[110:111], v14 offset:27136
    v_cvt_pk_bf16_f32 v208, v24, v25
    v_cvt_pk_bf16_f32 v209, v26, v27
    v_lshlrev_b32 v28, 16, v210
    v_and_b32 v29, s96, v210
    ds_read_b64_tr_b16 a[180:181], v9 offset:2048
    s_waitcnt lgkmcnt(11)
    s_add_u32 m0, s68, 0
    v_add_u32 v3, 0x4000, v3
    buffer_load_dwordx4 v3, s[24:27], s63 offen lds
    buffer_load_dwordx4 v3, s[24:27], s64 offen offset:1024 lds
    v_mfma_f32_32x32x16_bf16 a[48:63], v[204:207], a[132:135], a[48:63]
    ds_read_b64_tr_b16 a[112:113], v12 offset:28672
    ds_read_b64_tr_b16 a[114:115], v12 offset:29184
    v_lshlrev_b32 v30, 16, v211
    v_and_b32 v31, s96, v211
    v_fma_f32 v28, v28, v62, v63
    v_fma_f32 v29, v29, v62, v63
    ds_read_b64_tr_b16 a[182:183], v9 offset:3072
    v_mfma_f32_32x32x16_bf16 a[64:79], a[136:139], v[204:207], a[64:79]
    ds_read_b64_tr_b16 a[116:117], v14 offset:28672
    ds_read_b64_tr_b16 a[118:119], v14 offset:29184
    v_fma_f32 v30, v30, v62, v63
    v_fma_f32 v31, v31, v62, v63
    v_cvt_pk_bf16_f32 v210, v28, v29
    v_cvt_pk_bf16_f32 v211, v30, v31
    v_mfma_f32_32x32x16_bf16 a[80:95], a[140:143], v[204:207], a[80:95]
    s_waitcnt lgkmcnt(8)
    v_mfma_f32_32x32x16_bf16 a[0:15], v[208:211], a[96:99], a[0:15]
    ds_read_b64_tr_b16 a[120:121], v12 offset:57344
    ds_read_b64_tr_b16 a[122:123], v12 offset:57856
    ds_read_b64_tr_b16 a[124:125], v14 offset:57344
    v_lshlrev_b32 v24, 16, v212
    v_and_b32 v25, s96, v212
    v_lshlrev_b32 v26, 16, v213
    v_and_b32 v27, s96, v213
    s_waitcnt vmcnt(21)
    ds_read_b64_tr_b16 a[184:185], v8 offset:4096
    s_add_u32 m0, s40, 14336
    s_nop 0
    buffer_load_dwordx4 v6, s[16:19], s50 offen lds
    buffer_load_dwordx4 v6, s[16:19], s51 offen offset:1024 lds
    v_add_u32 v6, s92, v6
    v_mfma_f32_32x32x16_bf16 a[16:31], v[208:211], a[100:103], a[16:31]
    ds_read_b64_tr_b16 a[126:127], v14 offset:57856
    ds_read_b64_tr_b16 a[128:129], v12 offset:59392
    v_fma_f32 v24, v24, v62, v63
    v_fma_f32 v25, v25, v62, v63
    v_fma_f32 v26, v26, v62, v63
    v_fma_f32 v27, v27, v62, v63
    ds_read_b64_tr_b16 a[186:187], v8 offset:5120
    v_mfma_f32_32x32x16_bf16 a[32:47], v[208:211], a[104:107], a[32:47]
    ds_read_b64_tr_b16 a[130:131], v12 offset:59904
    ds_read_b64_tr_b16 a[132:133], v14 offset:59392
    ds_read_b64_tr_b16 a[134:135], v14 offset:59904
    v_cvt_pk_bf16_f32 v212, v24, v25
    v_cvt_pk_bf16_f32 v213, v26, v27
    v_lshlrev_b32 v28, 16, v214
    v_and_b32 v29, s96, v214
    ds_read_b64_tr_b16 a[188:189], v9 offset:4096
    s_waitcnt lgkmcnt(13)
    s_add_u32 m0, s68, 2048
    v_add_u32 v3, 0x4000, v3
    buffer_load_dwordx4 v3, s[24:27], s63 offen lds
    buffer_load_dwordx4 v3, s[24:27], s64 offen offset:1024 lds
    s_waitcnt lgkmcnt(11)
    v_mfma_f32_32x32x16_bf16 a[48:63], v[208:211], a[108:111], a[48:63]
    ds_read_b64_tr_b16 a[136:137], v12 offset:61440
    ds_read_b64_tr_b16 a[138:139], v12 offset:61952
    v_lshlrev_b32 v30, 16, v215
    v_and_b32 v31, s96, v215
    v_fma_f32 v28, v28, v62, v63
    v_fma_f32 v29, v29, v62, v63
    ds_read_b64_tr_b16 a[190:191], v9 offset:5120
    v_mfma_f32_32x32x16_bf16 a[64:79], a[112:115], v[208:211], a[64:79]
    ds_read_b64_tr_b16 a[140:141], v14 offset:61440
    ds_read_b64_tr_b16 a[142:143], v14 offset:61952
    v_fma_f32 v30, v30, v62, v63
    v_fma_f32 v31, v31, v62, v63
    v_cvt_pk_bf16_f32 v214, v28, v29
    v_cvt_pk_bf16_f32 v215, v30, v31
    v_mfma_f32_32x32x16_bf16 a[80:95], a[116:119], v[208:211], a[80:95]
    s_waitcnt lgkmcnt(8)
    v_mfma_f32_32x32x16_bf16 a[0:15], v[212:215], a[120:123], a[0:15]
    ds_read_b64_tr_b16 a[96:97], v13 offset:24576
    ds_read_b64_tr_b16 a[98:99], v13 offset:25088
    ds_read_b64_tr_b16 a[100:101], v15 offset:24576
    v_lshlrev_b32 v24, 16, v216
    v_and_b32 v25, s96, v216
    v_lshlrev_b32 v26, 16, v217
    v_and_b32 v27, s96, v217
    s_waitcnt vmcnt(22)
    ds_read_b64_tr_b16 a[192:193], v8 offset:6144
    s_waitcnt lgkmcnt(6)
    s_add_u32 m0, s68, 4096
    s_mov_b32 s59, 0x4000
    s_cmp_eq_u32 s101, 8
    s_cselect_b32 s59, 0xfff94000, s59
    v_add_u32 v3, s59, v3
    buffer_load_dwordx4 v3, s[24:27], s63 offen lds
    buffer_load_dwordx4 v3, s[24:27], s64 offen offset:1024 lds
    v_mfma_f32_32x32x16_bf16 a[16:31], v[212:215], a[124:127], a[16:31]
    ds_read_b64_tr_b16 a[102:103], v15 offset:25088
    ds_read_b64_tr_b16 a[104:105], v13 offset:26624
    v_fma_f32 v24, v24, v62, v63
    v_fma_f32 v25, v25, v62, v63
    v_fma_f32 v26, v26, v62, v63
    v_fma_f32 v27, v27, v62, v63
    ds_read_b64_tr_b16 a[194:195], v8 offset:7168
    v_mfma_f32_32x32x16_bf16 a[32:47], v[212:215], a[128:131], a[32:47]
    ds_read_b64_tr_b16 a[106:107], v13 offset:27136
    ds_read_b64_tr_b16 a[108:109], v15 offset:26624
    ds_read_b64_tr_b16 a[110:111], v15 offset:27136
    v_cvt_pk_bf16_f32 v216, v24, v25
    v_cvt_pk_bf16_f32 v217, v26, v27
    v_lshlrev_b32 v28, 16, v218
    v_and_b32 v29, s96, v218
    ds_read_b64_tr_b16 a[196:197], v9 offset:6144
    s_waitcnt lgkmcnt(11)
    v_mfma_f32_32x32x16_bf16 a[48:63], v[212:215], a[132:135], a[48:63]
    ds_read_b64_tr_b16 a[112:113], v13 offset:28672
    ds_read_b64_tr_b16 a[114:115], v13 offset:29184
    v_lshlrev_b32 v30, 16, v219
    v_and_b32 v31, s96, v219
    v_fma_f32 v28, v28, v62, v63
    v_fma_f32 v29, v29, v62, v63
    ds_read_b64_tr_b16 a[198:199], v9 offset:7168
    v_mfma_f32_32x32x16_bf16 a[64:79], a[136:139], v[212:215], a[64:79]
    ds_read_b64_tr_b16 a[116:117], v15 offset:28672
    ds_read_b64_tr_b16 a[118:119], v15 offset:29184
    v_fma_f32 v30, v30, v62, v63
    v_fma_f32 v31, v31, v62, v63
    v_cvt_pk_bf16_f32 v218, v28, v29
    v_cvt_pk_bf16_f32 v219, v30, v31
    v_mfma_f32_32x32x16_bf16 a[80:95], a[140:143], v[212:215], a[80:95]
    s_waitcnt lgkmcnt(8)
    v_mfma_f32_32x32x16_bf16 a[0:15], v[216:219], a[96:99], a[0:15]
    ds_read_b64_tr_b16 a[120:121], v13 offset:57344
    ds_read_b64_tr_b16 a[122:123], v13 offset:57856
    ds_read_b64_tr_b16 a[124:125], v15 offset:57344
    v_lshlrev_b32 v24, 16, v220
    v_and_b32 v25, s96, v220
    v_lshlrev_b32 v26, 16, v221
    v_and_b32 v27, s96, v221
    v_mfma_f32_32x32x16_bf16 a[16:31], v[216:219], a[100:103], a[16:31]
    ds_read_b64_tr_b16 a[126:127], v15 offset:57856
    ds_read_b64_tr_b16 a[128:129], v13 offset:59392
    v_fma_f32 v24, v24, v62, v63
    v_fma_f32 v25, v25, v62, v63
    v_fma_f32 v26, v26, v62, v63
    v_fma_f32 v27, v27, v62, v63
    v_mfma_f32_32x32x16_bf16 a[32:47], v[216:219], a[104:107], a[32:47]
    ds_read_b64_tr_b16 a[130:131], v13 offset:59904
    ds_read_b64_tr_b16 a[132:133], v15 offset:59392
    v_cvt_pk_bf16_f32 v220, v24, v25
    v_cvt_pk_bf16_f32 v221, v26, v27
    v_lshlrev_b32 v28, 16, v222
    v_and_b32 v29, s96, v222
    s_waitcnt lgkmcnt(7)
    v_mfma_f32_32x32x16_bf16 a[48:63], v[216:219], a[108:111], a[48:63]
    s_waitcnt vmcnt(18)
    s_barrier
    ds_read_b64_tr_b16 a[134:135], v15 offset:59904
    ds_read_b64_tr_b16 a[136:137], v13 offset:61440
    ds_read_b64_tr_b16 a[138:139], v13 offset:61952
    v_lshlrev_b32 v30, 16, v223
    v_and_b32 v31, s96, v223
    v_fma_f32 v28, v28, v62, v63
    v_fma_f32 v29, v29, v62, v63
    s_add_u32 m0, s68, 6144
    v_add_u32 v3, 0x4000, v3
    buffer_load_dwordx4 v3, s[24:27], s63 offen lds
    buffer_load_dwordx4 v3, s[24:27], s64 offen offset:1024 lds
    v_mfma_f32_32x32x16_bf16 a[64:79], a[112:115], v[216:219], a[64:79]
    ds_read_b64_tr_b16 a[140:141], v15 offset:61440
    ds_read_b64_tr_b16 a[142:143], v15 offset:61952
    v_fma_f32 v30, v30, v62, v63
    v_fma_f32 v31, v31, v62, v63
    v_cvt_pk_bf16_f32 v222, v28, v29
    v_cvt_pk_bf16_f32 v223, v30, v31
    v_mfma_f32_32x32x16_bf16 a[80:95], a[116:119], v[216:219], a[80:95]
    s_waitcnt lgkmcnt(6)
    v_mfma_f32_32x32x16_bf16 a[0:15], v[220:223], a[120:123], a[0:15]
    ds_read_b64_tr_b16 a[96:97], v12 offset:0
    ds_read_b64_tr_b16 a[98:99], v12 offset:512
    ds_read_b64_tr_b16 a[100:101], v14 offset:0
    v_lshlrev_b32 v24, 16, v224
    v_and_b32 v25, s96, v224
    v_lshlrev_b32 v26, 16, v225
    v_and_b32 v27, s96, v225
    s_add_u32 m0, s40, 18432
    s_cmp_eq_u32 s69, 1
    s_cselect_b32 s92, s91, s90
    buffer_load_dwordx4 v5, s[12:15], s50 offen lds
    buffer_load_dwordx4 v5, s[12:15], s51 offen offset:1024 lds
    v_add_u32 v5, s92, v5
    v_mfma_f32_32x32x16_bf16 a[16:31], v[220:223], a[124:127], a[16:31]
    ds_read_b64_tr_b16 a[102:103], v14 offset:512
    ds_read_b64_tr_b16 a[104:105], v12 offset:2048
    v_fma_f32 v24, v24, v62, v63
    v_fma_f32 v25, v25, v62, v63
    v_fma_f32 v26, v26, v62, v63
    v_fma_f32 v27, v27, v62, v63
    v_mfma_f32_32x32x16_bf16 a[32:47], v[220:223], a[128:131], a[32:47]
    ds_read_b64_tr_b16 a[106:107], v12 offset:2560
    ds_read_b64_tr_b16 a[108:109], v14 offset:2048
    ds_read_b64_tr_b16 a[110:111], v14 offset:2560
    v_cvt_pk_bf16_f32 v224, v24, v25
    v_cvt_pk_bf16_f32 v225, v26, v27
    v_lshlrev_b32 v28, 16, v226
    v_and_b32 v29, s96, v226
    s_waitcnt lgkmcnt(8)
    v_mfma_f32_32x32x16_bf16 a[48:63], v[220:223], a[132:135], a[48:63]
    ds_read_b64_tr_b16 a[112:113], v12 offset:4096
    ds_read_b64_tr_b16 a[114:115], v12 offset:4608
    v_lshlrev_b32 v30, 16, v227
    v_and_b32 v31, s96, v227
    v_fma_f32 v28, v28, v62, v63
    v_fma_f32 v29, v29, v62, v63
    v_mfma_f32_32x32x16_bf16 a[64:79], a[136:139], v[220:223], a[64:79]
    ds_read_b64_tr_b16 a[116:117], v14 offset:4096
    ds_read_b64_tr_b16 a[118:119], v14 offset:4608
    v_fma_f32 v30, v30, v62, v63
    v_fma_f32 v31, v31, v62, v63
    v_cvt_pk_bf16_f32 v226, v28, v29
    v_cvt_pk_bf16_f32 v227, v30, v31
    v_mfma_f32_32x32x16_bf16 a[80:95], a[140:143], v[220:223], a[80:95]
    s_waitcnt lgkmcnt(6)
    v_mfma_f32_32x32x16_bf16 a[0:15], v[224:227], a[96:99], a[0:15]
    ds_read_b64_tr_b16 a[120:121], v12 offset:32768
    ds_read_b64_tr_b16 a[122:123], v12 offset:33280
    ds_read_b64_tr_b16 a[124:125], v14 offset:32768
    v_lshlrev_b32 v24, 16, v228
    v_and_b32 v25, s96, v228
    v_lshlrev_b32 v26, 16, v229
    v_and_b32 v27, s96, v229
    s_waitcnt vmcnt(20)
    ds_read_b64_tr_b16 a[200:201], v10 offset:30720
    s_add_u32 m0, s40, 20480
    s_nop 0
    buffer_load_dwordx4 v6, s[16:19], s50 offen lds
    buffer_load_dwordx4 v6, s[16:19], s51 offen offset:1024 lds
    v_add_u32 v6, s92, v6
    v_mfma_f32_32x32x16_bf16 a[16:31], v[224:227], a[100:103], a[16:31]
    ds_read_b64_tr_b16 a[126:127], v14 offset:33280
    ds_read_b64_tr_b16 a[128:129], v12 offset:34816
    v_fma_f32 v24, v24, v62, v63
    v_fma_f32 v25, v25, v62, v63
    v_fma_f32 v26, v26, v62, v63
    v_fma_f32 v27, v27, v62, v63
    ds_read_b64_tr_b16 a[202:203], v10 offset:31744
    v_mfma_f32_32x32x16_bf16 a[32:47], v[224:227], a[104:107], a[32:47]
    ds_read_b64_tr_b16 a[130:131], v12 offset:35328
    ds_read_b64_tr_b16 a[132:133], v14 offset:34816
    ds_read_b64_tr_b16 a[134:135], v14 offset:35328
    v_cvt_pk_bf16_f32 v228, v24, v25
    v_cvt_pk_bf16_f32 v229, v26, v27
    v_lshlrev_b32 v28, 16, v230
    v_and_b32 v29, s96, v230
    ds_read_b64_tr_b16 a[204:205], v11 offset:30720
    s_waitcnt lgkmcnt(11)
    v_mfma_f32_32x32x16_bf16 a[48:63], v[224:227], a[108:111], a[48:63]
    ds_read_b64_tr_b16 a[136:137], v12 offset:36864
    ds_read_b64_tr_b16 a[138:139], v12 offset:37376
    v_lshlrev_b32 v30, 16, v231
    v_and_b32 v31, s96, v231
    v_fma_f32 v28, v28, v62, v63
    v_fma_f32 v29, v29, v62, v63
    ds_read_b64_tr_b16 a[206:207], v11 offset:31744
    v_mfma_f32_32x32x16_bf16 a[64:79], a[112:115], v[224:227], a[64:79]
    ds_read_b64_tr_b16 a[140:141], v14 offset:36864
    ds_read_b64_tr_b16 a[142:143], v14 offset:37376
    v_fma_f32 v30, v30, v62, v63
    v_fma_f32 v31, v31, v62, v63
    v_cvt_pk_bf16_f32 v230, v28, v29
    v_cvt_pk_bf16_f32 v231, v30, v31
    v_mfma_f32_32x32x16_bf16 a[80:95], a[116:119], v[224:227], a[80:95]
    s_waitcnt lgkmcnt(8)
    v_mfma_f32_32x32x16_bf16 a[0:15], v[228:231], a[120:123], a[0:15]
    ds_read_b64_tr_b16 a[96:97], v13 offset:0
    ds_read_b64_tr_b16 a[98:99], v13 offset:512
    ds_read_b64_tr_b16 a[100:101], v15 offset:0
    v_lshlrev_b32 v24, 16, v232
    v_and_b32 v25, s96, v232
    v_lshlrev_b32 v26, 16, v233
    v_and_b32 v27, s96, v233
    s_waitcnt lgkmcnt(5)
    s_add_u32 m0, s40, 30720
    v_add_u32 v3, 0x4000, v3
    buffer_load_dwordx4 v3, s[24:27], s63 offen lds
    buffer_load_dwordx4 v3, s[24:27], s64 offen offset:1024 lds
    v_mfma_f32_32x32x16_bf16 a[16:31], v[228:231], a[124:127], a[16:31]
    ds_read_b64_tr_b16 a[102:103], v15 offset:512
    ds_read_b64_tr_b16 a[104:105], v13 offset:2048
    v_fma_f32 v24, v24, v62, v63
    v_fma_f32 v25, v25, v62, v63
    v_fma_f32 v26, v26, v62, v63
    v_fma_f32 v27, v27, v62, v63
    v_mfma_f32_32x32x16_bf16 a[32:47], v[228:231], a[128:131], a[32:47]
    ds_read_b64_tr_b16 a[106:107], v13 offset:2560
    ds_read_b64_tr_b16 a[108:109], v15 offset:2048
    ds_read_b64_tr_b16 a[110:111], v15 offset:2560
    v_cvt_pk_bf16_f32 v232, v24, v25
    v_cvt_pk_bf16_f32 v233, v26, v27
    v_lshlrev_b32 v28, 16, v234
    v_and_b32 v29, s96, v234
    s_waitcnt lgkmcnt(8)
    v_mfma_f32_32x32x16_bf16 a[48:63], v[228:231], a[132:135], a[48:63]
    ds_read_b64_tr_b16 a[112:113], v13 offset:4096
    ds_read_b64_tr_b16 a[114:115], v13 offset:4608
    v_lshlrev_b32 v30, 16, v235
    v_and_b32 v31, s96, v235
    v_fma_f32 v28, v28, v62, v63
    v_fma_f32 v29, v29, v62, v63
    v_mfma_f32_32x32x16_bf16 a[64:79], a[136:139], v[228:231], a[64:79]
    ds_read_b64_tr_b16 a[116:117], v15 offset:4096
    ds_read_b64_tr_b16 a[118:119], v15 offset:4608
    v_fma_f32 v30, v30, v62, v63
    v_fma_f32 v31, v31, v62, v63
    v_cvt_pk_bf16_f32 v234, v28, v29
    v_cvt_pk_bf16_f32 v235, v30, v31
    v_mfma_f32_32x32x16_bf16 a[80:95], a[140:143], v[228:231], a[80:95]
    s_waitcnt lgkmcnt(6)
    v_mfma_f32_32x32x16_bf16 a[0:15], v[232:235], a[96:99], a[0:15]
    ds_read_b64_tr_b16 a[120:121], v13 offset:32768
    ds_read_b64_tr_b16 a[122:123], v13 offset:33280
    ds_read_b64_tr_b16 a[124:125], v15 offset:32768
    v_lshlrev_b32 v24, 16, v236
    v_and_b32 v25, s96, v236
    v_lshlrev_b32 v26, 16, v237
    v_and_b32 v27, s96, v237
    v_mfma_f32_32x32x16_bf16 a[16:31], v[232:235], a[100:103], a[16:31]
    ds_read_b64_tr_b16 a[126:127], v15 offset:33280
    ds_read_b64_tr_b16 a[128:129], v13 offset:34816
    v_fma_f32 v24, v24, v62, v63
    v_fma_f32 v25, v25, v62, v63
    v_fma_f32 v26, v26, v62, v63
    v_fma_f32 v27, v27, v62, v63
    v_mfma_f32_32x32x16_bf16 a[32:47], v[232:235], a[104:107], a[32:47]
    ds_read_b64_tr_b16 a[130:131], v13 offset:35328
    ds_read_b64_tr_b16 a[132:133], v15 offset:34816
    v_cvt_pk_bf16_f32 v236, v24, v25
    v_cvt_pk_bf16_f32 v237, v26, v27
    v_lshlrev_b32 v28, 16, v238
    v_and_b32 v29, s96, v238
    s_waitcnt lgkmcnt(7)
    v_mfma_f32_32x32x16_bf16 a[48:63], v[232:235], a[108:111], a[48:63]
    s_waitcnt vmcnt(18)
    s_barrier
    ds_read_b64_tr_b16 a[134:135], v15 offset:35328
    ds_read_b64_tr_b16 a[136:137], v13 offset:36864
    ds_read_b64_tr_b16 a[138:139], v13 offset:37376
    v_lshlrev_b32 v30, 16, v239
    v_and_b32 v31, s96, v239
    v_fma_f32 v28, v28, v62, v63
    v_fma_f32 v29, v29, v62, v63
    v_mfma_f32_32x32x16_bf16 a[64:79], a[112:115], v[232:235], a[64:79]
    ds_read_b64_tr_b16 a[140:141], v15 offset:36864
    ds_read_b64_tr_b16 a[142:143], v15 offset:37376
    v_fma_f32 v30, v30, v62, v63
    v_fma_f32 v31, v31, v62, v63
    v_cvt_pk_bf16_f32 v238, v28, v29
    v_cvt_pk_bf16_f32 v239, v30, v31
    v_mfma_f32_32x32x16_bf16 a[80:95], a[116:119], v[232:235], a[80:95]
    s_waitcnt lgkmcnt(6)
    v_mfma_f32_32x32x16_bf16 a[0:15], v[236:239], a[120:123], a[0:15]
    ds_read_b64_tr_b16 a[96:97], v12 offset:6144
    ds_read_b64_tr_b16 a[98:99], v12 offset:6656
    ds_read_b64_tr_b16 a[100:101], v14 offset:6144
    v_lshlrev_b32 v24, 16, v240
    v_and_b32 v25, s96, v240
    v_lshlrev_b32 v26, 16, v241
    v_and_b32 v27, s96, v241
    s_add_u32 m0, s40, 24576
    s_cmp_eq_u32 s69, 2
    s_cselect_b32 s92, s91, s90
    buffer_load_dwordx4 v5, s[12:15], s50 offen lds
    buffer_load_dwordx4 v5, s[12:15], s51 offen offset:1024 lds
    v_add_u32 v5, s92, v5
    v_mfma_f32_32x32x16_bf16 a[16:31], v[236:239], a[124:127], a[16:31]
    ds_read_b64_tr_b16 a[102:103], v14 offset:6656
    ds_read_b64_tr_b16 a[104:105], v12 offset:8192
    v_fma_f32 v24, v24, v62, v63
    v_fma_f32 v25, v25, v62, v63
    v_fma_f32 v26, v26, v62, v63
    v_fma_f32 v27, v27, v62, v63
    v_mfma_f32_32x32x16_bf16 a[32:47], v[236:239], a[128:131], a[32:47]
    ds_read_b64_tr_b16 a[106:107], v12 offset:8704
    ds_read_b64_tr_b16 a[108:109], v14 offset:8192
    ds_read_b64_tr_b16 a[110:111], v14 offset:8704
    v_cvt_pk_bf16_f32 v240, v24, v25
    v_cvt_pk_bf16_f32 v241, v26, v27
    v_lshlrev_b32 v28, 16, v242
    v_and_b32 v29, s96, v242
    s_waitcnt lgkmcnt(8)
    v_mfma_f32_32x32x16_bf16 a[48:63], v[236:239], a[132:135], a[48:63]
    ds_read_b64_tr_b16 a[112:113], v12 offset:10240
    ds_read_b64_tr_b16 a[114:115], v12 offset:10752
    v_lshlrev_b32 v30, 16, v243
    v_and_b32 v31, s96, v243
    v_fma_f32 v28, v28, v62, v63
    v_fma_f32 v29, v29, v62, v63
    v_mfma_f32_32x32x16_bf16 a[64:79], a[136:139], v[236:239], a[64:79]
    ds_read_b64_tr_b16 a[116:117], v14 offset:10240
    ds_read_b64_tr_b16 a[118:119], v14 offset:10752
    v_fma_f32 v30, v30, v62, v63
    v_fma_f32 v31, v31, v62, v63
    v_cvt_pk_bf16_f32 v242, v28, v29
    v_cvt_pk_bf16_f32 v243, v30, v31
    v_mfma_f32_32x32x16_bf16 a[80:95], a[140:143], v[236:239], a[80:95]
    s_waitcnt lgkmcnt(6)
    v_mfma_f32_32x32x16_bf16 a[0:15], v[240:243], a[96:99], a[0:15]
    ds_read_b64_tr_b16 a[120:121], v12 offset:38912
    ds_read_b64_tr_b16 a[122:123], v12 offset:39424
    ds_read_b64_tr_b16 a[124:125], v14 offset:38912
    v_lshlrev_b32 v24, 16, v244
    v_and_b32 v25, s96, v244
    v_lshlrev_b32 v26, 16, v245
    v_and_b32 v27, s96, v245
    s_add_u32 m0, s40, 26624
    s_nop 0
    buffer_load_dwordx4 v6, s[16:19], s50 offen lds
    buffer_load_dwordx4 v6, s[16:19], s51 offen offset:1024 lds
    v_add_u32 v6, s92, v6
    v_mfma_f32_32x32x16_bf16 a[16:31], v[240:243], a[100:103], a[16:31]
    ds_read_b64_tr_b16 a[126:127], v14 offset:39424
    ds_read_b64_tr_b16 a[128:129], v12 offset:40960
    v_fma_f32 v24, v24, v62, v63
    v_fma_f32 v25, v25, v62, v63
    v_fma_f32 v26, v26, v62, v63
    v_fma_f32 v27, v27, v62, v63
    v_mfma_f32_32x32x16_bf16 a[32:47], v[240:243], a[104:107], a[32:47]
    ds_read_b64_tr_b16 a[130:131], v12 offset:41472
    ds_read_b64_tr_b16 a[132:133], v14 offset:40960
    ds_read_b64_tr_b16 a[134:135], v14 offset:41472
    v_cvt_pk_bf16_f32 v244, v24, v25
    v_cvt_pk_bf16_f32 v245, v26, v27
    v_lshlrev_b32 v28, 16, v246
    v_and_b32 v29, s96, v246
    s_waitcnt lgkmcnt(8)
    v_mfma_f32_32x32x16_bf16 a[48:63], v[240:243], a[108:111], a[48:63]
    ds_read_b64_tr_b16 a[136:137], v12 offset:43008
    ds_read_b64_tr_b16 a[138:139], v12 offset:43520
    v_lshlrev_b32 v30, 16, v247
    v_and_b32 v31, s96, v247
    v_fma_f32 v28, v28, v62, v63
    v_fma_f32 v29, v29, v62, v63
    v_mfma_f32_32x32x16_bf16 a[64:79], a[112:115], v[240:243], a[64:79]
    ds_read_b64_tr_b16 a[140:141], v14 offset:43008
    ds_read_b64_tr_b16 a[142:143], v14 offset:43520
    v_fma_f32 v30, v30, v62, v63
    v_fma_f32 v31, v31, v62, v63
    v_cvt_pk_bf16_f32 v246, v28, v29
    v_cvt_pk_bf16_f32 v247, v30, v31
    v_mfma_f32_32x32x16_bf16 a[80:95], a[116:119], v[240:243], a[80:95]
    s_waitcnt lgkmcnt(6)
    v_mfma_f32_32x32x16_bf16 a[0:15], v[244:247], a[120:123], a[0:15]
    ds_read_b64_tr_b16 a[96:97], v13 offset:6144
    ds_read_b64_tr_b16 a[98:99], v13 offset:6656
    ds_read_b64_tr_b16 a[100:101], v15 offset:6144
    v_lshlrev_b32 v24, 16, v248
    v_and_b32 v25, s96, v248
    v_lshlrev_b32 v26, 16, v249
    v_and_b32 v27, s96, v249
    v_mfma_f32_32x32x16_bf16 a[16:31], v[244:247], a[124:127], a[16:31]
    ds_read_b64_tr_b16 a[102:103], v15 offset:6656
    ds_read_b64_tr_b16 a[104:105], v13 offset:8192
    v_fma_f32 v24, v24, v62, v63
    v_fma_f32 v25, v25, v62, v63
    v_fma_f32 v26, v26, v62, v63
    v_fma_f32 v27, v27, v62, v63
    v_mfma_f32_32x32x16_bf16 a[32:47], v[244:247], a[128:131], a[32:47]
    ds_read_b64_tr_b16 a[106:107], v13 offset:8704
    ds_read_b64_tr_b16 a[108:109], v15 offset:8192
    ds_read_b64_tr_b16 a[110:111], v15 offset:8704
    v_cvt_pk_bf16_f32 v248, v24, v25
    v_cvt_pk_bf16_f32 v249, v26, v27
    v_lshlrev_b32 v28, 16, v250
    v_and_b32 v29, s96, v250
    s_waitcnt lgkmcnt(8)
    v_mfma_f32_32x32x16_bf16 a[48:63], v[244:247], a[132:135], a[48:63]
    ds_read_b64_tr_b16 a[112:113], v13 offset:10240
    ds_read_b64_tr_b16 a[114:115], v13 offset:10752
    v_lshlrev_b32 v30, 16, v251
    v_and_b32 v31, s96, v251
    v_fma_f32 v28, v28, v62, v63
    v_fma_f32 v29, v29, v62, v63
    v_mfma_f32_32x32x16_bf16 a[64:79], a[136:139], v[244:247], a[64:79]
    ds_read_b64_tr_b16 a[116:117], v15 offset:10240
    ds_read_b64_tr_b16 a[118:119], v15 offset:10752
    v_fma_f32 v30, v30, v62, v63
    v_fma_f32 v31, v31, v62, v63
    v_cvt_pk_bf16_f32 v250, v28, v29
    v_cvt_pk_bf16_f32 v251, v30, v31
    v_mfma_f32_32x32x16_bf16 a[80:95], a[140:143], v[244:247], a[80:95]
    s_waitcnt lgkmcnt(6)
    v_mfma_f32_32x32x16_bf16 a[0:15], v[248:251], a[96:99], a[0:15]
    ds_read_b64_tr_b16 a[120:121], v13 offset:38912
    ds_read_b64_tr_b16 a[122:123], v13 offset:39424
    ds_read_b64_tr_b16 a[124:125], v15 offset:38912
    v_lshlrev_b32 v24, 16, v252
    v_and_b32 v25, s96, v252
    v_lshlrev_b32 v26, 16, v253
    v_and_b32 v27, s96, v253
    s_waitcnt vmcnt(18)
    ds_read_b64_tr_b16 a[208:209], v8 offset:0
    v_mfma_f32_32x32x16_bf16 a[16:31], v[248:251], a[100:103], a[16:31]
    ds_read_b64_tr_b16 a[126:127], v15 offset:39424
    ds_read_b64_tr_b16 a[128:129], v13 offset:40960
    v_fma_f32 v24, v24, v62, v63
    v_fma_f32 v25, v25, v62, v63
    v_fma_f32 v26, v26, v62, v63
    v_fma_f32 v27, v27, v62, v63
    ds_read_b64_tr_b16 a[210:211], v8 offset:1024
    v_mfma_f32_32x32x16_bf16 a[32:47], v[248:251], a[104:107], a[32:47]
    ds_read_b64_tr_b16 a[130:131], v13 offset:41472
    ds_read_b64_tr_b16 a[132:133], v15 offset:40960
    v_cvt_pk_bf16_f32 v252, v24, v25
    v_cvt_pk_bf16_f32 v253, v26, v27
    v_lshlrev_b32 v28, 16, v254
    v_and_b32 v29, s96, v254
    s_waitcnt lgkmcnt(9)
    v_mfma_f32_32x32x16_bf16 a[48:63], v[248:251], a[108:111], a[48:63]
    s_waitcnt vmcnt(16)
    s_barrier
    ds_read_b64_tr_b16 a[134:135], v15 offset:41472
    ds_read_b64_tr_b16 a[136:137], v13 offset:43008
    ds_read_b64_tr_b16 a[138:139], v13 offset:43520
    v_lshlrev_b32 v30, 16, v255
    v_and_b32 v31, s96, v255
    v_fma_f32 v28, v28, v62, v63
    v_fma_f32 v29, v29, v62, v63
    ds_read_b64_tr_b16 a[212:213], v9 offset:0
    v_mfma_f32_32x32x16_bf16 a[64:79], a[112:115], v[248:251], a[64:79]
    ds_read_b64_tr_b16 a[140:141], v15 offset:43008
    ds_read_b64_tr_b16 a[142:143], v15 offset:43520
    v_fma_f32 v30, v30, v62, v63
    v_fma_f32 v31, v31, v62, v63
    v_cvt_pk_bf16_f32 v254, v28, v29
    v_cvt_pk_bf16_f32 v255, v30, v31
    ds_read_b64_tr_b16 a[214:215], v9 offset:1024
    v_mfma_f32_32x32x16_bf16 a[80:95], a[116:119], v[248:251], a[80:95]
    s_waitcnt lgkmcnt(8)
    v_mfma_f32_32x32x16_bf16 a[0:15], v[252:255], a[120:123], a[0:15]
    ds_read_b64_tr_b16 a[96:97], v16 offset:12288
    ds_read_b64_tr_b16 a[98:99], v16 offset:12800
    v_mov_b32 v31, s43
    s_waitcnt vmcnt(14)
    ds_read_b64_tr_b16 a[216:217], v8 offset:2048
    s_add_u32 m0, s40, 0
    s_cmp_eq_u32 s69, 3
    s_cselect_b32 s92, s91, s90
    buffer_load_dwordx4 v5, s[12:15], s50 offen lds
    buffer_load_dwordx4 v5, s[12:15], s51 offen offset:1024 lds
    v_add_u32 v5, s92, v5
    v_mfma_f32_32x32x16_bf16 a[16:31], v[252:255], a[124:127], a[16:31]
    ds_read_b64_tr_b16 a[100:101], v18 offset:12288
    ds_read_b64_tr_b16 a[102:103], v18 offset:12800
    ds_read_b64_tr_b16 a[218:219], v8 offset:3072
    v_mfma_f32_32x32x16_bf16 a[32:47], v[252:255], a[128:131], a[32:47]
    ds_read_b64_tr_b16 a[104:105], v20 offset:12288
    ds_read_b64_tr_b16 a[220:221], v9 offset:2048
    s_waitcnt lgkmcnt(8)
    s_add_u32 m0, s68, 0
    v_add_u32 v3, 0x4000, v3
    buffer_load_dwordx4 v3, s[24:27], s63 offen lds
    buffer_load_dwordx4 v3, s[24:27], s64 offen offset:1024 lds
    v_mfma_f32_32x32x16_bf16 a[48:63], v[252:255], a[132:135], a[48:63]
    ds_read_b64_tr_b16 a[106:107], v20 offset:12800
    ds_read_b64_tr_b16 a[108:109], v22 offset:12288
    ds_read_b64_tr_b16 a[222:223], v9 offset:3072
    v_mfma_f32_32x32x16_bf16 a[64:79], a[136:139], v[252:255], a[64:79]
    ds_read_b64_tr_b16 a[110:111], v22 offset:12800
    v_mfma_f32_32x32x16_bf16 a[80:95], a[140:143], v[252:255], a[80:95]
    s_waitcnt lgkmcnt(7)
    v_mfma_f32_32x32x16_bf16 v[64:79], a[96:99], v[128:131], 0
    ds_read_b64_tr_b16 a[112:113], v16 offset:45056
    ds_read_b64_tr_b16 a[114:115], v16 offset:45568
    ds_read_b64_tr_b16 a[116:117], v18 offset:45056
    v_accvgpr_read_b32 v32, a0
    v_accvgpr_read_b32 v33, a1
    v_accvgpr_read_b32 v34, a2
    v_accvgpr_read_b32 v35, a3
    v_mul_f32 v36, s41, v32
    v_mul_f32 v37, s41, v33
    v_mul_f32 v38, s41, v34
    v_mul_f32 v39, s41, v35
    s_waitcnt vmcnt(16)
    ds_read_b64_tr_b16 a[224:225], v8 offset:4096
    ds_read_b64_tr_b16 a[226:227], v8 offset:5120
    s_add_u32 m0, s40, 2048
    s_nop 0
    buffer_load_dwordx4 v6, s[16:19], s50 offen lds
    buffer_load_dwordx4 v6, s[16:19], s51 offen offset:1024 lds
    v_add_u32 v6, s92, v6
    v_mfma_f32_32x32x16_bf16 v[80:95], a[100:103], v[128:131], 0
    ds_read_b64_tr_b16 a[118:119], v18 offset:45568
    ds_read_b64_tr_b16 a[120:121], v20 offset:45056
    ds_read_b64_tr_b16 a[122:123], v20 offset:45568
    v_exp_f32 v36, v36 clamp
    v_exp_f32 v37, v37 clamp
    v_exp_f32 v38, v38 clamp
    v_exp_f32 v39, v39 clamp
    v_max_f32 v32, s42, v32
    v_max_f32 v33, s42, v33
    v_max_f32 v34, s42, v34
    v_max_f32 v35, s42, v35
    ds_read_b64_tr_b16 a[228:229], v9 offset:4096
    s_waitcnt lgkmcnt(9)
    v_mfma_f32_32x32x16_bf16 v[96:111], a[104:107], v[128:131], 0
    ds_read_b64_tr_b16 a[124:125], v22 offset:45056
    ds_read_b64_tr_b16 a[126:127], v22 offset:45568
    v_add_f32 v32, v32, v36
    v_add_f32 v33, v33, v37
    v_add_f32 v34, v34, v38
    v_add_f32 v35, v35, v39
    v_cvt_pk_bf16_f32 v40, v32, v33
    v_cvt_pk_bf16_f32 v41, v34, v35
    v_accvgpr_read_b32 v32, a4
    v_accvgpr_read_b32 v33, a5
    ds_read_b64_tr_b16 a[230:231], v9 offset:5120
    v_mfma_f32_32x32x16_bf16 v[112:127], a[108:111], v[128:131], 0
    s_waitcnt lgkmcnt(6)
    v_mfma_f32_32x32x16_bf16 v[64:79], a[112:115], v[132:135], v[64:79]
    ds_read_b64_tr_b16 a[96:97], v17 offset:12288
    ds_read_b64_tr_b16 a[98:99], v17 offset:12800
    ds_read_b64_tr_b16 a[100:101], v19 offset:12288
    v_accvgpr_read_b32 v34, a6
    v_accvgpr_read_b32 v35, a7
    v_mul_f32 v36, s41, v32
    v_mul_f32 v37, s41, v33
    v_mul_f32 v38, s41, v34
    v_mul_f32 v39, s41, v35
    v_exp_f32 v36, v36 clamp
    v_exp_f32 v37, v37 clamp
    s_waitcnt vmcnt(16)
    ds_read_b64_tr_b16 a[232:233], v8 offset:6144
    ds_read_b64_tr_b16 a[234:235], v8 offset:7168
    s_add_u32 m0, s68, 2048
    s_mov_b32 s59, 0x4000
    s_cmp_eq_u32 s101, 12
    s_cselect_b32 s59, 0xfff94000, s59
    v_add_u32 v3, s59, v3
    buffer_load_dwordx4 v3, s[24:27], s63 offen lds
    buffer_load_dwordx4 v3, s[24:27], s64 offen offset:1024 lds
    v_mfma_f32_32x32x16_bf16 v[80:95], a[116:119], v[132:135], v[80:95]
    ds_read_b64_tr_b16 a[102:103], v19 offset:12800
    ds_read_b64_tr_b16 a[104:105], v21 offset:12288
    ds_read_b64_tr_b16 a[106:107], v21 offset:12800
    v_exp_f32 v38, v38 clamp
    v_exp_f32 v39, v39 clamp
    v_max_f32 v32, s42, v32
    v_max_f32 v33, s42, v33
    v_max_f32 v34, s42, v34
    v_max_f32 v35, s42, v35
    v_add_f32 v32, v32, v36
    v_add_f32 v33, v33, v37
    ds_read_b64_tr_b16 a[236:237], v9 offset:6144
    s_waitcnt lgkmcnt(10)
    v_mfma_f32_32x32x16_bf16 v[96:111], a[120:123], v[132:135], v[96:111]
    ds_read_b64_tr_b16 a[108:109], v23 offset:12288
    ds_read_b64_tr_b16 a[110:111], v23 offset:12800
    v_add_f32 v34, v34, v38
    v_add_f32 v35, v35, v39
    v_cvt_pk_bf16_f32 v42, v32, v33
    v_cvt_pk_bf16_f32 v43, v34, v35
    v_accvgpr_read_b32 v32, a8
    v_accvgpr_read_b32 v33, a9
    v_accvgpr_read_b32 v34, a10
    v_accvgpr_read_b32 v35, a11
    ds_read_b64_tr_b16 a[238:239], v9 offset:7168
    v_mfma_f32_32x32x16_bf16 v[112:127], a[124:127], v[132:135], v[112:127]
    s_waitcnt lgkmcnt(6)
    v_mfma_f32_32x32x16_bf16 v[64:79], a[96:99], v[136:139], v[64:79]
    ds_read_b64_tr_b16 a[112:113], v17 offset:45056
    ds_read_b64_tr_b16 a[114:115], v17 offset:45568
    ds_read_b64_tr_b16 a[116:117], v19 offset:45056
    v_mul_f32 v36, s41, v32
    v_mul_f32 v37, s41, v33
    v_mul_f32 v38, s41, v34
    v_mul_f32 v39, s41, v35
    v_exp_f32 v36, v36 clamp
    v_exp_f32 v37, v37 clamp
    v_exp_f32 v38, v38 clamp
    v_exp_f32 v39, v39 clamp
    v_mfma_f32_32x32x16_bf16 v[80:95], a[100:103], v[136:139], v[80:95]
    ds_read_b64_tr_b16 a[118:119], v19 offset:45568
    ds_read_b64_tr_b16 a[120:121], v21 offset:45056
    v_max_f32 v32, s42, v32
    v_max_f32 v33, s42, v33
    v_max_f32 v34, s42, v34
    v_max_f32 v35, s42, v35
    v_add_f32 v32, v32, v36
    v_add_f32 v33, v33, v37
    v_add_f32 v34, v34, v38
    v_add_f32 v35, v35, v39
    s_waitcnt lgkmcnt(6)
    v_mfma_f32_32x32x16_bf16 v[96:111], a[104:107], v[136:139], v[96:111]
    s_waitcnt vmcnt(14)
    s_barrier
    ds_read_b64_tr_b16 a[122:123], v21 offset:45568
    ds_read_b64_tr_b16 a[124:125], v23 offset:45056
    ds_read_b64_tr_b16 a[126:127], v23 offset:45568
    v_cvt_pk_bf16_f32 v44, v32, v33
    v_cvt_pk_bf16_f32 v45, v34, v35
    v_accvgpr_read_b32 v32, a12
    v_accvgpr_read_b32 v33, a13
    v_accvgpr_read_b32 v34, a14
    v_accvgpr_read_b32 v35, a15
    v_mul_f32 v36, s41, v32
    v_mul_f32 v37, s41, v33
    s_add_u32 m0, s68, 4096
    v_add_u32 v3, 0x4000, v3
    buffer_load_dwordx4 v3, s[24:27], s63 offen lds
    buffer_load_dwordx4 v3, s[24:27], s64 offen offset:1024 lds
    v_mfma_f32_32x32x16_bf16 v[112:127], a[108:111], v[136:139], v[112:127]
    s_waitcnt lgkmcnt(4)
    v_mfma_f32_32x32x16_bf16 v[64:79], a[112:115], v[140:143], v[64:79]
    ds_read_b64_tr_b16 a[96:97], v16 offset:18432
    ds_read_b64_tr_b16 a[98:99], v16 offset:18944
    ds_read_b64_tr_b16 a[100:101], v18 offset:18432
    v_mul_f32 v38, s41, v34
    v_mul_f32 v39, s41, v35
    v_exp_f32 v36, v36 clamp
    v_exp_f32 v37, v37 clamp
    v_exp_f32 v38, v38 clamp
    v_exp_f32 v39, v39 clamp
    v_max_f32 v32, s42, v32
    v_max_f32 v33, s42, v33
    s_add_u32 m0, s40, 6144
    s_cmp_eq_u32 s69, 4
    s_cselect_b32 s92, s91, s90
    buffer_load_dwordx4 v5, s[12:15], s50 offen lds
    buffer_load_dwordx4 v5, s[12:15], s51 offen offset:1024 lds
    v_add_u32 v5, s92, v5
    v_mfma_f32_32x32x16_bf16 v[80:95], a[116:119], v[140:143], v[80:95]
    ds_read_b64_tr_b16 a[102:103], v18 offset:18944
    ds_read_b64_tr_b16 a[104:105], v20 offset:18432
    ds_read_b64_tr_b16 a[106:107], v20 offset:18944
    v_max_f32 v34, s42, v34
    v_max_f32 v35, s42, v35
    v_add_f32 v32, v32, v36
    v_add_f32 v33, v33, v37
    v_add_f32 v34, v34, v38
    v_add_f32 v35, v35, v39
    v_cvt_pk_bf16_f32 v46, v32, v33
    v_cvt_pk_bf16_f32 v47, v34, v35
    s_waitcnt lgkmcnt(6)
    v_mfma_f32_32x32x16_bf16 v[96:111], a[120:123], v[140:143], v[96:111]
    ds_read_b64_tr_b16 a[108:109], v22 offset:18432
    ds_read_b64_tr_b16 a[110:111], v22 offset:18944
    v_accvgpr_read_b32 v32, a32
    v_accvgpr_read_b32 v33, a33
    v_accvgpr_read_b32 v34, a34
    v_accvgpr_read_b32 v35, a35
    v_cvt_pk_bf16_f32 v48, v32, v33
    v_cvt_pk_bf16_f32 v49, v34, v35
    v_accvgpr_read_b32 v32, a36
    v_accvgpr_read_b32 v33, a37
    v_mfma_f32_32x32x16_bf16 v[112:127], a[124:127], v[140:143], v[112:127]
    s_waitcnt lgkmcnt(4)
    v_mfma_f32_32x32x16_bf16 v[64:79], a[96:99], v[144:147], v[64:79]
    ds_read_b64_tr_b16 a[112:113], v16 offset:51200
    ds_read_b64_tr_b16 a[114:115], v16 offset:51712
    ds_read_b64_tr_b16 a[116:117], v18 offset:51200
    v_accvgpr_read_b32 v34, a38
    v_accvgpr_read_b32 v35, a39
    v_cvt_pk_bf16_f32 v50, v32, v33
    v_cvt_pk_bf16_f32 v51, v34, v35
    v_accvgpr_read_b32 v32, a40
    v_accvgpr_read_b32 v33, a41
    v_accvgpr_read_b32 v34, a42
    v_accvgpr_read_b32 v35, a43
    s_add_u32 m0, s40, 8192
    s_nop 0
    buffer_load_dwordx4 v6, s[16:19], s50 offen lds
    buffer_load_dwordx4 v6, s[16:19], s51 offen offset:1024 lds
    v_add_u32 v6, s92, v6
    v_mfma_f32_32x32x16_bf16 v[80:95], a[100:103], v[144:147], v[80:95]
    ds_read_b64_tr_b16 a[118:119], v18 offset:51712
    ds_read_b64_tr_b16 a[120:121], v20 offset:51200
    ds_read_b64_tr_b16 a[122:123], v20 offset:51712
    v_cvt_pk_bf16_f32 v52, v32, v33
    v_cvt_pk_bf16_f32 v53, v34, v35
    v_accvgpr_read_b32 v32, a44
    v_accvgpr_read_b32 v33, a45
    v_accvgpr_read_b32 v34, a46
    v_accvgpr_read_b32 v35, a47
    v_cvt_pk_bf16_f32 v54, v32, v33
    v_cvt_pk_bf16_f32 v55, v34, v35
    s_waitcnt lgkmcnt(6)
    v_mfma_f32_32x32x16_bf16 v[96:111], a[104:107], v[144:147], v[96:111]
    ds_read_b64_tr_b16 a[124:125], v22 offset:51200
    ds_read_b64_tr_b16 a[126:127], v22 offset:51712
    s_mov_b32 vcc_lo, 0xffff
    s_mov_b32 vcc_hi, 0xffff
    v_cndmask_b32 v56, v31, v48, vcc
    v_cndmask_b32 v57, v31, v49, vcc
    v_cndmask_b32 v58, v31, v50, vcc
    v_cndmask_b32 v59, v31, v51, vcc
    v_cndmask_b32 v60, v31, v52, vcc
    v_cndmask_b32 v61, v31, v53, vcc
    v_mfma_f32_32x32x16_bf16 v[112:127], a[108:111], v[144:147], v[112:127]
    s_waitcnt lgkmcnt(4)
    v_mfma_f32_32x32x16_bf16 v[64:79], a[112:115], v[148:151], v[64:79]
    ds_read_b64_tr_b16 a[96:97], v17 offset:18432
    ds_read_b64_tr_b16 a[98:99], v17 offset:18944
    ds_read_b64_tr_b16 a[100:101], v19 offset:18432
    v_cndmask_b32 v62, v31, v54, vcc
    v_cndmask_b32 v63, v31, v55, vcc
    s_nop 1
    v_mfma_f32_32x32x16_bf16 a[0:15], v[40:43], v[56:59], 0
    v_mfma_f32_32x32x16_bf16 a[0:15], v[44:47], v[60:63], a[0:15]
    s_mov_b32 vcc_lo, 0xffff0000
    s_mov_b32 vcc_hi, 0xffff0000
    v_cndmask_b32 v56, v31, v48, vcc
    s_waitcnt vmcnt(18)
    ds_read_b64_tr_b16 a[240:241], v10 offset:30720
    ds_read_b64_tr_b16 a[242:243], v10 offset:31744
    s_add_u32 m0, s68, 6144
    v_add_u32 v3, 0x4000, v3
    buffer_load_dwordx4 v3, s[24:27], s63 offen lds
    buffer_load_dwordx4 v3, s[24:27], s64 offen offset:1024 lds
    v_mfma_f32_32x32x16_bf16 v[80:95], a[116:119], v[148:151], v[80:95]
    ds_read_b64_tr_b16 a[102:103], v19 offset:18944
    ds_read_b64_tr_b16 a[104:105], v21 offset:18432
    ds_read_b64_tr_b16 a[106:107], v21 offset:18944
    v_cndmask_b32 v57, v31, v49, vcc
    v_cndmask_b32 v58, v31, v50, vcc
    v_cndmask_b32 v59, v31, v51, vcc
    v_cndmask_b32 v60, v31, v52, vcc
    v_cndmask_b32 v61, v31, v53, vcc
    v_cndmask_b32 v62, v31, v54, vcc
    v_cndmask_b32 v63, v31, v55, vcc
    s_nop 1
    ds_read_b64_tr_b16 a[244:245], v11 offset:30720
    s_waitcnt lgkmcnt(9)
    v_mfma_f32_32x32x16_bf16 v[96:111], a[120:123], v[148:151], v[96:111]
    ds_read_b64_tr_b16 a[108:109], v23 offset:18432
    ds_read_b64_tr_b16 a[110:111], v23 offset:18944
    v_mfma_f32_32x32x16_bf16 a[32:47], v[40:43], v[56:59], 0
    v_mfma_f32_32x32x16_bf16 a[32:47], v[44:47], v[60:63], a[32:47]
    v_accvgpr_read_b32 v32, a16
    v_accvgpr_read_b32 v33, a17
    v_accvgpr_read_b32 v34, a18
    v_accvgpr_read_b32 v35, a19
    v_mul_f32 v36, s41, v32
    v_mul_f32 v37, s41, v33
    ds_read_b64_tr_b16 a[246:247], v11 offset:31744
    v_mfma_f32_32x32x16_bf16 v[112:127], a[124:127], v[148:151], v[112:127]
    s_waitcnt lgkmcnt(6)
    v_mfma_f32_32x32x16_bf16 v[64:79], a[96:99], v[152:155], v[64:79]
    ds_read_b64_tr_b16 a[112:113], v17 offset:51200
    ds_read_b64_tr_b16 a[114:115], v17 offset:51712
    ds_read_b64_tr_b16 a[116:117], v19 offset:51200
    v_mul_f32 v38, s41, v34
    v_mul_f32 v39, s41, v35
    v_exp_f32 v36, v36 clamp
    v_exp_f32 v37, v37 clamp
    v_exp_f32 v38, v38 clamp
    v_exp_f32 v39, v39 clamp
    v_max_f32 v32, s42, v32
    v_max_f32 v33, s42, v33
    v_mfma_f32_32x32x16_bf16 v[80:95], a[100:103], v[152:155], v[80:95]
    ds_read_b64_tr_b16 a[118:119], v19 offset:51712
    ds_read_b64_tr_b16 a[120:121], v21 offset:51200
    v_max_f32 v34, s42, v34
    v_max_f32 v35, s42, v35
    v_add_f32 v32, v32, v36
    v_add_f32 v33, v33, v37
    v_add_f32 v34, v34, v38
    v_add_f32 v35, v35, v39
    v_cvt_pk_bf16_f32 v40, v32, v33
    v_cvt_pk_bf16_f32 v41, v34, v35
    s_waitcnt lgkmcnt(6)
    v_mfma_f32_32x32x16_bf16 v[96:111], a[104:107], v[152:155], v[96:111]
    s_waitcnt vmcnt(16)
    s_barrier
    ds_read_b64_tr_b16 a[122:123], v21 offset:51712
    ds_read_b64_tr_b16 a[124:125], v23 offset:51200
    ds_read_b64_tr_b16 a[126:127], v23 offset:51712
    v_accvgpr_read_b32 v32, a20
    v_accvgpr_read_b32 v33, a21
    v_accvgpr_read_b32 v34, a22
    v_accvgpr_read_b32 v35, a23
    v_mul_f32 v36, s41, v32
    v_mul_f32 v37, s41, v33
    v_mul_f32 v38, s41, v34
    v_mul_f32 v39, s41, v35
    s_waitcnt lgkmcnt(8)
    s_add_u32 m0, s40, 30720
    v_add_u32 v3, 0x4000, v3
    buffer_load_dwordx4 v3, s[24:27], s63 offen lds
    buffer_load_dwordx4 v3, s[24:27], s64 offen offset:1024 lds
    v_mfma_f32_32x32x16_bf16 v[112:127], a[108:111], v[152:155], v[112:127]
    s_waitcnt lgkmcnt(4)
    v_mfma_f32_32x32x16_bf16 v[64:79], a[112:115], v[156:159], v[64:79]
    ds_read_b64_tr_b16 a[96:97], v16 offset:24576
    ds_read_b64_tr_b16 a[98:99], v16 offset:25088
    ds_read_b64_tr_b16 a[100:101], v18 offset:24576
    v_exp_f32 v36, v36 clamp
    v_exp_f32 v37, v37 clamp
    v_exp_f32 v38, v38 clamp
    v_exp_f32 v39, v39 clamp
    v_max_f32 v32, s42, v32
    v_max_f32 v33, s42, v33
    v_max_f32 v34, s42, v34
    v_max_f32 v35, s42, v35
    s_add_u32 m0, s40, 12288
    s_cmp_eq_u32 s69, 5
    s_cselect_b32 s92, s91, s90
    buffer_load_dwordx4 v5, s[12:15], s50 offen lds
    buffer_load_dwordx4 v5, s[12:15], s51 offen offset:1024 lds
    v_add_u32 v5, s92, v5
    v_mfma_f32_32x32x16_bf16 v[80:95], a[116:119], v[156:159], v[80:95]
    ds_read_b64_tr_b16 a[102:103], v18 offset:25088
    ds_read_b64_tr_b16 a[104:105], v20 offset:24576
    ds_read_b64_tr_b16 a[106:107], v20 offset:25088
    v_add_f32 v32, v32, v36
    v_add_f32 v33, v33, v37
    v_add_f32 v34, v34, v38
    v_add_f32 v35, v35, v39
    v_cvt_pk_bf16_f32 v42, v32, v33
    v_cvt_pk_bf16_f32 v43, v34, v35
    v_accvgpr_read_b32 v32, a24
    v_accvgpr_read_b32 v33, a25
    s_waitcnt lgkmcnt(6)
    v_mfma_f32_32x32x16_bf16 v[96:111], a[120:123], v[156:159], v[96:111]
    ds_read_b64_tr_b16 a[108:109], v22 offset:24576
    ds_read_b64_tr_b16 a[110:111], v22 offset:25088
    v_accvgpr_read_b32 v34, a26
    v_accvgpr_read_b32 v35, a27
    v_mul_f32 v36, s41, v32
    v_mul_f32 v37, s41, v33
    v_mul_f32 v38, s41, v34
    v_mul_f32 v39, s41, v35
    v_exp_f32 v36, v36 clamp
    v_exp_f32 v37, v37 clamp
    v_mfma_f32_32x32x16_bf16 v[112:127], a[124:127], v[156:159], v[112:127]
    s_waitcnt lgkmcnt(4)
    v_mfma_f32_32x32x16_bf16 v[64:79], a[96:99], v[160:163], v[64:79]
    ds_read_b64_tr_b16 a[112:113], v16 offset:57344
    ds_read_b64_tr_b16 a[114:115], v16 offset:57856
    ds_read_b64_tr_b16 a[116:117], v18 offset:57344
    v_exp_f32 v38, v38 clamp
    v_exp_f32 v39, v39 clamp
    v_max_f32 v32, s42, v32
    v_max_f32 v33, s42, v33
    v_max_f32 v34, s42, v34
    v_max_f32 v35, s42, v35
    v_add_f32 v32, v32, v36
    v_add_f32 v33, v33, v37
    s_add_u32 m0, s40, 14336
    s_nop 0
    buffer_load_dwordx4 v6, s[16:19], s50 offen lds
    buffer_load_dwordx4 v6, s[16:19], s51 offen offset:1024 lds
    v_add_u32 v6, s92, v6
    v_mfma_f32_32x32x16_bf16 v[80:95], a[100:103], v[160:163], v[80:95]
    ds_read_b64_tr_b16 a[118:119], v18 offset:57856
    ds_read_b64_tr_b16 a[120:121], v20 offset:57344
    ds_read_b64_tr_b16 a[122:123], v20 offset:57856
    v_add_f32 v34, v34, v38
    v_add_f32 v35, v35, v39
    v_cvt_pk_bf16_f32 v44, v32, v33
    v_cvt_pk_bf16_f32 v45, v34, v35
    v_accvgpr_read_b32 v32, a28
    v_accvgpr_read_b32 v33, a29
    v_accvgpr_read_b32 v34, a30
    v_accvgpr_read_b32 v35, a31
    s_waitcnt lgkmcnt(6)
    v_mfma_f32_32x32x16_bf16 v[96:111], a[104:107], v[160:163], v[96:111]
    ds_read_b64_tr_b16 a[124:125], v22 offset:57344
    ds_read_b64_tr_b16 a[126:127], v22 offset:57856
    v_mul_f32 v36, s41, v32
    v_mul_f32 v37, s41, v33
    v_mul_f32 v38, s41, v34
    v_mul_f32 v39, s41, v35
    v_exp_f32 v36, v36 clamp
    v_exp_f32 v37, v37 clamp
    v_exp_f32 v38, v38 clamp
    v_exp_f32 v39, v39 clamp
    v_mfma_f32_32x32x16_bf16 v[112:127], a[108:111], v[160:163], v[112:127]
    s_waitcnt lgkmcnt(4)
    v_mfma_f32_32x32x16_bf16 v[64:79], a[112:115], v[164:167], v[64:79]
    ds_read_b64_tr_b16 a[96:97], v17 offset:24576
    ds_read_b64_tr_b16 a[98:99], v17 offset:25088
    ds_read_b64_tr_b16 a[100:101], v19 offset:24576
    v_max_f32 v32, s42, v32
    v_max_f32 v33, s42, v33
    v_max_f32 v34, s42, v34
    v_max_f32 v35, s42, v35
    v_add_f32 v32, v32, v36
    v_add_f32 v33, v33, v37
    v_add_f32 v34, v34, v38
    v_add_f32 v35, v35, v39
    v_mfma_f32_32x32x16_bf16 v[80:95], a[116:119], v[164:167], v[80:95]
    ds_read_b64_tr_b16 a[102:103], v19 offset:25088
    ds_read_b64_tr_b16 a[104:105], v21 offset:24576
    ds_read_b64_tr_b16 a[106:107], v21 offset:25088
    v_cvt_pk_bf16_f32 v46, v32, v33
    v_cvt_pk_bf16_f32 v47, v34, v35
    v_accvgpr_read_b32 v32, a48
    v_accvgpr_read_b32 v33, a49
    v_accvgpr_read_b32 v34, a50
    v_accvgpr_read_b32 v35, a51
    v_cvt_pk_bf16_f32 v48, v32, v33
    v_cvt_pk_bf16_f32 v49, v34, v35
    s_waitcnt lgkmcnt(6)
    v_mfma_f32_32x32x16_bf16 v[96:111], a[120:123], v[164:167], v[96:111]
    ds_read_b64_tr_b16 a[108:109], v23 offset:24576
    ds_read_b64_tr_b16 a[110:111], v23 offset:25088
    v_accvgpr_read_b32 v32, a52
    v_accvgpr_read_b32 v33, a53
    v_accvgpr_read_b32 v34, a54
    v_accvgpr_read_b32 v35, a55
    v_cvt_pk_bf16_f32 v50, v32, v33
    v_cvt_pk_bf16_f32 v51, v34, v35
    v_accvgpr_read_b32 v32, a56
    v_accvgpr_read_b32 v33, a57
    v_mfma_f32_32x32x16_bf16 v[112:127], a[124:127], v[164:167], v[112:127]
    s_waitcnt lgkmcnt(4)
    v_mfma_f32_32x32x16_bf16 v[64:79], a[96:99], v[168:171], v[64:79]
    ds_read_b64_tr_b16 a[112:113], v17 offset:57344
    ds_read_b64_tr_b16 a[114:115], v17 offset:57856
    ds_read_b64_tr_b16 a[116:117], v19 offset:57344
    v_accvgpr_read_b32 v34, a58
    v_accvgpr_read_b32 v35, a59
    v_cvt_pk_bf16_f32 v52, v32, v33
    v_cvt_pk_bf16_f32 v53, v34, v35
    v_accvgpr_read_b32 v32, a60
    v_accvgpr_read_b32 v33, a61
    v_accvgpr_read_b32 v34, a62
    v_accvgpr_read_b32 v35, a63
    v_mfma_f32_32x32x16_bf16 v[80:95], a[100:103], v[168:171], v[80:95]
    ds_read_b64_tr_b16 a[118:119], v19 offset:57856
    ds_read_b64_tr_b16 a[120:121], v21 offset:57344
    v_cvt_pk_bf16_f32 v54, v32, v33
    v_cvt_pk_bf16_f32 v55, v34, v35
    s_mov_b32 vcc_lo, 0xffff
    s_mov_b32 vcc_hi, 0xffff
    v_cndmask_b32 v56, v31, v48, vcc
    v_cndmask_b32 v57, v31, v49, vcc
    v_cndmask_b32 v58, v31, v50, vcc
    s_waitcnt lgkmcnt(5)
    v_mfma_f32_32x32x16_bf16 v[96:111], a[104:107], v[168:171], v[96:111]
    s_waitcnt vmcnt(16)
    s_barrier
    ds_read_b64_tr_b16 a[122:123], v21 offset:57856
    ds_read_b64_tr_b16 a[124:125], v23 offset:57344
    ds_read_b64_tr_b16 a[126:127], v23 offset:57856
    v_cndmask_b32 v59, v31, v51, vcc
    v_cndmask_b32 v60, v31, v52, vcc
    v_cndmask_b32 v61, v31, v53, vcc
    v_cndmask_b32 v62, v31, v54, vcc
    v_cndmask_b32 v63, v31, v55, vcc
    s_nop 1
    v_mfma_f32_32x32x16_bf16 a[16:31], v[40:43], v[56:59], 0
    v_mfma_f32_32x32x16_bf16 a[16:31], v[44:47], v[60:63], a[16:31]
    v_mfma_f32_32x32x16_bf16 v[112:127], a[108:111], v[168:171], v[112:127]
    s_waitcnt lgkmcnt(4)
    v_mfma_f32_32x32x16_bf16 v[64:79], a[112:115], v[172:175], v[64:79]
    ds_read_b64_tr_b16 a[96:97], v16 offset:0
    ds_read_b64_tr_b16 a[98:99], v16 offset:512
    ds_read_b64_tr_b16 a[100:101], v18 offset:0
    s_mov_b32 vcc_lo, 0xffff0000
    s_mov_b32 vcc_hi, 0xffff0000
    v_cndmask_b32 v56, v31, v48, vcc
    v_cndmask_b32 v57, v31, v49, vcc
    v_cndmask_b32 v58, v31, v50, vcc
    v_cndmask_b32 v59, v31, v51, vcc
    v_cndmask_b32 v60, v31, v52, vcc
    v_cndmask_b32 v61, v31, v53, vcc
    s_add_u32 m0, s40, 18432
    s_cmp_eq_u32 s69, 6
    s_cselect_b32 s92, s91, s90
    buffer_load_dwordx4 v5, s[12:15], s50 offen lds
    buffer_load_dwordx4 v5, s[12:15], s51 offen offset:1024 lds
    v_add_u32 v5, s92, v5
    v_mfma_f32_32x32x16_bf16 v[80:95], a[116:119], v[172:175], v[80:95]
    ds_read_b64_tr_b16 a[102:103], v18 offset:512
    ds_read_b64_tr_b16 a[104:105], v20 offset:0
    ds_read_b64_tr_b16 a[106:107], v20 offset:512
    v_cndmask_b32 v62, v31, v54, vcc
    v_cndmask_b32 v63, v31, v55, vcc
    s_nop 1
    v_mfma_f32_32x32x16_bf16 a[48:63], v[40:43], v[56:59], 0
    v_mfma_f32_32x32x16_bf16 a[48:63], v[44:47], v[60:63], a[48:63]
    v_accvgpr_read_b32 v32, a64
    v_accvgpr_read_b32 v33, a65
    v_accvgpr_read_b32 v34, a66
    s_waitcnt lgkmcnt(6)
    v_mfma_f32_32x32x16_bf16 v[96:111], a[120:123], v[172:175], v[96:111]
    ds_read_b64_tr_b16 a[108:109], v22 offset:0
    ds_read_b64_tr_b16 a[110:111], v22 offset:512
    v_accvgpr_read_b32 v35, a67
    v_mul_f32 v36, s41, v32
    v_mul_f32 v37, s41, v33
    v_mul_f32 v38, s41, v34
    v_mul_f32 v39, s41, v35
    v_exp_f32 v36, v36 clamp
    v_exp_f32 v37, v37 clamp
    v_mfma_f32_32x32x16_bf16 v[112:127], a[124:127], v[172:175], v[112:127]
    s_waitcnt lgkmcnt(4)
    v_mfma_f32_32x32x16_bf16 v[64:79], a[96:99], v[176:179], v[64:79]
    ds_read_b64_tr_b16 a[112:113], v16 offset:32768
    ds_read_b64_tr_b16 a[114:115], v16 offset:33280
    ds_read_b64_tr_b16 a[116:117], v18 offset:32768
    v_exp_f32 v38, v38 clamp
    v_exp_f32 v39, v39 clamp
    v_max_f32 v32, s42, v32
    v_max_f32 v33, s42, v33
    v_max_f32 v34, s42, v34
    v_max_f32 v35, s42, v35
    v_add_f32 v32, v32, v36
    v_add_f32 v33, v33, v37
    ds_read_b64_tr_b16 a[248:249], v8 offset:0
    ds_read_b64_tr_b16 a[250:251], v8 offset:1024
    s_add_u32 m0, s40, 20480
    s_nop 0
    buffer_load_dwordx4 v6, s[16:19], s50 offen lds
    buffer_load_dwordx4 v6, s[16:19], s51 offen offset:1024 lds
    v_add_u32 v6, s92, v6
    v_mfma_f32_32x32x16_bf16 v[80:95], a[100:103], v[176:179], v[80:95]
    ds_read_b64_tr_b16 a[118:119], v18 offset:33280
    ds_read_b64_tr_b16 a[120:121], v20 offset:32768
    ds_read_b64_tr_b16 a[122:123], v20 offset:33280
    v_add_f32 v34, v34, v38
    v_add_f32 v35, v35, v39
    v_cvt_pk_bf16_f32 v40, v32, v33
    v_cvt_pk_bf16_f32 v41, v34, v35
    v_accvgpr_read_b32 v32, a68
    v_accvgpr_read_b32 v33, a69
    v_accvgpr_read_b32 v34, a70
    v_accvgpr_read_b32 v35, a71
    ds_read_b64_tr_b16 a[252:253], v9 offset:0
    s_waitcnt lgkmcnt(9)
    v_mfma_f32_32x32x16_bf16 v[96:111], a[104:107], v[176:179], v[96:111]
    ds_read_b64_tr_b16 a[124:125], v22 offset:32768
    ds_read_b64_tr_b16 a[126:127], v22 offset:33280
    v_mul_f32 v36, s41, v32
    v_mul_f32 v37, s41, v33
    v_mul_f32 v38, s41, v34
    v_mul_f32 v39, s41, v35
    v_exp_f32 v36, v36 clamp
    v_exp_f32 v37, v37 clamp
    v_exp_f32 v38, v38 clamp
    ds_read_b64_tr_b16 a[254:255], v9 offset:1024
    v_mfma_f32_32x32x16_bf16 v[112:127], a[108:111], v[176:179], v[112:127]
    s_waitcnt lgkmcnt(6)
    v_mfma_f32_32x32x16_bf16 v[64:79], a[112:115], v[180:183], v[64:79]
    ds_read_b64_tr_b16 a[96:97], v17 offset:0
    ds_read_b64_tr_b16 a[98:99], v17 offset:512
    ds_read_b64_tr_b16 a[100:101], v19 offset:0
    v_exp_f32 v39, v39 clamp
    v_max_f32 v32, s42, v32
    v_max_f32 v33, s42, v33
    v_max_f32 v34, s42, v34
    v_max_f32 v35, s42, v35
    v_add_f32 v32, v32, v36
    v_add_f32 v33, v33, v37
    v_add_f32 v34, v34, v38
    s_waitcnt lgkmcnt(3)
    s_add_u32 m0, s68, 0
    s_mov_b32 s59, 0x4000
    s_cmp_eq_u32 s101, 16
    s_cselect_b32 s59, 0xfff94000, s59
    v_add_u32 v3, s59, v3
    buffer_load_dwordx4 v3, s[24:27], s63 offen lds
    buffer_load_dwordx4 v3, s[24:27], s64 offen offset:1024 lds
    v_mfma_f32_32x32x16_bf16 v[80:95], a[116:119], v[180:183], v[80:95]
    ds_read_b64_tr_b16 a[102:103], v19 offset:512
    ds_read_b64_tr_b16 a[104:105], v21 offset:0
    ds_read_b64_tr_b16 a[106:107], v21 offset:512
    v_add_f32 v35, v35, v39
    v_cvt_pk_bf16_f32 v42, v32, v33
    v_cvt_pk_bf16_f32 v43, v34, v35
    buffer_store_dwordx4 v[40:43], v2, s[20:23], s55 offen sc1
    v_add_u32 v30, s40, v2
    ds_write_b128 v30, a[0:3] offset:4096
    ds_write_b128 v30, a[4:7] offset:5120
    v_mfma_f32_32x32x16_bf16 v[96:111], a[120:123], v[180:183], v[96:111]
    ds_read_b64_tr_b16 a[108:109], v23 offset:0
    ds_read_b64_tr_b16 a[110:111], v23 offset:512
    ds_write_b128 v30, a[40:43] offset:10240
    ds_write_b128 v30, a[44:47] offset:11264
    ds_write_b128 v30, a[16:19] offset:16384
    ds_write_b128 v30, a[20:23] offset:17408
    ds_write_b128 v30, a[56:59] offset:22528
    ds_write_b128 v30, a[60:63] offset:23552
    v_mfma_f32_32x32x16_bf16 v[112:127], a[124:127], v[180:183], v[112:127]
    s_waitcnt lgkmcnt(12)
    v_mfma_f32_32x32x16_bf16 v[64:79], a[96:99], v[184:187], v[64:79]
    ds_read_b64_tr_b16 a[112:113], v17 offset:32768
    ds_read_b64_tr_b16 a[114:115], v17 offset:33280
    ds_read_b64_tr_b16 a[116:117], v19 offset:32768
    s_waitcnt vmcnt(21)
    ds_read_b64_tr_b16 a[144:145], v8 offset:2048
    v_mfma_f32_32x32x16_bf16 v[80:95], a[100:103], v[184:187], v[80:95]
    ds_read_b64_tr_b16 a[118:119], v19 offset:33280
    ds_read_b64_tr_b16 a[120:121], v21 offset:32768
    ds_read_b64_tr_b16 a[146:147], v8 offset:3072
    s_waitcnt lgkmcnt(13)
    v_mfma_f32_32x32x16_bf16 v[96:111], a[104:107], v[184:187], v[96:111]
    s_waitcnt vmcnt(15) lgkmcnt(7)
    s_barrier
    ds_read_b64_tr_b16 a[122:123], v21 offset:33280
    ds_read_b64_tr_b16 a[124:125], v23 offset:32768
    ds_read_b64_tr_b16 a[126:127], v23 offset:33280
    ds_read_b64_tr_b16 a[148:149], v9 offset:2048
    ds_read_b64_tr_b16 a[150:151], v9 offset:3072
    v_mfma_f32_32x32x16_bf16 v[112:127], a[108:111], v[184:187], v[112:127]
    s_waitcnt lgkmcnt(7)
    v_mfma_f32_32x32x16_bf16 v[64:79], a[112:115], v[188:191], v[64:79]
    ds_read_b64_tr_b16 a[96:97], v16 offset:6144
    ds_read_b64_tr_b16 a[98:99], v16 offset:6656
    ds_read_b64_tr_b16 a[100:101], v18 offset:6144
    s_mul_i32 s57, s36, 6144
    s_add_u32 s57, s57, 4096
    v_add_u32 v30, s57, v2
    v_add_u32 v29, 0x10000, v30
    ds_read_b64_tr_b16 a[152:153], v8 offset:4096
    ds_read_b64_tr_b16 a[154:155], v8 offset:5120
    s_add_u32 m0, s40, 24576
    s_cmp_eq_u32 s69, 7
    s_cselect_b32 s92, s91, s90
    buffer_load_dwordx4 v5, s[12:15], s50 offen lds
    buffer_load_dwordx4 v5, s[12:15], s51 offen offset:1024 lds
    v_mfma_f32_32x32x16_bf16 v[80:95], a[116:119], v[188:191], v[80:95]
    ds_read_b64_tr_b16 a[102:103], v18 offset:6656
    ds_read_b64_tr_b16 a[104:105], v20 offset:6144
    ds_read_b64_tr_b16 a[106:107], v20 offset:6656
    ds_read_b128 v[32:35], v30 offset:0
    ds_read_b128 v[36:39], v30 offset:1024
    ds_read_b128 v[40:43], v30 offset:32768
    ds_read_b128 v[44:47], v30 offset:33792
    ds_read_b64_tr_b16 a[156:157], v9 offset:4096
    s_waitcnt lgkmcnt(15)
    v_mfma_f32_32x32x16_bf16 v[96:111], a[120:123], v[188:191], v[96:111]
    ds_read_b64_tr_b16 a[108:109], v22 offset:6144
    ds_read_b64_tr_b16 a[110:111], v22 offset:6656
    ds_read_b128 v[48:51], v29 offset:0
    ds_read_b128 v[52:55], v29 offset:1024
    ds_read_b128 v[56:59], v29 offset:32768
    ds_read_b128 v[60:63], v29 offset:33792
    ds_read_b64_tr_b16 a[158:159], v9 offset:5120
    v_mfma_f32_32x32x16_bf16 v[112:127], a[124:127], v[188:191], v[112:127]
    s_waitcnt lgkmcnt(14)
    v_mfma_f32_32x32x16_bf16 v[64:79], a[96:99], v[192:195], v[64:79]
    ds_read_b64_tr_b16 a[112:113], v16 offset:38912
    ds_read_b64_tr_b16 a[114:115], v16 offset:39424
    ds_read_b64_tr_b16 a[116:117], v18 offset:38912
    s_waitcnt lgkmcnt(4)
    v_add_f32 v32, v32, v40
    v_add_f32 v33, v33, v41
    v_add_f32 v34, v34, v42
    s_add_u32 m0, s40, 26624
    s_nop 0
    buffer_load_dwordx4 v6, s[16:19], s50 offen lds
    buffer_load_dwordx4 v6, s[16:19], s51 offen offset:1024 lds
    v_mfma_f32_32x32x16_bf16 v[80:95], a[100:103], v[192:195], v[80:95]
    ds_read_b64_tr_b16 a[118:119], v18 offset:39424
    ds_read_b64_tr_b16 a[120:121], v20 offset:38912
    ds_read_b64_tr_b16 a[122:123], v20 offset:39424
    v_add_f32 v35, v35, v43
    v_add_f32 v36, v36, v44
    v_add_f32 v37, v37, v45
    v_add_f32 v38, v38, v46
    s_add_u32 m0, s68, 2048
    v_add_u32 v3, 0x4000, v3
    buffer_load_dwordx4 v3, s[24:27], s63 offen lds
    buffer_load_dwordx4 v3, s[24:27], s64 offen offset:1024 lds
    v_mfma_f32_32x32x16_bf16 v[96:111], a[104:107], v[192:195], v[96:111]
    ds_read_b64_tr_b16 a[124:125], v22 offset:38912
    ds_read_b64_tr_b16 a[126:127], v22 offset:39424
    v_add_f32 v39, v39, v47
    v_add_f32 v32, v32, v48
    v_add_f32 v33, v33, v49
    v_add_f32 v34, v34, v50
    v_mfma_f32_32x32x16_bf16 v[112:127], a[108:111], v[192:195], v[112:127]
    s_waitcnt lgkmcnt(4)
    v_mfma_f32_32x32x16_bf16 v[64:79], a[112:115], v[196:199], v[64:79]
    ds_read_b64_tr_b16 a[96:97], v17 offset:6144
    ds_read_b64_tr_b16 a[98:99], v17 offset:6656
    ds_read_b64_tr_b16 a[100:101], v19 offset:6144
    v_add_f32 v35, v35, v51
    v_add_f32 v36, v36, v52
    v_add_f32 v37, v37, v53
    v_add_f32 v38, v38, v54
    s_add_u32 m0, s68, 4096
    v_add_u32 v3, 0x4000, v3
    buffer_load_dwordx4 v3, s[24:27], s63 offen lds
    buffer_load_dwordx4 v3, s[24:27], s64 offen offset:1024 lds
    v_mfma_f32_32x32x16_bf16 v[80:95], a[116:119], v[196:199], v[80:95]
    ds_read_b64_tr_b16 a[102:103], v19 offset:6656
    ds_read_b64_tr_b16 a[104:105], v21 offset:6144
    ds_read_b64_tr_b16 a[106:107], v21 offset:6656
    v_add_f32 v39, v39, v55
    v_add_f32 v32, v32, v56
    v_add_f32 v33, v33, v57
    v_add_f32 v34, v34, v58
    s_waitcnt lgkmcnt(6)
    v_mfma_f32_32x32x16_bf16 v[96:111], a[120:123], v[196:199], v[96:111]
    ds_read_b64_tr_b16 a[108:109], v23 offset:6144
    ds_read_b64_tr_b16 a[110:111], v23 offset:6656
    v_add_f32 v35, v35, v59
    v_add_f32 v36, v36, v60
    v_add_f32 v37, v37, v61
    v_mfma_f32_32x32x16_bf16 v[112:127], a[124:127], v[196:199], v[112:127]
    s_waitcnt lgkmcnt(4)
    v_mfma_f32_32x32x16_bf16 v[64:79], a[96:99], v[200:203], v[64:79]
    ds_read_b64_tr_b16 a[112:113], v17 offset:38912
    ds_read_b64_tr_b16 a[114:115], v17 offset:39424
    ds_read_b64_tr_b16 a[116:117], v19 offset:38912
    v_add_f32 v38, v38, v62
    v_add_f32 v39, v39, v63
    buffer_store_dwordx4 v[32:35], v2, s[20:23], s56 offen sc1
    buffer_store_dwordx4 v[36:39], v2, s[20:23], s56 offen offset:1024 sc1
    s_waitcnt vmcnt(23)
    ds_read_b64_tr_b16 a[128:129], v8 offset:6144
    v_mfma_f32_32x32x16_bf16 v[80:95], a[100:103], v[200:203], v[80:95]
    ds_read_b64_tr_b16 a[118:119], v19 offset:39424
    ds_read_b64_tr_b16 a[120:121], v21 offset:38912
    s_nop 1
    v_accvgpr_read_b32 v32, a72
    v_accvgpr_read_b32 v33, a73
    ds_read_b64_tr_b16 a[130:131], v8 offset:7168
    s_waitcnt lgkmcnt(7)
    v_mfma_f32_32x32x16_bf16 v[96:111], a[104:107], v[200:203], v[96:111]
    s_waitcnt vmcnt(17)
    s_barrier
    ds_read_b64_tr_b16 a[122:123], v21 offset:39424
    ds_read_b64_tr_b16 a[124:125], v23 offset:38912
    ds_read_b64_tr_b16 a[126:127], v23 offset:39424
    v_accvgpr_read_b32 v34, a74
    v_accvgpr_read_b32 v35, a75
    v_mul_f32 v36, s41, v32
    v_mul_f32 v37, s41, v33
    ds_read_b64_tr_b16 a[132:133], v9 offset:6144
    ds_read_b64_tr_b16 a[134:135], v9 offset:7168
    v_mfma_f32_32x32x16_bf16 v[112:127], a[108:111], v[200:203], v[112:127]
    s_waitcnt lgkmcnt(7)
    v_mfma_f32_32x32x16_bf16 v[64:79], a[112:115], v[204:207], v[64:79]
    ds_read_b64_tr_b16 a[96:97], v16 offset:12288
    ds_read_b64_tr_b16 a[98:99], v16 offset:12800
    ds_read_b64_tr_b16 a[100:101], v18 offset:12288
    v_mul_f32 v38, s41, v34
    v_mul_f32 v39, s41, v35
    v_exp_f32 v36, v36 clamp
    v_exp_f32 v37, v37 clamp
    ds_read_b64_tr_b16 a[136:137], v10 offset:30720
    ds_read_b64_tr_b16 a[138:139], v10 offset:31744
    s_waitcnt lgkmcnt(5)
    s_add_u32 m0, s68, 6144
    v_add_u32 v3, 0x4000, v3
    buffer_load_dwordx4 v3, s[24:27], s63 offen lds
    buffer_load_dwordx4 v3, s[24:27], s64 offen offset:1024 lds
    v_mfma_f32_32x32x16_bf16 v[80:95], a[116:119], v[204:207], v[80:95]
    ds_read_b64_tr_b16 a[102:103], v18 offset:12800
    ds_read_b64_tr_b16 a[104:105], v20 offset:12288
    ds_read_b64_tr_b16 a[106:107], v20 offset:12800
    v_exp_f32 v38, v38 clamp
    v_exp_f32 v39, v39 clamp
    v_max_f32 v32, s42, v32
    v_max_f32 v33, s42, v33
    ds_read_b64_tr_b16 a[140:141], v11 offset:30720
    v_mfma_f32_32x32x16_bf16 v[96:111], a[120:123], v[204:207], v[96:111]
    ds_read_b64_tr_b16 a[108:109], v22 offset:12288
    ds_read_b64_tr_b16 a[110:111], v22 offset:12800
    v_max_f32 v34, s42, v34
    v_max_f32 v35, s42, v35
    v_add_f32 v32, v32, v36
    ds_read_b64_tr_b16 a[142:143], v11 offset:31744
    v_mfma_f32_32x32x16_bf16 v[112:127], a[124:127], v[204:207], v[112:127]
    s_waitcnt lgkmcnt(6)
    v_mfma_f32_32x32x16_bf16 v[64:79], a[96:99], v[208:211], v[64:79]
    ds_read_b64_tr_b16 a[112:113], v16 offset:45056
    ds_read_b64_tr_b16 a[114:115], v16 offset:45568
    ds_read_b64_tr_b16 a[116:117], v18 offset:45056
    v_add_f32 v33, v33, v37
    v_add_f32 v34, v34, v38
    v_add_f32 v35, v35, v39
    v_cvt_pk_bf16_f32 v44, v32, v33
    s_waitcnt lgkmcnt(3)
    s_add_u32 m0, s40, 30720
    s_mov_b32 s59, 0x4000
    s_cmp_eq_u32 s101, 20
    s_cselect_b32 s59, 0xfff94000, s59
    v_add_u32 v3, s59, v3
    buffer_load_dwordx4 v3, s[24:27], s63 offen lds
    buffer_load_dwordx4 v3, s[24:27], s64 offen offset:1024 lds
    v_mfma_f32_32x32x16_bf16 v[80:95], a[100:103], v[208:211], v[80:95]
    ds_read_b64_tr_b16 a[118:119], v18 offset:45568
    ds_read_b64_tr_b16 a[120:121], v20 offset:45056
    ds_read_b64_tr_b16 a[122:123], v20 offset:45568
    v_cvt_pk_bf16_f32 v45, v34, v35
    v_accvgpr_read_b32 v32, a76
    v_accvgpr_read_b32 v33, a77
    v_accvgpr_read_b32 v34, a78
    v_mfma_f32_32x32x16_bf16 v[96:111], a[104:107], v[208:211], v[96:111]
    ds_read_b64_tr_b16 a[124:125], v22 offset:45056
    ds_read_b64_tr_b16 a[126:127], v22 offset:45568
    v_accvgpr_read_b32 v35, a79
    v_mul_f32 v36, s41, v32
    v_mul_f32 v37, s41, v33
    v_mfma_f32_32x32x16_bf16 v[112:127], a[108:111], v[208:211], v[112:127]
    s_waitcnt lgkmcnt(4)
    v_mfma_f32_32x32x16_bf16 v[64:79], a[112:115], v[212:215], v[64:79]
    ds_read_b64_tr_b16 a[96:97], v17 offset:12288
    ds_read_b64_tr_b16 a[98:99], v17 offset:12800
    ds_read_b64_tr_b16 a[100:101], v19 offset:12288
    v_mul_f32 v38, s41, v34
    v_mul_f32 v39, s41, v35
    v_exp_f32 v36, v36 clamp
    v_exp_f32 v37, v37 clamp
    s_add_u32 m0, s40, 0
    v_add_u32 v3, 0x4000, v3
    buffer_load_dwordx4 v3, s[24:27], s63 offen lds
    buffer_load_dwordx4 v3, s[24:27], s64 offen offset:1024 lds
    v_mfma_f32_32x32x16_bf16 v[80:95], a[116:119], v[212:215], v[80:95]
    ds_read_b64_tr_b16 a[102:103], v19 offset:12800
    ds_read_b64_tr_b16 a[104:105], v21 offset:12288
    ds_read_b64_tr_b16 a[106:107], v21 offset:12800
    v_exp_f32 v38, v38 clamp
    v_exp_f32 v39, v39 clamp
    v_max_f32 v32, s42, v32
    v_max_f32 v33, s42, v33
    s_waitcnt lgkmcnt(6)
    v_mfma_f32_32x32x16_bf16 v[96:111], a[120:123], v[212:215], v[96:111]
    ds_read_b64_tr_b16 a[108:109], v23 offset:12288
    ds_read_b64_tr_b16 a[110:111], v23 offset:12800
    v_max_f32 v34, s42, v34
    v_max_f32 v35, s42, v35
    v_add_f32 v32, v32, v36
    v_mfma_f32_32x32x16_bf16 v[112:127], a[124:127], v[212:215], v[112:127]
    s_waitcnt lgkmcnt(4)
    v_mfma_f32_32x32x16_bf16 v[64:79], a[96:99], v[216:219], v[64:79]
    ds_read_b64_tr_b16 a[112:113], v17 offset:45056
    ds_read_b64_tr_b16 a[114:115], v17 offset:45568
    ds_read_b64_tr_b16 a[116:117], v19 offset:45056
    v_add_f32 v33, v33, v37
    v_add_f32 v34, v34, v38
    v_add_f32 v35, v35, v39
    v_cvt_pk_bf16_f32 v46, v32, v33
    v_mfma_f32_32x32x16_bf16 v[80:95], a[100:103], v[216:219], v[80:95]
    ds_read_b64_tr_b16 a[118:119], v19 offset:45568
    ds_read_b64_tr_b16 a[120:121], v21 offset:45056
    v_cvt_pk_bf16_f32 v47, v34, v35
    buffer_store_dwordx4 v[44:47], v2, s[20:23], s55 offen offset:1024 sc1
    s_waitcnt lgkmcnt(5)
    v_mfma_f32_32x32x16_bf16 v[96:111], a[104:107], v[216:219], v[96:111]
    s_waitcnt vmcnt(20)
    s_barrier
    ds_read_b64_tr_b16 a[122:123], v21 offset:45568
    ds_read_b64_tr_b16 a[124:125], v23 offset:45056
    ds_read_b64_tr_b16 a[126:127], v23 offset:45568
    v_accvgpr_read_b32 v32, a80
    v_accvgpr_read_b32 v33, a81
    v_accvgpr_read_b32 v34, a82
    v_accvgpr_read_b32 v35, a83
    s_add_u32 m0, s40, 2048
    v_add_u32 v3, 0x4000, v3
    buffer_load_dwordx4 v3, s[24:27], s63 offen lds
    buffer_load_dwordx4 v3, s[24:27], s64 offen offset:1024 lds
    v_mfma_f32_32x32x16_bf16 v[112:127], a[108:111], v[216:219], v[112:127]
    s_waitcnt lgkmcnt(4)
    v_mfma_f32_32x32x16_bf16 v[64:79], a[112:115], v[220:223], v[64:79]
    ds_read_b64_tr_b16 a[96:97], v16 offset:18432
    ds_read_b64_tr_b16 a[98:99], v16 offset:18944
    ds_read_b64_tr_b16 a[100:101], v18 offset:18432
    v_mul_f32 v36, s41, v32
    v_mul_f32 v37, s41, v33
    v_mul_f32 v38, s41, v34
    v_mul_f32 v39, s41, v35
    s_add_u32 m0, s40, 4096
    v_add_u32 v3, 0x4000, v3
    buffer_load_dwordx4 v3, s[24:27], s63 offen lds
    buffer_load_dwordx4 v3, s[24:27], s64 offen offset:1024 lds
    v_mfma_f32_32x32x16_bf16 v[80:95], a[116:119], v[220:223], v[80:95]
    ds_read_b64_tr_b16 a[102:103], v18 offset:18944
    ds_read_b64_tr_b16 a[104:105], v20 offset:18432
    ds_read_b64_tr_b16 a[106:107], v20 offset:18944
    v_exp_f32 v36, v36 clamp
    v_exp_f32 v37, v37 clamp
    v_exp_f32 v38, v38 clamp
    v_exp_f32 v39, v39 clamp
    s_waitcnt lgkmcnt(6)
    v_mfma_f32_32x32x16_bf16 v[96:111], a[120:123], v[220:223], v[96:111]
    ds_read_b64_tr_b16 a[108:109], v22 offset:18432
    ds_read_b64_tr_b16 a[110:111], v22 offset:18944
    v_max_f32 v32, s42, v32
    v_max_f32 v33, s42, v33
    v_max_f32 v34, s42, v34
    v_mfma_f32_32x32x16_bf16 v[112:127], a[124:127], v[220:223], v[112:127]
    s_waitcnt lgkmcnt(4)
    v_mfma_f32_32x32x16_bf16 v[64:79], a[96:99], v[224:227], v[64:79]
    ds_read_b64_tr_b16 a[112:113], v16 offset:51200
    ds_read_b64_tr_b16 a[114:115], v16 offset:51712
    ds_read_b64_tr_b16 a[116:117], v18 offset:51200
    v_max_f32 v35, s42, v35
    v_add_f32 v32, v32, v36
    v_add_f32 v33, v33, v37
    v_add_f32 v34, v34, v38
    s_add_u32 m0, s40, 6144
    s_mov_b32 s59, 0x4000
    s_cmp_eq_u32 s101, 24
    s_cselect_b32 s59, 0xfff94000, s59
    v_add_u32 v3, s59, v3
    buffer_load_dwordx4 v3, s[24:27], s63 offen lds
    buffer_load_dwordx4 v3, s[24:27], s64 offen offset:1024 lds
    v_mfma_f32_32x32x16_bf16 v[80:95], a[100:103], v[224:227], v[80:95]
    ds_read_b64_tr_b16 a[118:119], v18 offset:51712
    ds_read_b64_tr_b16 a[120:121], v20 offset:51200
    ds_read_b64_tr_b16 a[122:123], v20 offset:51712
    v_add_f32 v35, v35, v39
    v_cvt_pk_bf16_f32 v40, v32, v33
    v_cvt_pk_bf16_f32 v41, v34, v35
    v_accvgpr_read_b32 v32, a84
    s_waitcnt lgkmcnt(6)
    v_mfma_f32_32x32x16_bf16 v[96:111], a[104:107], v[224:227], v[96:111]
    ds_read_b64_tr_b16 a[124:125], v22 offset:51200
    ds_read_b64_tr_b16 a[126:127], v22 offset:51712
    v_accvgpr_read_b32 v33, a85
    v_accvgpr_read_b32 v34, a86
    v_accvgpr_read_b32 v35, a87
    v_mfma_f32_32x32x16_bf16 v[112:127], a[108:111], v[224:227], v[112:127]
    s_waitcnt lgkmcnt(4)
    v_mfma_f32_32x32x16_bf16 v[64:79], a[112:115], v[228:231], v[64:79]
    ds_read_b64_tr_b16 a[96:97], v17 offset:18432
    ds_read_b64_tr_b16 a[98:99], v17 offset:18944
    ds_read_b64_tr_b16 a[100:101], v19 offset:18432
    v_mul_f32 v36, s41, v32
    v_mul_f32 v37, s41, v33
    v_mul_f32 v38, s41, v34
    v_mul_f32 v39, s41, v35
    s_add_u32 m0, s40, 8192
    v_add_u32 v3, 0x4000, v3
    buffer_load_dwordx4 v3, s[24:27], s63 offen lds
    buffer_load_dwordx4 v3, s[24:27], s64 offen offset:1024 lds
    v_mfma_f32_32x32x16_bf16 v[80:95], a[116:119], v[228:231], v[80:95]
    ds_read_b64_tr_b16 a[102:103], v19 offset:18944
    ds_read_b64_tr_b16 a[104:105], v21 offset:18432
    ds_read_b64_tr_b16 a[106:107], v21 offset:18944
    v_exp_f32 v36, v36 clamp
    v_exp_f32 v37, v37 clamp
    v_exp_f32 v38, v38 clamp
    v_exp_f32 v39, v39 clamp
    s_waitcnt lgkmcnt(6)
    v_mfma_f32_32x32x16_bf16 v[96:111], a[120:123], v[228:231], v[96:111]
    ds_read_b64_tr_b16 a[108:109], v23 offset:18432
    ds_read_b64_tr_b16 a[110:111], v23 offset:18944
    v_max_f32 v32, s42, v32
    v_max_f32 v33, s42, v33
    v_max_f32 v34, s42, v34
    v_mfma_f32_32x32x16_bf16 v[112:127], a[124:127], v[228:231], v[112:127]
    s_waitcnt lgkmcnt(4)
    v_mfma_f32_32x32x16_bf16 v[64:79], a[96:99], v[232:235], v[64:79]
    ds_read_b64_tr_b16 a[112:113], v17 offset:51200
    ds_read_b64_tr_b16 a[114:115], v17 offset:51712
    ds_read_b64_tr_b16 a[116:117], v19 offset:51200
    v_max_f32 v35, s42, v35
    v_add_f32 v32, v32, v36
    v_add_f32 v33, v33, v37
    v_add_f32 v34, v34, v38
    s_waitcnt vmcnt(26)
    ds_read_b64_tr_b16 a[64:65], v8 offset:0
    v_mfma_f32_32x32x16_bf16 v[80:95], a[100:103], v[232:235], v[80:95]
    ds_read_b64_tr_b16 a[118:119], v19 offset:51712
    ds_read_b64_tr_b16 a[120:121], v21 offset:51200
    v_add_f32 v35, v35, v39
    v_cvt_pk_bf16_f32 v42, v32, v33
    v_cvt_pk_bf16_f32 v43, v34, v35
    ds_read_b64_tr_b16 a[66:67], v8 offset:1024
    s_waitcnt lgkmcnt(7)
    v_mfma_f32_32x32x16_bf16 v[96:111], a[104:107], v[232:235], v[96:111]
    s_waitcnt vmcnt(15)
    s_barrier
    s_lshl_b32 s58, s67, 4
    s_add_u32 s58, s58, s37
    s_cmp_lg_u32 s36, 0
    s_cbranch_scc1 L_fa3
    s_lshl_b32 s57, s58, 7
    s_add_u32 s57, s57, 0xc10000
    v_mov_b32 v28, s60
    v_mov_b32 v29, 0
    s_mov_b64 s[94:95], exec
    s_mov_b64 exec, 1
    buffer_store_dword v28, v29, s[20:23], s57 offen sc1
    s_mov_b64 exec, s[94:95]
L_fa3:
    ds_read_b64_tr_b16 a[122:123], v21 offset:51712
    ds_read_b64_tr_b16 a[124:125], v23 offset:51200
    ds_read_b64_tr_b16 a[126:127], v23 offset:51712
    buffer_store_dwordx4 v[40:43], v2, s[20:23], s55 offen offset:2048 sc1
    v_accvgpr_read_b32 v32, a88
    v_accvgpr_read_b32 v33, a89
    ds_read_b64_tr_b16 a[68:69], v9 offset:0
    ds_read_b64_tr_b16 a[70:71], v9 offset:1024
    s_add_u32 m0, s40, 10240
    v_add_u32 v3, 0x4000, v3
    buffer_load_dwordx4 v3, s[24:27], s63 offen lds
    buffer_load_dwordx4 v3, s[24:27], s64 offen offset:1024 lds
    v_mfma_f32_32x32x16_bf16 v[112:127], a[108:111], v[232:235], v[112:127]
    s_waitcnt lgkmcnt(7)
    v_mfma_f32_32x32x16_bf16 v[64:79], a[112:115], v[236:239], v[64:79]
    ds_read_b64_tr_b16 a[96:97], v16 offset:24576
    ds_read_b64_tr_b16 a[98:99], v16 offset:25088
    ds_read_b64_tr_b16 a[100:101], v18 offset:24576
    v_accvgpr_read_b32 v34, a90
    v_accvgpr_read_b32 v35, a91
    v_mul_f32 v36, s41, v32
    v_mul_f32 v37, s41, v33
    s_waitcnt lgkmcnt(3)
    s_add_u32 m0, s68, 0
    v_add_u32 v3, 0x4000, v3
    buffer_load_dwordx4 v3, s[24:27], s63 offen lds
    buffer_load_dwordx4 v3, s[24:27], s64 offen offset:1024 lds
    v_mfma_f32_32x32x16_bf16 v[80:95], a[116:119], v[236:239], v[80:95]
    ds_read_b64_tr_b16 a[102:103], v18 offset:25088
    ds_read_b64_tr_b16 a[104:105], v20 offset:24576
    ds_read_b64_tr_b16 a[106:107], v20 offset:25088
    v_mul_f32 v38, s41, v34
    v_mul_f32 v39, s41, v35
    v_exp_f32 v36, v36 clamp
    v_exp_f32 v37, v37 clamp
    v_mfma_f32_32x32x16_bf16 v[96:111], a[120:123], v[236:239], v[96:111]
    ds_read_b64_tr_b16 a[108:109], v22 offset:24576
    ds_read_b64_tr_b16 a[110:111], v22 offset:25088
    v_exp_f32 v38, v38 clamp
    v_exp_f32 v39, v39 clamp
    v_max_f32 v32, s42, v32
    v_mfma_f32_32x32x16_bf16 v[112:127], a[124:127], v[236:239], v[112:127]
    s_waitcnt lgkmcnt(4)
    v_mfma_f32_32x32x16_bf16 v[64:79], a[96:99], v[240:243], v[64:79]
    ds_read_b64_tr_b16 a[112:113], v16 offset:57344
    ds_read_b64_tr_b16 a[114:115], v16 offset:57856
    ds_read_b64_tr_b16 a[116:117], v18 offset:57344
    v_max_f32 v33, s42, v33
    v_max_f32 v34, s42, v34
    v_max_f32 v35, s42, v35
    v_add_f32 v32, v32, v36
    s_add_u32 m0, s40, 12288
    v_and_b32 v3, 0x3fff, v3
    buffer_load_dwordx4 v3, s[28:31], s65 offen lds
    buffer_load_dwordx4 v3, s[28:31], s66 offen offset:1024 lds
    v_mfma_f32_32x32x16_bf16 v[80:95], a[100:103], v[240:243], v[80:95]
    ds_read_b64_tr_b16 a[118:119], v18 offset:57856
    ds_read_b64_tr_b16 a[120:121], v20 offset:57344
    ds_read_b64_tr_b16 a[122:123], v20 offset:57856
    v_add_f32 v33, v33, v37
    v_add_f32 v34, v34, v38
    v_add_f32 v35, v35, v39
    v_cvt_pk_bf16_f32 v44, v32, v33
    s_waitcnt lgkmcnt(6)
    v_mfma_f32_32x32x16_bf16 v[96:111], a[104:107], v[240:243], v[96:111]
    ds_read_b64_tr_b16 a[124:125], v22 offset:57344
    ds_read_b64_tr_b16 a[126:127], v22 offset:57856
    v_cvt_pk_bf16_f32 v45, v34, v35
    v_accvgpr_read_b32 v32, a92
    v_accvgpr_read_b32 v33, a93
    v_mfma_f32_32x32x16_bf16 v[112:127], a[108:111], v[240:243], v[112:127]
    s_waitcnt lgkmcnt(4)
    v_mfma_f32_32x32x16_bf16 v[64:79], a[112:115], v[244:247], v[64:79]
    ds_read_b64_tr_b16 a[96:97], v17 offset:24576
    ds_read_b64_tr_b16 a[98:99], v17 offset:25088
    ds_read_b64_tr_b16 a[100:101], v19 offset:24576
    v_accvgpr_read_b32 v34, a94
    v_accvgpr_read_b32 v35, a95
    v_mul_f32 v36, s41, v32
    v_mul_f32 v37, s41, v33
    ds_read_b64_tr_b16 a[0:1], v8 offset:2048
    ds_read_b64_tr_b16 a[2:3], v8 offset:3072
    s_add_u32 m0, s40, 14336
    v_add_u32 v3, 0x4000, v3
    buffer_load_dwordx4 v3, s[28:31], s65 offen lds
    buffer_load_dwordx4 v3, s[28:31], s66 offen offset:1024 lds
    v_mfma_f32_32x32x16_bf16 v[80:95], a[116:119], v[244:247], v[80:95]
    ds_read_b64_tr_b16 a[102:103], v19 offset:25088
    ds_read_b64_tr_b16 a[104:105], v21 offset:24576
    ds_read_b64_tr_b16 a[106:107], v21 offset:25088
    v_mul_f32 v38, s41, v34
    v_mul_f32 v39, s41, v35
    v_exp_f32 v36, v36 clamp
    v_exp_f32 v37, v37 clamp
    ds_read_b64_tr_b16 a[4:5], v9 offset:2048
    s_waitcnt lgkmcnt(9)
    v_mfma_f32_32x32x16_bf16 v[96:111], a[120:123], v[244:247], v[96:111]
    ds_read_b64_tr_b16 a[108:109], v23 offset:24576
    ds_read_b64_tr_b16 a[110:111], v23 offset:25088
    v_exp_f32 v38, v38 clamp
    v_exp_f32 v39, v39 clamp
    v_max_f32 v32, s42, v32
    ds_read_b64_tr_b16 a[6:7], v9 offset:3072
    v_mfma_f32_32x32x16_bf16 v[112:127], a[124:127], v[244:247], v[112:127]
    s_waitcnt lgkmcnt(6)
    v_mfma_f32_32x32x16_bf16 v[64:79], a[96:99], v[248:251], v[64:79]
    ds_read_b64_tr_b16 a[112:113], v17 offset:57344
    ds_read_b64_tr_b16 a[114:115], v17 offset:57856
    ds_read_b64_tr_b16 a[116:117], v19 offset:57344
    v_max_f32 v33, s42, v33
    v_max_f32 v34, s42, v34
    v_max_f32 v35, s42, v35
    v_add_f32 v32, v32, v36
    ds_read_b64_tr_b16 a[8:9], v8 offset:4096
    v_mfma_f32_32x32x16_bf16 v[80:95], a[100:103], v[248:251], v[80:95]
    ds_read_b64_tr_b16 a[118:119], v19 offset:57856
    ds_read_b64_tr_b16 a[120:121], v21 offset:57344
    v_add_f32 v33, v33, v37
    v_add_f32 v34, v34, v38
    v_add_f32 v35, v35, v39
    ds_read_b64_tr_b16 a[10:11], v8 offset:5120
    s_waitcnt lgkmcnt(8)
    v_mfma_f32_32x32x16_bf16 v[96:111], a[104:107], v[248:251], v[96:111]
    s_barrier
    ds_read_b64_tr_b16 a[122:123], v21 offset:57856
    ds_read_b64_tr_b16 a[124:125], v23 offset:57344
    ds_read_b64_tr_b16 a[126:127], v23 offset:57856
    v_cvt_pk_bf16_f32 v46, v32, v33
    v_cvt_pk_bf16_f32 v47, v34, v35
    buffer_store_dwordx4 v[44:47], v2, s[20:23], s55 offen offset:3072 sc1
    ds_read_b64_tr_b16 a[12:13], v9 offset:4096
    ds_read_b64_tr_b16 a[14:15], v9 offset:5120
    s_waitcnt lgkmcnt(12)
    s_add_u32 m0, s68, 2048
    v_add_u32 v3, 0x4000, v3
    buffer_load_dwordx4 v3, s[28:31], s65 offen lds
    buffer_load_dwordx4 v3, s[28:31], s66 offen offset:1024 lds
    v_mfma_f32_32x32x16_bf16 v[112:127], a[108:111], v[248:251], v[112:127]
    s_waitcnt lgkmcnt(7)
    v_mfma_f32_32x32x16_bf16 v[64:79], a[112:115], v[252:255], v[64:79]
    s_waitcnt lgkmcnt(0)
    s_add_u32 m0, s68, 4096
    v_add_u32 v3, 0x4000, v3
    buffer_load_dwordx4 v3, s[28:31], s65 offen lds
    buffer_load_dwordx4 v3, s[28:31], s66 offen offset:1024 lds
    v_mfma_f32_32x32x16_bf16 v[80:95], a[116:119], v[252:255], v[80:95]
    v_mfma_f32_32x32x16_bf16 v[96:111], a[120:123], v[252:255], v[96:111]
    v_mfma_f32_32x32x16_bf16 v[112:127], a[124:127], v[252:255], v[112:127]
    s_nop 7
    s_nop 3
    v_max_f32 v64, 0, v64
    v_max_f32 v65, 0, v65
    v_max_f32 v66, 0, v66
    v_max_f32 v67, 0, v67
    v_max_f32 v68, 0, v68
    v_max_f32 v69, 0, v69
    v_max_f32 v70, 0, v70
    v_max_f32 v71, 0, v71
    v_mul_f32 v64, v64, v72
    v_mul_f32 v65, v65, v73
    v_mul_f32 v66, v66, v74
    v_mul_f32 v67, v67, v75
    v_mul_f32 v68, v68, v76
    v_mul_f32 v69, v69, v77
    v_mul_f32 v70, v70, v78
    v_mul_f32 v71, v71, v79
    v_cvt_pk_bf16_f32 v32, v64, v65
    v_cvt_pk_bf16_f32 v33, v66, v67
    v_cvt_pk_bf16_f32 v34, v68, v69
    v_cvt_pk_bf16_f32 v35, v70, v71
    buffer_store_dwordx4 v[32:35], v2, s[20:23], s54 offen sc1
    v_max_f32 v80, 0, v80
    v_max_f32 v81, 0, v81
    v_max_f32 v82, 0, v82
    v_max_f32 v83, 0, v83
    v_max_f32 v84, 0, v84
    v_max_f32 v85, 0, v85
    v_max_f32 v86, 0, v86
    v_max_f32 v87, 0, v87
    v_mul_f32 v80, v80, v88
    v_mul_f32 v81, v81, v89
    v_mul_f32 v82, v82, v90
    v_mul_f32 v83, v83, v91
    v_mul_f32 v84, v84, v92
    v_mul_f32 v85, v85, v93
    v_mul_f32 v86, v86, v94
    v_mul_f32 v87, v87, v95
    v_cvt_pk_bf16_f32 v44, v80, v81
    v_cvt_pk_bf16_f32 v45, v82, v83
    v_cvt_pk_bf16_f32 v46, v84, v85
    v_cvt_pk_bf16_f32 v47, v86, v87
    buffer_store_dwordx4 v[44:47], v2, s[20:23], s54 offen offset:1024 sc1
    v_max_f32 v96, 0, v96
    v_max_f32 v97, 0, v97
    v_max_f32 v98, 0, v98
    v_max_f32 v99, 0, v99
    v_max_f32 v100, 0, v100
    v_max_f32 v101, 0, v101
    v_max_f32 v102, 0, v102
    v_max_f32 v103, 0, v103
    v_mul_f32 v96, v96, v104
    v_mul_f32 v97, v97, v105
    v_mul_f32 v98, v98, v106
    v_mul_f32 v99, v99, v107
    v_mul_f32 v100, v100, v108
    v_mul_f32 v101, v101, v109
    v_mul_f32 v102, v102, v110
    v_mul_f32 v103, v103, v111
    v_cvt_pk_bf16_f32 v32, v96, v97
    v_cvt_pk_bf16_f32 v33, v98, v99
    v_cvt_pk_bf16_f32 v34, v100, v101
    v_cvt_pk_bf16_f32 v35, v102, v103
    buffer_store_dwordx4 v[32:35], v2, s[20:23], s54 offen offset:2048 sc1
    v_max_f32 v112, 0, v112
    v_max_f32 v113, 0, v113
    v_max_f32 v114, 0, v114
    v_max_f32 v115, 0, v115
    v_max_f32 v116, 0, v116
    v_max_f32 v117, 0, v117
    v_max_f32 v118, 0, v118
    v_max_f32 v119, 0, v119
    v_mul_f32 v112, v112, v120
    v_mul_f32 v113, v113, v121
    v_mul_f32 v114, v114, v122
    v_mul_f32 v115, v115, v123
    v_mul_f32 v116, v116, v124
    v_mul_f32 v117, v117, v125
    v_mul_f32 v118, v118, v126
    v_mul_f32 v119, v119, v127
    v_cvt_pk_bf16_f32 v44, v112, v113
    v_cvt_pk_bf16_f32 v45, v114, v115
    v_cvt_pk_bf16_f32 v46, v116, v117
    v_cvt_pk_bf16_f32 v47, v118, v119
    buffer_store_dwordx4 v[44:47], v2, s[20:23], s54 offen offset:3072 sc1
    s_waitcnt vmcnt(0)
    s_barrier
    s_lshl_b32 s58, s37, 4
    s_add_u32 s58, s58, s93
    s_cmp_lg_u32 s36, 0
    s_cbranch_scc1 L_fa4
    s_lshl_b32 s57, s58, 7
    s_add_u32 s57, s57, 0xc00000
    v_mov_b32 v28, s60
    v_mov_b32 v29, 0
    s_mov_b64 s[94:95], exec
    s_mov_b64 exec, 1
    buffer_store_dword v28, v29, s[20:23], s57 offen sc1
    s_mov_b64 exec, s[94:95]
L_fa4:
    s_add_u32 m0, s40, 16384
    v_add_u32 v3, 0x4000, v3
    buffer_load_dwordx4 v3, s[28:31], s65 offen lds
    buffer_load_dwordx4 v3, s[28:31], s66 offen offset:1024 lds
    s_add_u32 m0, s40, 18432
    v_add_u32 v3, 0x4000, v3
    buffer_load_dwordx4 v3, s[28:31], s65 offen lds
    buffer_load_dwordx4 v3, s[28:31], s66 offen offset:1024 lds
    s_add_u32 m0, s40, 20480
    v_add_u32 v3, 0x4000, v3
    buffer_load_dwordx4 v3, s[28:31], s65 offen lds
    buffer_load_dwordx4 v3, s[28:31], s66 offen offset:1024 lds
    s_add_u32 m0, s40, 22528
    v_add_u32 v3, 0x4000, v3
    buffer_load_dwordx4 v3, s[28:31], s65 offen lds
    buffer_load_dwordx4 v3, s[28:31], s66 offen offset:1024 lds
    v_and_b32 v40, 3, v1
    v_lshlrev_b32 v40, 7, v40
    s_lshr_b32 s57, s61, 1
    s_lshl_b32 s57, s57, 4
    s_lshl_b32 s58, s36, 2
    s_add_u32 s57, s57, s58
    s_lshl_b32 s57, s57, 7
    s_add_u32 s50, s57, 0xc00000
    v_and_b32 v41, 31, v1
    v_lshlrev_b32 v41, 7, v41
    s_lshl_b32 s51, s36, 12
    s_add_u32 s51, s51, 0xc20000
    s_mul_i32 s44, s61, 229376
    s_mul_i32 s57, s36, 28672
    s_add_u32 s44, s44, s57
    s_and_b32 s57, s61, 3
    s_lshl_b32 s57, s57, 13
    s_add_u32 s44, s44, s57
    s_add_u32 s45, s44, 114688
    s_lshl_b32 s46, s61, 16
    s_lshl_b32 s57, s36, 13
    s_add_u32 s46, s46, s57
    s_add_u32 s46, s46, 0x800000
    s_add_u32 s47, s46, 32768
    s_add_u32 s48, s57, 0xb00000
    buffer_load_dword v42, v40, s[20:23], s50 offen sc1
    s_waitcnt vmcnt(0)
    v_cmp_eq_u32 vcc, s60, v42
    s_nop 1
    s_cmp_eq_u64 vcc, -1
    s_cbranch_scc1 L_pcok6
    s_mov_b32 s3, 0
L_pc5:
    buffer_load_dword v42, v40, s[20:23], s50 offen sc1
    s_waitcnt vmcnt(0)
    v_cmp_eq_u32 vcc, s60, v42
    s_nop 1
    s_cmp_eq_u64 vcc, -1
    s_cbranch_scc1 L_pcok6
    s_sleep 6
    s_add_u32 s3, s3, 1
    s_cmp_lt_u32 s3, 20000
    s_cbranch_scc1 L_pc5
L_pcok6:
    buffer_load_dwordx4 v[128:131], v2, s[20:23], s44 offen sc1
    buffer_load_dwordx4 v[132:135], v2, s[20:23], s45 offen sc1
    buffer_load_dwordx4 v[136:139], v2, s[20:23], s44 offen offset:1024 sc1
    buffer_load_dwordx4 v[140:143], v2, s[20:23], s45 offen offset:1024 sc1
    buffer_load_dwordx4 v[144:147], v2, s[20:23], s44 offen offset:2048 sc1
    buffer_load_dwordx4 v[148:151], v2, s[20:23], s45 offen offset:2048 sc1
    buffer_load_dwordx4 v[152:155], v2, s[20:23], s44 offen offset:3072 sc1
    buffer_load_dwordx4 v[156:159], v2, s[20:23], s45 offen offset:3072 sc1
    s_movk_i32 s59, 4096
    s_cmp_eq_u32 s101, 4
    s_cselect_b32 s59, 0xffffa000, s59
    s_add_u32 s44, s44, s59
    s_add_u32 s45, s45, s59
    buffer_load_dwordx4 v[160:163], v2, s[20:23], s44 offen sc1
    buffer_load_dwordx4 v[164:167], v2, s[20:23], s45 offen sc1
    buffer_load_dwordx4 v[168:171], v2, s[20:23], s44 offen offset:1024 sc1
    buffer_load_dwordx4 v[172:175], v2, s[20:23], s45 offen offset:1024 sc1
    buffer_load_dwordx4 v[176:179], v2, s[20:23], s44 offen offset:2048 sc1
    buffer_load_dwordx4 v[180:183], v2, s[20:23], s45 offen offset:2048 sc1
    buffer_load_dwordx4 v[184:187], v2, s[20:23], s44 offen offset:3072 sc1
    buffer_load_dwordx4 v[188:191], v2, s[20:23], s45 offen offset:3072 sc1
    s_movk_i32 s59, 4096
    s_cmp_eq_u32 s101, 8
    s_cselect_b32 s59, 0xffffa000, s59
    s_add_u32 s44, s44, s59
    s_add_u32 s45, s45, s59
    buffer_load_dwordx4 v[192:195], v2, s[20:23], s44 offen sc1
    buffer_load_dwordx4 v[196:199], v2, s[20:23], s45 offen sc1
    buffer_load_dwordx4 v[200:203], v2, s[20:23], s44 offen offset:1024 sc1
    buffer_load_dwordx4 v[204:207], v2, s[20:23], s45 offen offset:1024 sc1
    buffer_load_dwordx4 v[208:211], v2, s[20:23], s44 offen offset:2048 sc1
    buffer_load_dwordx4 v[212:215], v2, s[20:23], s45 offen offset:2048 sc1
    buffer_load_dwordx4 v[216:219], v2, s[20:23], s44 offen offset:3072 sc1
    buffer_load_dwordx4 v[220:223], v2, s[20:23], s45 offen offset:3072 sc1
    s_movk_i32 s59, 4096
    s_cmp_eq_u32 s101, 12
    s_cselect_b32 s59, 0xffffa000, s59
    s_add_u32 s44, s44, s59
    s_add_u32 s45, s45, s59
    buffer_load_dwordx4 v[224:227], v2, s[20:23], s44 offen sc1
    buffer_load_dwordx4 v[228:231], v2, s[20:23], s45 offen sc1
    buffer_load_dwordx4 v[232:235], v2, s[20:23], s44 offen offset:1024 sc1
    buffer_load_dwordx4 v[236:239], v2, s[20:23], s45 offen offset:1024 sc1
    buffer_load_dwordx4 v[240:243], v2, s[20:23], s44 offen offset:2048 sc1
    buffer_load_dwordx4 v[244:247], v2, s[20:23], s45 offen offset:2048 sc1
    buffer_load_dwordx4 v[248:251], v2, s[20:23], s44 offen offset:3072 sc1
    buffer_load_dwordx4 v[252:255], v2, s[20:23], s45 offen offset:3072 sc1
    s_movk_i32 s59, 4096
    s_cmp_eq_u32 s101, 16
    s_cselect_b32 s59, 0xffffa000, s59
    s_add_u32 s44, s44, s59
    s_add_u32 s45, s45, s59
    ds_read_b64_tr_b16 a[16:17], v8 offset:6144
    ds_read_b64_tr_b16 a[18:19], v8 offset:7168
    ds_read_b64_tr_b16 a[20:21], v9 offset:6144
    ds_read_b64_tr_b16 a[22:23], v9 offset:7168
    ds_read_b64_tr_b16 a[24:25], v10 offset:30720
    ds_read_b64_tr_b16 a[26:27], v10 offset:31744
    ds_read_b64_tr_b16 a[28:29], v11 offset:30720
    ds_read_b64_tr_b16 a[30:31], v11 offset:31744
    ds_read_b64_tr_b16 a[32:33], v10 offset:0
    ds_read_b64_tr_b16 a[34:35], v10 offset:1024
    ds_read_b64_tr_b16 a[36:37], v11 offset:0
    ds_read_b64_tr_b16 a[38:39], v11 offset:1024
    ds_read_b64_tr_b16 a[40:41], v10 offset:2048
    ds_read_b64_tr_b16 a[42:43], v10 offset:3072
    ds_read_b64_tr_b16 a[44:45], v11 offset:2048
    ds_read_b64_tr_b16 a[46:47], v11 offset:3072
    ds_read_b64_tr_b16 a[48:49], v10 offset:4096
    ds_read_b64_tr_b16 a[50:51], v10 offset:5120
    ds_read_b64_tr_b16 a[52:53], v11 offset:4096
    ds_read_b64_tr_b16 a[54:55], v11 offset:5120
    ds_read_b64_tr_b16 a[56:57], v10 offset:6144
    ds_read_b64_tr_b16 a[58:59], v10 offset:7168
    ds_read_b64_tr_b16 a[60:61], v11 offset:6144
    ds_read_b64_tr_b16 a[62:63], v11 offset:7168
    ds_read_b64_tr_b16 a[72:73], v10 offset:8192
    ds_read_b64_tr_b16 a[74:75], v10 offset:9216
    ds_read_b64_tr_b16 a[76:77], v11 offset:8192
    ds_read_b64_tr_b16 a[78:79], v11 offset:9216
    ds_read_b64_tr_b16 a[80:81], v10 offset:10240
    ds_read_b64_tr_b16 a[82:83], v10 offset:11264
    ds_read_b64_tr_b16 a[84:85], v11 offset:10240
    ds_read_b64_tr_b16 a[86:87], v11 offset:11264
    ds_read_b64_tr_b16 a[88:89], v8 offset:0
    ds_read_b64_tr_b16 a[90:91], v8 offset:1024
    ds_read_b64_tr_b16 a[92:93], v9 offset:0
    ds_read_b64_tr_b16 a[94:95], v9 offset:1024
    s_waitcnt vmcnt(30)
    v_mfma_f32_32x32x16_bf16 v[64:79], a[160:163], v[128:131], 0
    v_mfma_f32_32x32x16_bf16 v[80:95], a[160:163], v[132:135], 0
    v_mfma_f32_32x32x16_bf16 v[96:111], a[164:167], v[128:131], 0
    v_mfma_f32_32x32x16_bf16 v[112:127], a[164:167], v[132:135], 0
    buffer_load_dwordx4 v[128:131], v2, s[20:23], s44 offen sc1
    buffer_load_dwordx4 v[132:135], v2, s[20:23], s45 offen sc1
    s_waitcnt vmcnt(30)
    v_mfma_f32_32x32x16_bf16 v[64:79], a[168:171], v[136:139], v[64:79]
    v_mfma_f32_32x32x16_bf16 v[80:95], a[168:171], v[140:143], v[80:95]
    v_mfma_f32_32x32x16_bf16 v[96:111], a[172:175], v[136:139], v[96:111]
    v_mfma_f32_32x32x16_bf16 v[112:127], a[172:175], v[140:143], v[112:127]
    buffer_load_dwordx4 v[136:139], v2, s[20:23], s44 offen offset:1024 sc1
    buffer_load_dwordx4 v[140:143], v2, s[20:23], s45 offen offset:1024 sc1
    s_waitcnt vmcnt(30)
    v_mfma_f32_32x32x16_bf16 v[64:79], a[176:179], v[144:147], v[64:79]
    v_mfma_f32_32x32x16_bf16 v[80:95], a[176:179], v[148:151], v[80:95]
    v_mfma_f32_32x32x16_bf16 v[96:111], a[180:183], v[144:147], v[96:111]
    v_mfma_f32_32x32x16_bf16 v[112:127], a[180:183], v[148:151], v[112:127]
    buffer_load_dwordx4 v[144:147], v2, s[20:23], s44 offen offset:2048 sc1
    buffer_load_dwordx4 v[148:151], v2, s[20:23], s45 offen offset:2048 sc1
    s_waitcnt vmcnt(30)
    v_mfma_f32_32x32x16_bf16 v[64:79], a[184:187], v[152:155], v[64:79]
    v_mfma_f32_32x32x16_bf16 v[80:95], a[184:187], v[156:159], v[80:95]
    v_mfma_f32_32x32x16_bf16 v[96:111], a[188:191], v[152:155], v[96:111]
    v_mfma_f32_32x32x16_bf16 v[112:127], a[188:191], v[156:159], v[112:127]
    buffer_load_dwordx4 v[152:155], v2, s[20:23], s44 offen offset:3072 sc1
    buffer_load_dwordx4 v[156:159], v2, s[20:23], s45 offen offset:3072 sc1
    s_movk_i32 s59, 4096
    s_cmp_eq_u32 s101, 20
    s_cselect_b32 s59, 0xffffa000, s59
    s_add_u32 s44, s44, s59
    s_add_u32 s45, s45, s59
    s_waitcnt vmcnt(30)
    v_mfma_f32_32x32x16_bf16 v[64:79], a[192:195], v[160:163], v[64:79]
    v_mfma_f32_32x32x16_bf16 v[80:95], a[192:195], v[164:167], v[80:95]
    v_mfma_f32_32x32x16_bf16 v[96:111], a[196:199], v[160:163], v[96:111]
    v_mfma_f32_32x32x16_bf16 v[112:127], a[196:199], v[164:167], v[112:127]
    buffer_load_dwordx4 v[160:163], v2, s[20:23], s44 offen sc1
    buffer_load_dwordx4 v[164:167], v2, s[20:23], s45 offen sc1
    s_waitcnt vmcnt(30)
    v_mfma_f32_32x32x16_bf16 v[64:79], a[200:203], v[168:171], v[64:79]
    v_mfma_f32_32x32x16_bf16 v[80:95], a[200:203], v[172:175], v[80:95]
    v_mfma_f32_32x32x16_bf16 v[96:111], a[204:207], v[168:171], v[96:111]
    v_mfma_f32_32x32x16_bf16 v[112:127], a[204:207], v[172:175], v[112:127]
    buffer_load_dwordx4 v[168:171], v2, s[20:23], s44 offen offset:1024 sc1
    buffer_load_dwordx4 v[172:175], v2, s[20:23], s45 offen offset:1024 sc1
    s_waitcnt vmcnt(30)
    v_mfma_f32_32x32x16_bf16 v[64:79], a[208:211], v[176:179], v[64:79]
    v_mfma_f32_32x32x16_bf16 v[80:95], a[208:211], v[180:183], v[80:95]
    v_mfma_f32_32x32x16_bf16 v[96:111], a[212:215], v[176:179], v[96:111]
    v_mfma_f32_32x32x16_bf16 v[112:127], a[212:215], v[180:183], v[112:127]
    buffer_load_dwordx4 v[176:179], v2, s[20:23], s44 offen offset:2048 sc1
    buffer_load_dwordx4 v[180:183], v2, s[20:23], s45 offen offset:2048 sc1
    s_waitcnt vmcnt(30)
    v_mfma_f32_32x32x16_bf16 v[64:79], a[216:219], v[184:187], v[64:79]
    v_mfma_f32_32x32x16_bf16 v[80:95], a[216:219], v[188:191], v[80:95]
    v_mfma_f32_32x32x16_bf16 v[96:111], a[220:223], v[184:187], v[96:111]
    v_mfma_f32_32x32x16_bf16 v[112:127], a[220:223], v[188:191], v[112:127]
    buffer_load_dwordx4 v[184:187], v2, s[20:23], s44 offen offset:3072 sc1
    buffer_load_dwordx4 v[188:191], v2, s[20:23], s45 offen offset:3072 sc1
    s_movk_i32 s59, 4096
    s_cmp_eq_u32 s101, 24
    s_cselect_b32 s59, 0xffffa000, s59
    s_add_u32 s44, s44, s59
    s_add_u32 s45, s45, s59
    s_waitcnt vmcnt(30)
    v_mfma_f32_32x32x16_bf16 v[64:79], a[224:227], v[192:195], v[64:79]
    v_mfma_f32_32x32x16_bf16 v[80:95], a[224:227], v[196:199], v[80:95]
    v_mfma_f32_32x32x16_bf16 v[96:111], a[228:231], v[192:195], v[96:111]
    v_mfma_f32_32x32x16_bf16 v[112:127], a[228:231], v[196:199], v[112:127]
    buffer_load_dwordx4 v[192:195], v2, s[20:23], s44 offen sc1
    buffer_load_dwordx4 v[196:199], v2, s[20:23], s45 offen sc1
    s_waitcnt vmcnt(30)
    v_mfma_f32_32x32x16_bf16 v[64:79], a[232:235], v[200:203], v[64:79]
    v_mfma_f32_32x32x16_bf16 v[80:95], a[232:235], v[204:207], v[80:95]
    v_mfma_f32_32x32x16_bf16 v[96:111], a[236:239], v[200:203], v[96:111]
    v_mfma_f32_32x32x16_bf16 v[112:127], a[236:239], v[204:207], v[112:127]
    buffer_load_dwordx4 v[200:203], v2, s[20:23], s44 offen offset:1024 sc1
    buffer_load_dwordx4 v[204:207], v2, s[20:23], s45 offen offset:1024 sc1
    s_waitcnt vmcnt(30)
    v_mfma_f32_32x32x16_bf16 v[64:79], a[240:243], v[208:211], v[64:79]
    v_mfma_f32_32x32x16_bf16 v[80:95], a[240:243], v[212:215], v[80:95]
    v_mfma_f32_32x32x16_bf16 v[96:111], a[244:247], v[208:211], v[96:111]
    v_mfma_f32_32x32x16_bf16 v[112:127], a[244:247], v[212:215], v[112:127]
    buffer_load_dwordx4 v[208:211], v2, s[20:23], s44 offen offset:2048 sc1
    buffer_load_dwordx4 v[212:215], v2, s[20:23], s45 offen offset:2048 sc1
    s_waitcnt vmcnt(30)
    v_mfma_f32_32x32x16_bf16 v[64:79], a[248:251], v[216:219], v[64:79]
    v_mfma_f32_32x32x16_bf16 v[80:95], a[248:251], v[220:223], v[80:95]
    v_mfma_f32_32x32x16_bf16 v[96:111], a[252:255], v[216:219], v[96:111]
    v_mfma_f32_32x32x16_bf16 v[112:127], a[252:255], v[220:223], v[112:127]
    buffer_load_dwordx4 v[216:219], v2, s[20:23], s44 offen offset:3072 sc1
    buffer_load_dwordx4 v[220:223], v2, s[20:23], s45 offen offset:3072 sc1
    s_waitcnt vmcnt(30)
    v_mfma_f32_32x32x16_bf16 v[64:79], a[144:147], v[224:227], v[64:79]
    v_mfma_f32_32x32x16_bf16 v[80:95], a[144:147], v[228:231], v[80:95]
    v_mfma_f32_32x32x16_bf16 v[96:111], a[148:151], v[224:227], v[96:111]
    v_mfma_f32_32x32x16_bf16 v[112:127], a[148:151], v[228:231], v[112:127]
    buffer_load_dword v42, v41, s[20:23], s51 offen sc1
    s_waitcnt vmcnt(29)
    v_mfma_f32_32x32x16_bf16 v[64:79], a[152:155], v[232:235], v[64:79]
    v_mfma_f32_32x32x16_bf16 v[80:95], a[152:155], v[236:239], v[80:95]
    v_mfma_f32_32x32x16_bf16 v[96:111], a[156:159], v[232:235], v[96:111]
    v_mfma_f32_32x32x16_bf16 v[112:127], a[156:159], v[236:239], v[112:127]
    s_waitcnt vmcnt(27)
    v_mfma_f32_32x32x16_bf16 v[64:79], a[128:131], v[240:243], v[64:79]
    v_mfma_f32_32x32x16_bf16 v[80:95], a[128:131], v[244:247], v[80:95]
    v_mfma_f32_32x32x16_bf16 v[96:111], a[132:135], v[240:243], v[96:111]
    v_mfma_f32_32x32x16_bf16 v[112:127], a[132:135], v[244:247], v[112:127]
    s_waitcnt vmcnt(25)
    v_mfma_f32_32x32x16_bf16 v[64:79], a[136:139], v[248:251], v[64:79]
    v_mfma_f32_32x32x16_bf16 v[80:95], a[136:139], v[252:255], v[80:95]
    v_mfma_f32_32x32x16_bf16 v[96:111], a[140:143], v[248:251], v[96:111]
    v_mfma_f32_32x32x16_bf16 v[112:127], a[140:143], v[252:255], v[112:127]
    s_waitcnt vmcnt(23)
    v_mfma_f32_32x32x16_bf16 v[64:79], a[64:67], v[128:131], v[64:79]
    v_mfma_f32_32x32x16_bf16 v[80:95], a[64:67], v[132:135], v[80:95]
    v_mfma_f32_32x32x16_bf16 v[96:111], a[68:71], v[128:131], v[96:111]
    v_mfma_f32_32x32x16_bf16 v[112:127], a[68:71], v[132:135], v[112:127]
    buffer_load_dwordx4 v[128:131], v2, s[20:23], s46 offen sc1
    buffer_load_dwordx4 v[132:135], v2, s[20:23], s47 offen sc1
    s_waitcnt vmcnt(2)
    v_cmp_eq_u32 vcc, s60, v42
    s_nop 1
    s_cmp_eq_u64 vcc, -1
    s_cbranch_scc1 L_pcok8
    s_mov_b32 s3, 0
L_pc7:
    buffer_load_dword v42, v41, s[20:23], s51 offen sc1
    s_waitcnt vmcnt(0)
    v_cmp_eq_u32 vcc, s60, v42
    s_nop 1
    s_cmp_eq_u64 vcc, -1
    s_cbranch_scc1 L_pcok8
    s_sleep 6
    s_add_u32 s3, s3, 1
    s_cmp_lt_u32 s3, 20000
    s_cbranch_scc1 L_pc7
L_pcok8:
    buffer_load_dwordx4 v[224:227], v2, s[20:23], s48 offen sc1
    buffer_load_dwordx4 v[228:231], v2, s[20:23], s48 offen offset:1024 sc1
    buffer_load_dwordx4 v[232:235], v2, s[20:23], s48 offen offset:2048 sc1
    buffer_load_dwordx4 v[236:239], v2, s[20:23], s48 offen offset:3072 sc1
    s_add_u32 s48, s48, 4096
    buffer_load_dwordx4 v[240:243], v2, s[20:23], s48 offen sc1
    buffer_load_dwordx4 v[244:247], v2, s[20:23], s48 offen offset:1024 sc1
    buffer_load_dwordx4 v[248:251], v2, s[20:23], s48 offen offset:2048 sc1
    buffer_load_dwordx4 v[252:255], v2, s[20:23], s48 offen offset:3072 sc1
    v_mfma_f32_32x32x16_bf16 v[64:79], a[0:3], v[136:139], v[64:79]
    v_mfma_f32_32x32x16_bf16 v[80:95], a[0:3], v[140:143], v[80:95]
    v_mfma_f32_32x32x16_bf16 v[96:111], a[4:7], v[136:139], v[96:111]
    v_mfma_f32_32x32x16_bf16 v[112:127], a[4:7], v[140:143], v[112:127]
    buffer_load_dwordx4 v[136:139], v2, s[20:23], s46 offen offset:1024 sc1
    buffer_load_dwordx4 v[140:143], v2, s[20:23], s47 offen offset:1024 sc1
    v_mfma_f32_32x32x16_bf16 v[64:79], a[8:11], v[144:147], v[64:79]
    v_mfma_f32_32x32x16_bf16 v[80:95], a[8:11], v[148:151], v[80:95]
    v_mfma_f32_32x32x16_bf16 v[96:111], a[12:15], v[144:147], v[96:111]
    v_mfma_f32_32x32x16_bf16 v[112:127], a[12:15], v[148:151], v[112:127]
    buffer_load_dwordx4 v[144:147], v2, s[20:23], s46 offen offset:2048 sc1
    buffer_load_dwordx4 v[148:151], v2, s[20:23], s47 offen offset:2048 sc1
    s_waitcnt lgkmcnt(15)
    v_mfma_f32_32x32x16_bf16 v[64:79], a[16:19], v[152:155], v[64:79]
    v_mfma_f32_32x32x16_bf16 v[80:95], a[16:19], v[156:159], v[80:95]
    v_mfma_f32_32x32x16_bf16 v[96:111], a[20:23], v[152:155], v[96:111]
    v_mfma_f32_32x32x16_bf16 v[112:127], a[20:23], v[156:159], v[112:127]
    buffer_load_dwordx4 v[152:155], v2, s[20:23], s46 offen offset:3072 sc1
    buffer_load_dwordx4 v[156:159], v2, s[20:23], s47 offen offset:3072 sc1
    s_add_u32 s46, s46, 4096
    s_add_u32 s47, s47, 4096
    v_mfma_f32_32x32x16_bf16 v[64:79], a[24:27], v[160:163], v[64:79]
    v_mfma_f32_32x32x16_bf16 v[80:95], a[24:27], v[164:167], v[80:95]
    v_mfma_f32_32x32x16_bf16 v[96:111], a[28:31], v[160:163], v[96:111]
    v_mfma_f32_32x32x16_bf16 v[112:127], a[28:31], v[164:167], v[112:127]
    buffer_load_dwordx4 v[160:163], v2, s[20:23], s46 offen sc1
    buffer_load_dwordx4 v[164:167], v2, s[20:23], s47 offen sc1
    v_lshrrev_b32 v46, 3, v0
    v_lshlrev_b32 v46, 10, v46
    v_and_b32 v47, 7, v0
    v_lshl_add_u32 v46, v47, 4, v46
    s_lshl_b32 s52, s61, 16
    s_lshl_b32 s58, s62, 7
    s_add_u32 s52, s52, s58
    s_add_u32 s54, s52, 32768
    buffer_load_dwordx4 v[48:51], v46, s[4:7], s52 offen
    buffer_load_dwordx4 v[52:55], v46, s[4:7], s54 offen
    v_mfma_f32_32x32x16_bf16 v[64:79], a[32:35], v[168:171], v[64:79]
    v_mfma_f32_32x32x16_bf16 v[80:95], a[32:35], v[172:175], v[80:95]
    v_mfma_f32_32x32x16_bf16 v[96:111], a[36:39], v[168:171], v[96:111]
    v_mfma_f32_32x32x16_bf16 v[112:127], a[36:39], v[172:175], v[112:127]
    buffer_load_dwordx4 v[168:171], v2, s[20:23], s46 offen offset:1024 sc1
    buffer_load_dwordx4 v[172:175], v2, s[20:23], s47 offen offset:1024 sc1
    v_mfma_f32_32x32x16_bf16 v[64:79], a[40:43], v[176:179], v[64:79]
    v_mfma_f32_32x32x16_bf16 v[80:95], a[40:43], v[180:183], v[80:95]
    v_mfma_f32_32x32x16_bf16 v[96:111], a[44:47], v[176:179], v[96:111]
    v_mfma_f32_32x32x16_bf16 v[112:127], a[44:47], v[180:183], v[112:127]
    buffer_load_dwordx4 v[176:179], v2, s[20:23], s46 offen offset:2048 sc1
    buffer_load_dwordx4 v[180:183], v2, s[20:23], s47 offen offset:2048 sc1
    v_mfma_f32_32x32x16_bf16 v[64:79], a[48:51], v[184:187], v[64:79]
    v_mfma_f32_32x32x16_bf16 v[80:95], a[48:51], v[188:191], v[80:95]
    v_mfma_f32_32x32x16_bf16 v[96:111], a[52:55], v[184:187], v[96:111]
    v_mfma_f32_32x32x16_bf16 v[112:127], a[52:55], v[188:191], v[112:127]
    buffer_load_dwordx4 v[184:187], v2, s[20:23], s46 offen offset:3072 sc1
    buffer_load_dwordx4 v[188:191], v2, s[20:23], s47 offen offset:3072 sc1
    s_waitcnt lgkmcnt(12)
    v_mfma_f32_32x32x16_bf16 v[64:79], a[56:59], v[192:195], v[64:79]
    v_mfma_f32_32x32x16_bf16 v[80:95], a[56:59], v[196:199], v[80:95]
    v_mfma_f32_32x32x16_bf16 v[96:111], a[60:63], v[192:195], v[96:111]
    v_mfma_f32_32x32x16_bf16 v[112:127], a[60:63], v[196:199], v[112:127]
    s_waitcnt lgkmcnt(8)
    v_mfma_f32_32x32x16_bf16 v[64:79], a[72:75], v[200:203], v[64:79]
    v_mfma_f32_32x32x16_bf16 v[80:95], a[72:75], v[204:207], v[80:95]
    v_mfma_f32_32x32x16_bf16 v[96:111], a[76:79], v[200:203], v[96:111]
    v_mfma_f32_32x32x16_bf16 v[112:127], a[76:79], v[204:207], v[112:127]
    s_waitcnt lgkmcnt(4)
    v_mfma_f32_32x32x16_bf16 v[64:79], a[80:83], v[208:211], v[64:79]
    v_mfma_f32_32x32x16_bf16 v[80:95], a[80:83], v[212:215], v[80:95]
    v_mfma_f32_32x32x16_bf16 v[96:111], a[84:87], v[208:211], v[96:111]
    v_mfma_f32_32x32x16_bf16 v[112:127], a[84:87], v[212:215], v[112:127]
    s_waitcnt lgkmcnt(0)
    v_mfma_f32_32x32x16_bf16 v[64:79], a[88:91], v[216:219], v[64:79]
    v_mfma_f32_32x32x16_bf16 v[80:95], a[88:91], v[220:223], v[80:95]
    v_mfma_f32_32x32x16_bf16 v[96:111], a[92:95], v[216:219], v[96:111]
    v_mfma_f32_32x32x16_bf16 v[112:127], a[92:95], v[220:223], v[112:127]
    s_nop 3
    ds_read_b64_tr_b16 a[0:1], v10 offset:12288
    ds_read_b64_tr_b16 a[2:3], v10 offset:13312
    ds_read_b64_tr_b16 a[4:5], v11 offset:12288
    ds_read_b64_tr_b16 a[6:7], v11 offset:13312
    ds_read_b64_tr_b16 a[8:9], v10 offset:14336
    ds_read_b64_tr_b16 a[10:11], v10 offset:15360
    ds_read_b64_tr_b16 a[12:13], v11 offset:14336
    ds_read_b64_tr_b16 a[14:15], v11 offset:15360
    s_waitcnt vmcnt(23)
    v_mfma_f32_32x32x16_bf16 v[192:207], v[224:227], v[128:131], 0
    v_mfma_f32_32x32x16_bf16 v[208:223], v[224:227], v[132:135], 0
    s_nop 10
    v_add_f32 v28, s42, v200
    v_rcp_f32 v28, v28
    s_nop 0
    v_mul_f32 v192, v192, v28
    v_mul_f32 v193, v193, v28
    v_mul_f32 v194, v194, v28
    v_mul_f32 v195, v195, v28
    v_mul_f32 v196, v196, v28
    v_mul_f32 v197, v197, v28
    v_mul_f32 v198, v198, v28
    v_mul_f32 v199, v199, v28
    v_cvt_pk_bf16_f32 v24, v192, v193
    v_cvt_pk_bf16_f32 v25, v194, v195
    v_cvt_pk_bf16_f32 v26, v196, v197
    v_cvt_pk_bf16_f32 v27, v198, v199
    s_waitcnt vmcnt(15)
    v_mfma_f32_32x32x16_bf16 v[192:207], v[228:231], v[136:139], 0
    ds_read_b64_tr_b16 a[16:17], v8 offset:2048
    ds_read_b64_tr_b16 a[18:19], v8 offset:3072
    ds_read_b64_tr_b16 a[20:21], v9 offset:2048
    ds_read_b64_tr_b16 a[22:23], v9 offset:3072
    s_waitcnt lgkmcnt(8)
    v_mfma_f32_32x32x16_bf16 v[64:79], a[0:3], v[24:27], v[64:79]
    v_mfma_f32_32x32x16_bf16 v[96:111], a[4:7], v[24:27], v[96:111]
    v_add_f32 v36, s42, v216
    v_rcp_f32 v36, v36
    s_nop 0
    v_mul_f32 v208, v208, v36
    v_mul_f32 v209, v209, v36
    v_mul_f32 v210, v210, v36
    v_mul_f32 v211, v211, v36
    v_mul_f32 v212, v212, v36
    v_mul_f32 v213, v213, v36
    v_mul_f32 v214, v214, v36
    v_mul_f32 v215, v215, v36
    v_cvt_pk_bf16_f32 v32, v208, v209
    v_cvt_pk_bf16_f32 v33, v210, v211
    v_cvt_pk_bf16_f32 v34, v212, v213
    v_cvt_pk_bf16_f32 v35, v214, v215
    s_waitcnt vmcnt(14)
    v_mfma_f32_32x32x16_bf16 v[208:223], v[228:231], v[140:143], 0
    v_mfma_f32_32x32x16_bf16 v[80:95], a[0:3], v[32:35], v[80:95]
    v_mfma_f32_32x32x16_bf16 v[112:127], a[4:7], v[32:35], v[112:127]
    v_add_f32 v28, s42, v192
    v_rcp_f32 v28, v28
    s_nop 0
    v_mul_f32 v200, v200, v28
    v_mul_f32 v201, v201, v28
    v_mul_f32 v202, v202, v28
    v_mul_f32 v203, v203, v28
    v_mul_f32 v204, v204, v28
    v_mul_f32 v205, v205, v28
    v_mul_f32 v206, v206, v28
    v_mul_f32 v207, v207, v28
    v_cvt_pk_bf16_f32 v24, v200, v201
    v_cvt_pk_bf16_f32 v25, v202, v203
    v_cvt_pk_bf16_f32 v26, v204, v205
    v_cvt_pk_bf16_f32 v27, v206, v207
    s_waitcnt vmcnt(13)
    v_mfma_f32_32x32x16_bf16 v[192:207], v[232:235], v[144:147], 0
    ds_read_b64_tr_b16 a[0:1], v8 offset:4096
    ds_read_b64_tr_b16 a[2:3], v8 offset:5120
    ds_read_b64_tr_b16 a[4:5], v9 offset:4096
    ds_read_b64_tr_b16 a[6:7], v9 offset:5120
    s_waitcnt lgkmcnt(8)
    v_mfma_f32_32x32x16_bf16 v[64:79], a[8:11], v[24:27], v[64:79]
    v_mfma_f32_32x32x16_bf16 v[96:111], a[12:15], v[24:27], v[96:111]
    v_add_f32 v36, s42, v208
    v_rcp_f32 v36, v36
    s_nop 0
    v_mul_f32 v216, v216, v36
    v_mul_f32 v217, v217, v36
    v_mul_f32 v218, v218, v36
    v_mul_f32 v219, v219, v36
    v_mul_f32 v220, v220, v36
    v_mul_f32 v221, v221, v36
    v_mul_f32 v222, v222, v36
    v_mul_f32 v223, v223, v36
    v_cvt_pk_bf16_f32 v32, v216, v217
    v_cvt_pk_bf16_f32 v33, v218, v219
    v_cvt_pk_bf16_f32 v34, v220, v221
    v_cvt_pk_bf16_f32 v35, v222, v223
    s_waitcnt vmcnt(12)
    v_mfma_f32_32x32x16_bf16 v[208:223], v[232:235], v[148:151], 0
    v_mfma_f32_32x32x16_bf16 v[80:95], a[8:11], v[32:35], v[80:95]
    v_mfma_f32_32x32x16_bf16 v[112:127], a[12:15], v[32:35], v[112:127]
    v_add_f32 v28, s42, v200
    v_rcp_f32 v28, v28
    s_nop 0
    v_mul_f32 v192, v192, v28
    v_mul_f32 v193, v193, v28
    v_mul_f32 v194, v194, v28
    v_mul_f32 v195, v195, v28
    v_mul_f32 v196, v196, v28
    v_mul_f32 v197, v197, v28
    v_mul_f32 v198, v198, v28
    v_mul_f32 v199, v199, v28
    v_cvt_pk_bf16_f32 v24, v192, v193
    v_cvt_pk_bf16_f32 v25, v194, v195
    v_cvt_pk_bf16_f32 v26, v196, v197
    v_cvt_pk_bf16_f32 v27, v198, v199
    s_waitcnt vmcnt(11)
    v_mfma_f32_32x32x16_bf16 v[192:207], v[236:239], v[152:155], 0
    ds_read_b64_tr_b16 a[8:9], v10 offset:16384
    ds_read_b64_tr_b16 a[10:11], v10 offset:17408
    ds_read_b64_tr_b16 a[12:13], v11 offset:16384
    ds_read_b64_tr_b16 a[14:15], v11 offset:17408
    s_waitcnt lgkmcnt(8)
    v_mfma_f32_32x32x16_bf16 v[64:79], a[16:19], v[24:27], v[64:79]
    v_mfma_f32_32x32x16_bf16 v[96:111], a[20:23], v[24:27], v[96:111]
    v_add_f32 v36, s42, v216
    v_rcp_f32 v36, v36
    s_nop 0
    v_mul_f32 v208, v208, v36
    v_mul_f32 v209, v209, v36
    v_mul_f32 v210, v210, v36
    v_mul_f32 v211, v211, v36
    v_mul_f32 v212, v212, v36
    v_mul_f32 v213, v213, v36
    v_mul_f32 v214, v214, v36
    v_mul_f32 v215, v215, v36
    v_cvt_pk_bf16_f32 v32, v208, v209
    v_cvt_pk_bf16_f32 v33, v210, v211
    v_cvt_pk_bf16_f32 v34, v212, v213
    v_cvt_pk_bf16_f32 v35, v214, v215
    s_waitcnt vmcnt(10)
    v_mfma_f32_32x32x16_bf16 v[208:223], v[236:239], v[156:159], 0
    v_mfma_f32_32x32x16_bf16 v[80:95], a[16:19], v[32:35], v[80:95]
    v_mfma_f32_32x32x16_bf16 v[112:127], a[20:23], v[32:35], v[112:127]
    v_add_f32 v28, s42, v192
    v_rcp_f32 v28, v28
    s_nop 0
    v_mul_f32 v200, v200, v28
    v_mul_f32 v201, v201, v28
    v_mul_f32 v202, v202, v28
    v_mul_f32 v203, v203, v28
    v_mul_f32 v204, v204, v28
    v_mul_f32 v205, v205, v28
    v_mul_f32 v206, v206, v28
    v_mul_f32 v207, v207, v28
    v_cvt_pk_bf16_f32 v24, v200, v201
    v_cvt_pk_bf16_f32 v25, v202, v203
    v_cvt_pk_bf16_f32 v26, v204, v205
    v_cvt_pk_bf16_f32 v27, v206, v207
    s_waitcnt vmcnt(9)
    v_mfma_f32_32x32x16_bf16 v[192:207], v[240:243], v[160:163], 0
    ds_read_b64_tr_b16 a[16:17], v10 offset:18432
    ds_read_b64_tr_b16 a[18:19], v10 offset:19456
    ds_read_b64_tr_b16 a[20:21], v11 offset:18432
    ds_read_b64_tr_b16 a[22:23], v11 offset:19456
    s_waitcnt lgkmcnt(8)
    v_mfma_f32_32x32x16_bf16 v[64:79], a[0:3], v[24:27], v[64:79]
    v_mfma_f32_32x32x16_bf16 v[96:111], a[4:7], v[24:27], v[96:111]
    v_add_f32 v36, s42, v208
    v_rcp_f32 v36, v36
    s_nop 0
    v_mul_f32 v216, v216, v36
    v_mul_f32 v217, v217, v36
    v_mul_f32 v218, v218, v36
    v_mul_f32 v219, v219, v36
    v_mul_f32 v220, v220, v36
    v_mul_f32 v221, v221, v36
    v_mul_f32 v222, v222, v36
    v_mul_f32 v223, v223, v36
    v_cvt_pk_bf16_f32 v32, v216, v217
    v_cvt_pk_bf16_f32 v33, v218, v219
    v_cvt_pk_bf16_f32 v34, v220, v221
    v_cvt_pk_bf16_f32 v35, v222, v223
    s_waitcnt vmcnt(8)
    v_mfma_f32_32x32x16_bf16 v[208:223], v[240:243], v[164:167], 0
    v_mfma_f32_32x32x16_bf16 v[80:95], a[0:3], v[32:35], v[80:95]
    v_mfma_f32_32x32x16_bf16 v[112:127], a[4:7], v[32:35], v[112:127]
    v_add_f32 v28, s42, v200
    v_rcp_f32 v28, v28
    s_nop 0
    v_mul_f32 v192, v192, v28
    v_mul_f32 v193, v193, v28
    v_mul_f32 v194, v194, v28
    v_mul_f32 v195, v195, v28
    v_mul_f32 v196, v196, v28
    v_mul_f32 v197, v197, v28
    v_mul_f32 v198, v198, v28
    v_mul_f32 v199, v199, v28
    v_cvt_pk_bf16_f32 v24, v192, v193
    v_cvt_pk_bf16_f32 v25, v194, v195
    v_cvt_pk_bf16_f32 v26, v196, v197
    v_cvt_pk_bf16_f32 v27, v198, v199
    s_waitcnt vmcnt(5)
    v_mfma_f32_32x32x16_bf16 v[192:207], v[244:247], v[168:171], 0
    ds_read_b64_tr_b16 a[0:1], v10 offset:20480
    ds_read_b64_tr_b16 a[2:3], v10 offset:21504
    ds_read_b64_tr_b16 a[4:5], v11 offset:20480
    ds_read_b64_tr_b16 a[6:7], v11 offset:21504
    s_waitcnt lgkmcnt(8)
    v_mfma_f32_32x32x16_bf16 v[64:79], a[8:11], v[24:27], v[64:79]
    v_mfma_f32_32x32x16_bf16 v[96:111], a[12:15], v[24:27], v[96:111]
    v_add_f32 v36, s42, v216
    v_rcp_f32 v36, v36
    s_nop 0
    v_mul_f32 v208, v208, v36
    v_mul_f32 v209, v209, v36
    v_mul_f32 v210, v210, v36
    v_mul_f32 v211, v211, v36
    v_mul_f32 v212, v212, v36
    v_mul_f32 v213, v213, v36
    v_mul_f32 v214, v214, v36
    v_mul_f32 v215, v215, v36
    v_cvt_pk_bf16_f32 v32, v208, v209
    v_cvt_pk_bf16_f32 v33, v210, v211
    v_cvt_pk_bf16_f32 v34, v212, v213
    v_cvt_pk_bf16_f32 v35, v214, v215
    s_waitcnt vmcnt(4)
    v_mfma_f32_32x32x16_bf16 v[208:223], v[244:247], v[172:175], 0
    v_mfma_f32_32x32x16_bf16 v[80:95], a[8:11], v[32:35], v[80:95]
    v_mfma_f32_32x32x16_bf16 v[112:127], a[12:15], v[32:35], v[112:127]
    v_add_f32 v28, s42, v192
    v_rcp_f32 v28, v28
    s_nop 0
    v_mul_f32 v200, v200, v28
    v_mul_f32 v201, v201, v28
    v_mul_f32 v202, v202, v28
    v_mul_f32 v203, v203, v28
    v_mul_f32 v204, v204, v28
    v_mul_f32 v205, v205, v28
    v_mul_f32 v206, v206, v28
    v_mul_f32 v207, v207, v28
    v_cvt_pk_bf16_f32 v24, v200, v201
    v_cvt_pk_bf16_f32 v25, v202, v203
    v_cvt_pk_bf16_f32 v26, v204, v205
    v_cvt_pk_bf16_f32 v27, v206, v207
    s_waitcnt vmcnt(3)
    v_mfma_f32_32x32x16_bf16 v[192:207], v[248:251], v[176:179], 0
    ds_read_b64_tr_b16 a[8:9], v10 offset:22528
    ds_read_b64_tr_b16 a[10:11], v10 offset:23552
    ds_read_b64_tr_b16 a[12:13], v11 offset:22528
    ds_read_b64_tr_b16 a[14:15], v11 offset:23552
    s_waitcnt lgkmcnt(8)
    v_mfma_f32_32x32x16_bf16 v[64:79], a[16:19], v[24:27], v[64:79]
    v_mfma_f32_32x32x16_bf16 v[96:111], a[20:23], v[24:27], v[96:111]
    v_add_f32 v36, s42, v208
    v_rcp_f32 v36, v36
    s_nop 0
    v_mul_f32 v216, v216, v36
    v_mul_f32 v217, v217, v36
    v_mul_f32 v218, v218, v36
    v_mul_f32 v219, v219, v36
    v_mul_f32 v220, v220, v36
    v_mul_f32 v221, v221, v36
    v_mul_f32 v222, v222, v36
    v_mul_f32 v223, v223, v36
    v_cvt_pk_bf16_f32 v32, v216, v217
    v_cvt_pk_bf16_f32 v33, v218, v219
    v_cvt_pk_bf16_f32 v34, v220, v221
    v_cvt_pk_bf16_f32 v35, v222, v223
    s_waitcnt vmcnt(2)
    v_mfma_f32_32x32x16_bf16 v[208:223], v[248:251], v[180:183], 0
    v_mfma_f32_32x32x16_bf16 v[80:95], a[16:19], v[32:35], v[80:95]
    v_mfma_f32_32x32x16_bf16 v[112:127], a[20:23], v[32:35], v[112:127]
    v_add_f32 v28, s42, v200
    v_rcp_f32 v28, v28
    s_nop 0
    v_mul_f32 v192, v192, v28
    v_mul_f32 v193, v193, v28
    v_mul_f32 v194, v194, v28
    v_mul_f32 v195, v195, v28
    v_mul_f32 v196, v196, v28
    v_mul_f32 v197, v197, v28
    v_mul_f32 v198, v198, v28
    v_mul_f32 v199, v199, v28
    v_cvt_pk_bf16_f32 v24, v192, v193
    v_cvt_pk_bf16_f32 v25, v194, v195
    v_cvt_pk_bf16_f32 v26, v196, v197
    v_cvt_pk_bf16_f32 v27, v198, v199
    s_waitcnt vmcnt(1)
    v_mfma_f32_32x32x16_bf16 v[192:207], v[252:255], v[184:187], 0
    s_waitcnt lgkmcnt(4)
    v_mfma_f32_32x32x16_bf16 v[64:79], a[0:3], v[24:27], v[64:79]
    v_mfma_f32_32x32x16_bf16 v[96:111], a[4:7], v[24:27], v[96:111]
    v_add_f32 v36, s42, v216
    v_rcp_f32 v36, v36
    s_nop 0
    v_mul_f32 v208, v208, v36
    v_mul_f32 v209, v209, v36
    v_mul_f32 v210, v210, v36
    v_mul_f32 v211, v211, v36
    v_mul_f32 v212, v212, v36
    v_mul_f32 v213, v213, v36
    v_mul_f32 v214, v214, v36
    v_mul_f32 v215, v215, v36
    v_cvt_pk_bf16_f32 v32, v208, v209
    v_cvt_pk_bf16_f32 v33, v210, v211
    v_cvt_pk_bf16_f32 v34, v212, v213
    v_cvt_pk_bf16_f32 v35, v214, v215
    s_waitcnt vmcnt(0)
    v_mfma_f32_32x32x16_bf16 v[208:223], v[252:255], v[188:191], 0
    v_mfma_f32_32x32x16_bf16 v[80:95], a[0:3], v[32:35], v[80:95]
    v_mfma_f32_32x32x16_bf16 v[112:127], a[4:7], v[32:35], v[112:127]
    v_add_f32 v28, s42, v192
    v_rcp_f32 v28, v28
    s_nop 0
    v_mul_f32 v200, v200, v28
    v_mul_f32 v201, v201, v28
    v_mul_f32 v202, v202, v28
    v_mul_f32 v203, v203, v28
    v_mul_f32 v204, v204, v28
    v_mul_f32 v205, v205, v28
    v_mul_f32 v206, v206, v28
    v_mul_f32 v207, v207, v28
    v_cvt_pk_bf16_f32 v24, v200, v201
    v_cvt_pk_bf16_f32 v25, v202, v203
    v_cvt_pk_bf16_f32 v26, v204, v205
    v_cvt_pk_bf16_f32 v27, v206, v207
    s_waitcnt lgkmcnt(0)
    s_nop 0
    v_mfma_f32_32x32x16_bf16 v[64:79], a[8:11], v[24:27], v[64:79]
    v_mfma_f32_32x32x16_bf16 v[96:111], a[12:15], v[24:27], v[96:111]
    v_add_f32 v36, s42, v208
    v_rcp_f32 v36, v36
    s_nop 0
    v_mul_f32 v216, v216, v36
    v_mul_f32 v217, v217, v36
    v_mul_f32 v218, v218, v36
    v_mul_f32 v219, v219, v36
    v_mul_f32 v220, v220, v36
    v_mul_f32 v221, v221, v36
    v_mul_f32 v222, v222, v36
    v_mul_f32 v223, v223, v36
    v_cvt_pk_bf16_f32 v32, v216, v217
    v_cvt_pk_bf16_f32 v33, v218, v219
    v_cvt_pk_bf16_f32 v34, v220, v221
    v_cvt_pk_bf16_f32 v35, v222, v223
    s_nop 1
    v_mfma_f32_32x32x16_bf16 v[80:95], a[8:11], v[32:35], v[80:95]
    v_mfma_f32_32x32x16_bf16 v[112:127], a[12:15], v[32:35], v[112:127]
    s_waitcnt lgkmcnt(0)
    v_and_b32 v24, 31, v1
    v_mul_u32_u24 v24, 272, v24
    v_lshrrev_b32 v25, 5, v1
    v_lshl_add_u32 v24, v25, 4, v24
    v_add_u32 v24, s40, v24
    v_lshrrev_b32 v26, 3, v0
    v_mul_u32_u24 v26, 272, v26
    v_and_b32 v27, 7, v0
    v_lshl_add_u32 v26, v27, 5, v26
    v_add_u32 v27, 0x10000, v26
    s_nop 3
    ds_write_b128 v24, v[64:67] offset:0
    ds_write_b128 v24, v[68:71] offset:32
    ds_write_b128 v24, v[72:75] offset:64
    ds_write_b128 v24, v[76:79] offset:96
    ds_write_b128 v24, v[96:99] offset:128
    ds_write_b128 v24, v[100:103] offset:160
    ds_write_b128 v24, v[104:107] offset:192
    ds_write_b128 v24, v[108:111] offset:224
    ds_write_b128 v24, v[80:83] offset:8704
    ds_write_b128 v24, v[84:87] offset:8736
    ds_write_b128 v24, v[88:91] offset:8768
    ds_write_b128 v24, v[92:95] offset:8800
    ds_write_b128 v24, v[112:115] offset:8832
    ds_write_b128 v24, v[116:119] offset:8864
    ds_write_b128 v24, v[120:123] offset:8896
    ds_write_b128 v24, v[124:127] offset:8928
    s_waitcnt lgkmcnt(0)
    s_barrier
    ds_read_b128 v[128:131], v26 offset:0
    ds_read_b128 v[132:135], v26 offset:16
    ds_read_b128 v[136:139], v26 offset:32768
    ds_read_b128 v[140:143], v26 offset:32784
    ds_read_b128 v[144:147], v27 offset:0
    ds_read_b128 v[148:151], v27 offset:16
    ds_read_b128 v[152:155], v27 offset:32768
    ds_read_b128 v[156:159], v27 offset:32784
    ds_read_b128 v[160:163], v26 offset:8704
    ds_read_b128 v[164:167], v26 offset:8720
    ds_read_b128 v[168:171], v26 offset:41472
    ds_read_b128 v[172:175], v26 offset:41488
    ds_read_b128 v[176:179], v27 offset:8704
    ds_read_b128 v[180:183], v27 offset:8720
    ds_read_b128 v[184:187], v27 offset:41472
    ds_read_b128 v[188:191], v27 offset:41488
    s_waitcnt lgkmcnt(8)
    v_add_f32 v128, v128, v136
    v_add_f32 v129, v129, v137
    v_add_f32 v130, v130, v138
    v_add_f32 v131, v131, v139
    v_add_f32 v132, v132, v140
    v_add_f32 v133, v133, v141
    v_add_f32 v134, v134, v142
    v_add_f32 v135, v135, v143
    v_add_f32 v144, v144, v152
    v_add_f32 v145, v145, v153
    v_add_f32 v146, v146, v154
    v_add_f32 v147, v147, v155
    v_add_f32 v148, v148, v156
    v_add_f32 v149, v149, v157
    v_add_f32 v150, v150, v158
    v_add_f32 v151, v151, v159
    v_add_f32 v128, v128, v144
    v_add_f32 v129, v129, v145
    v_add_f32 v130, v130, v146
    v_add_f32 v131, v131, v147
    v_add_f32 v132, v132, v148
    v_add_f32 v133, v133, v149
    v_add_f32 v134, v134, v150
    v_add_f32 v135, v135, v151
    v_lshlrev_b32 v40, 16, v48
    v_and_b32 v41, 0xffff0000, v48
    v_add_f32 v128, v128, v40
    v_add_f32 v129, v129, v41
    v_cvt_pk_bf16_f32 v48, v128, v129
    v_lshlrev_b32 v40, 16, v49
    v_and_b32 v41, 0xffff0000, v49
    v_add_f32 v130, v130, v40
    v_add_f32 v131, v131, v41
    v_cvt_pk_bf16_f32 v49, v130, v131
    v_lshlrev_b32 v40, 16, v50
    v_and_b32 v41, 0xffff0000, v50
    v_add_f32 v132, v132, v40
    v_add_f32 v133, v133, v41
    v_cvt_pk_bf16_f32 v50, v132, v133
    v_lshlrev_b32 v40, 16, v51
    v_and_b32 v41, 0xffff0000, v51
    v_add_f32 v134, v134, v40
    v_add_f32 v135, v135, v41
    v_cvt_pk_bf16_f32 v51, v134, v135
    buffer_store_dwordx4 v[48:51], v46, s[32:35], s52 offen
    s_waitcnt lgkmcnt(0)
    v_add_f32 v160, v160, v168
    v_add_f32 v161, v161, v169
    v_add_f32 v162, v162, v170
    v_add_f32 v163, v163, v171
    v_add_f32 v164, v164, v172
    v_add_f32 v165, v165, v173
    v_add_f32 v166, v166, v174
    v_add_f32 v167, v167, v175
    v_add_f32 v176, v176, v184
    v_add_f32 v177, v177, v185
    v_add_f32 v178, v178, v186
    v_add_f32 v179, v179, v187
    v_add_f32 v180, v180, v188
    v_add_f32 v181, v181, v189
    v_add_f32 v182, v182, v190
    v_add_f32 v183, v183, v191
    v_add_f32 v160, v160, v176
    v_add_f32 v161, v161, v177
    v_add_f32 v162, v162, v178
    v_add_f32 v163, v163, v179
    v_add_f32 v164, v164, v180
    v_add_f32 v165, v165, v181
    v_add_f32 v166, v166, v182
    v_add_f32 v167, v167, v183
    v_lshlrev_b32 v40, 16, v52
    v_and_b32 v41, 0xffff0000, v52
    v_add_f32 v160, v160, v40
    v_add_f32 v161, v161, v41
    v_cvt_pk_bf16_f32 v52, v160, v161
    v_lshlrev_b32 v40, 16, v53
    v_and_b32 v41, 0xffff0000, v53
    v_add_f32 v162, v162, v40
    v_add_f32 v163, v163, v41
    v_cvt_pk_bf16_f32 v53, v162, v163
    v_lshlrev_b32 v40, 16, v54
    v_and_b32 v41, 0xffff0000, v54
    v_add_f32 v164, v164, v40
    v_add_f32 v165, v165, v41
    v_cvt_pk_bf16_f32 v54, v164, v165
    v_lshlrev_b32 v40, 16, v55
    v_and_b32 v41, 0xffff0000, v55
    v_add_f32 v166, v166, v40
    v_add_f32 v167, v167, v41
    v_cvt_pk_bf16_f32 v55, v166, v167
    buffer_store_dwordx4 v[52:55], v46, s[32:35], s54 offen
    s_or_b32 s58, s2, s36
    s_cmp_lg_u32 s58, 0
    s_cbranch_scc1 L_ns9
    v_mov_b32 v28, s60
    v_mov_b32 v29, 0
    s_mov_b32 s58, 0xc30000
    s_mov_b64 exec, 1
    buffer_store_dword v28, v29, s[20:23], s58 offen sc1
L_ns9:
    s_branch L_end
L_cd:
    s_mov_b32 s3, s54
    s_add_u32 m0, s40, 0
    s_add_u32 s99, s99, 1
    s_and_b32 s99, s99, 7
    s_movk_i32 s100, 128
    s_cmp_eq_u32 s99, 0
    s_cselect_b32 s100, 0xfffffc80, s100
    buffer_load_dwordx4 v72, s[4:7], s98 offen lds
    buffer_load_dwordx4 v73, s[4:7], s98 offen offset:1024 lds
    buffer_load_dwordx4 v74, s[4:7], s98 offen offset:2048 lds
    buffer_load_dwordx4 v75, s[4:7], s98 offen offset:3072 lds
    v_add_u32 v72, s100, v72
    v_add_u32 v73, s100, v73
    v_add_u32 v74, s100, v74
    v_add_u32 v75, s100, v75
    s_add_u32 m0, s40, 4096
    s_add_u32 s99, s99, 1
    s_and_b32 s99, s99, 7
    s_movk_i32 s100, 128
    s_cmp_eq_u32 s99, 0
    s_cselect_b32 s100, 0xfffffc80, s100
    buffer_load_dwordx4 v72, s[4:7], s98 offen lds
    buffer_load_dwordx4 v73, s[4:7], s98 offen offset:1024 lds
    buffer_load_dwordx4 v74, s[4:7], s98 offen offset:2048 lds
    buffer_load_dwordx4 v75, s[4:7], s98 offen offset:3072 lds
    v_add_u32 v72, s100, v72
    v_add_u32 v73, s100, v73
    v_add_u32 v74, s100, v74
    v_add_u32 v75, s100, v75
    s_add_u32 m0, s40, 8192
    s_add_u32 s99, s99, 1
    s_and_b32 s99, s99, 7
    s_movk_i32 s100, 128
    s_cmp_eq_u32 s99, 0
    s_cselect_b32 s100, 0xfffffc80, s100
    buffer_load_dwordx4 v72, s[4:7], s98 offen lds
    buffer_load_dwordx4 v73, s[4:7], s98 offen offset:1024 lds
    buffer_load_dwordx4 v74, s[4:7], s98 offen offset:2048 lds
    buffer_load_dwordx4 v75, s[4:7], s98 offen offset:3072 lds
    v_add_u32 v72, s100, v72
    v_add_u32 v73, s100, v73
    v_add_u32 v74, s100, v74
    v_add_u32 v75, s100, v75
    s_add_u32 m0, s40, 12288
    s_add_u32 s99, s99, 1
    s_and_b32 s99, s99, 7
    s_movk_i32 s100, 128
    s_cmp_eq_u32 s99, 0
    s_cselect_b32 s100, 0xfffffc80, s100
    buffer_load_dwordx4 v72, s[4:7], s98 offen lds
    buffer_load_dwordx4 v73, s[4:7], s98 offen offset:1024 lds
    buffer_load_dwordx4 v74, s[4:7], s98 offen offset:2048 lds
    buffer_load_dwordx4 v75, s[4:7], s98 offen offset:3072 lds
    v_add_u32 v72, s100, v72
    v_add_u32 v73, s100, v73
    v_add_u32 v74, s100, v74
    v_add_u32 v75, s100, v75
    s_waitcnt vmcnt(18)
    v_mov_b32 v28, 0
    v_mov_b32 v29, 0
    v_dot2_f32_bf16 v28, v32, s43, v28
    v_dot2_f32_bf16 v29, v32, v32, v29
    v_dot2_f32_bf16 v28, v33, s43, v28
    v_dot2_f32_bf16 v29, v33, v33, v29
    v_dot2_f32_bf16 v28, v34, s43, v28
    v_dot2_f32_bf16 v29, v34, v34, v29
    v_dot2_f32_bf16 v28, v35, s43, v28
    v_dot2_f32_bf16 v29, v35, v35, v29
    v_dot2_f32_bf16 v28, v36, s43, v28
    v_dot2_f32_bf16 v29, v36, v36, v29
    v_dot2_f32_bf16 v28, v37, s43, v28
    v_dot2_f32_bf16 v29, v37, v37, v29
    v_dot2_f32_bf16 v28, v38, s43, v28
    v_dot2_f32_bf16 v29, v38, v38, v29
    v_dot2_f32_bf16 v28, v39, s43, v28
    v_dot2_f32_bf16 v29, v39, v39, v29
    s_nop 1
    v_add_f32_dpp v28, v28, v28 row_ror:8 row_mask:0xf bank_mask:0xf
    v_add_f32_dpp v29, v29, v29 row_ror:8 row_mask:0xf bank_mask:0xf
    s_nop 1
    v_add_f32_dpp v28, v28, v28 row_ror:4 row_mask:0xf bank_mask:0xf
    v_add_f32_dpp v29, v29, v29 row_ror:4 row_mask:0xf bank_mask:0xf
    s_nop 1
    v_add_f32_dpp v28, v28, v28 row_ror:2 row_mask:0xf bank_mask:0xf
    v_add_f32_dpp v29, v29, v29 row_ror:2 row_mask:0xf bank_mask:0xf
    s_nop 1
    v_add_f32_dpp v28, v28, v28 row_ror:1 row_mask:0xf bank_mask:0xf
    v_add_f32_dpp v29, v29, v29 row_ror:1 row_mask:0xf bank_mask:0xf
    v_mov_b32 v30, v28
    v_mov_b32 v31, v29
    s_nop 1
    v_permlane16_swap_b32 v28, v30
    v_permlane16_swap_b32 v29, v31
    s_nop 1
    v_add_f32 v28, v28, v30
    v_add_f32 v29, v29, v31
    v_mul_f32 v28, 0x3b000000, v28
    v_mul_f32 v29, 0x3b000000, v29
    v_fma_f32 v29, -v28, v28, v29
    v_max_f32 v29, 0, v29
    v_add_f32 v29, 0x3727c5ac, v29
    v_rsq_f32 v29, v29
    s_nop 0
    v_mul_f32 v28, v28, v29
    v_sub_f32 v28, 0, v28
    s_waitcnt vmcnt(17)
    v_add_u32 v27, 64, v27
    v_or_b32 v27, 1, v27
    v_mov_b32 v40, v29
    v_mov_b32 v41, v27
    v_mov_b32 v42, v28
    v_mov_b32 v43, v27
    v_lshrrev_b32 v30, 5, v1
    v_lshlrev_b32 v30, 4, v30
    v_readfirstlane_b32 s60, v27
    s_mov_b64 s[94:95], exec
    s_mov_b32 exec_lo, 1
    s_mov_b32 exec_hi, 1
    buffer_store_dwordx4 v[40:43], v30, s[20:23], s3 offen sc1
    s_mov_b64 exec, s[94:95]
    s_add_u32 m0, s40, 16384
    s_add_u32 s99, s99, 1
    s_and_b32 s99, s99, 7
    s_movk_i32 s100, 128
    s_cmp_eq_u32 s99, 0
    s_cselect_b32 s100, 0xfffffc80, s100
    buffer_load_dwordx4 v72, s[4:7], s98 offen lds
    buffer_load_dwordx4 v73, s[4:7], s98 offen offset:1024 lds
    buffer_load_dwordx4 v74, s[4:7], s98 offen offset:2048 lds
    buffer_load_dwordx4 v75, s[4:7], s98 offen offset:3072 lds
    v_add_u32 v72, s100, v72
    v_add_u32 v73, s100, v73
    v_add_u32 v74, s100, v74
    v_add_u32 v75, s100, v75
    v_lshrrev_b32 v40, 3, v1
    v_lshrrev_b32 v42, 2, v1
    v_and_b32 v42, 4, v42
    v_and_b32 v41, 7, v1
    v_xor_b32 v41, v41, v42
    v_lshlrev_b32 v41, 4, v41
    v_lshl_add_u32 v3, v40, 10, v41
    s_movk_i32 s58, 3072
    s_movk_i32 s59, 3584
    s_mul_i32 s66, s97, 196608
    s_mul_i32 s64, s97, 229376
    v_mad_u32_u24 v4, v40, s59, v41
    v_add_u32 v4, s64, v4
    v_xor_b32 v5, 32, v4
    v_lshrrev_b32 v40, 2, v1
    v_and_b32 v41, 3, v1
    v_lshlrev_b32 v41, 4, v41
    v_mad_u32_u24 v6, v40, s59, v41
    v_add_u32 v6, s64, v6
    v_xor_b32 v7, 32, v6
    s_mul_i32 s58, s36, 49152
    s_mul_i32 s59, s36, 57344
    s_lshl_b32 s65, s37, 2
    s_add_u32 s65, s65, s36
    s_mul_i32 s52, s65, 114688
    s_lshl_b32 s55, s65, 15
    s_add_u32 s55, s55, 0x800000
    s_mul_i32 s57, s39, 7
    s_sub_u32 s58, s38, 2
    s_mul_i32 s49, s58, 3
    s_add_u32 s49, s49, s57
    s_add_u32 s49, s49, 2
    s_add_u32 s48, s57, 4
    s_lshl_b32 s53, s48, 12
    s_lshl_b32 s47, s58, 11
    s_add_u32 s53, s53, s47
    s_add_u32 s53, s53, s52
    s_lshl_b32 s47, s49, 12
    s_add_u32 s54, s47, 4096
    s_add_u32 m0, s40, 20480
    s_add_u32 s99, s99, 1
    s_and_b32 s99, s99, 7
    s_movk_i32 s100, 128
    s_cmp_eq_u32 s99, 0
    s_cselect_b32 s100, 0xfffffc80, s100
    buffer_load_dwordx4 v72, s[4:7], s98 offen lds
    buffer_load_dwordx4 v73, s[4:7], s98 offen offset:1024 lds
    buffer_load_dwordx4 v74, s[4:7], s98 offen offset:2048 lds
    buffer_load_dwordx4 v75, s[4:7], s98 offen offset:3072 lds
    v_add_u32 v72, s100, v72
    v_add_u32 v73, s100, v73
    v_add_u32 v74, s100, v74
    v_add_u32 v75, s100, v75
    s_add_u32 s54, s54, s52
    s_add_u32 s52, s52, s47
    s_lshl_b32 s46, s48, 7
    s_lshl_b32 s58, s58, 6
    s_add_u32 s46, s46, s58
    s_add_u32 s46, s46, s59
    s_lshl_b32 s44, s49, 7
    s_add_u32 s44, s44, s59
    s_add_u32 s45, s44, 27648
    s_add_u32 s50, s44, 128
    s_add_u32 s51, s45, 128
    s_mul_i32 s63, s36, 458752
    s_lshl_b32 s57, s62, 7
    s_add_u32 s63, s63, s57
    s_and_b32 s58, s61, 3
    s_lshl_b32 s58, s58, 3
    s_sub_u32 s101, 28, s58
    s_lshl_b32 s58, s58, 14
    v_add_u32 v3, s58, v3
    s_add_u32 s64, s63, 7168
    s_lshl_b32 s65, s36, 17
    s_add_u32 s65, s65, s57
    s_add_u32 s66, s65, 7168
    v_lshrrev_b32 v47, 5, v1
    v_lshlrev_b32 v40, 3, v47
    v_bfe_u32 v41, v1, 2, 2
    v_add_u32 v40, v40, v41
    v_lshl_add_u32 v47, v47, 2, v41
    v_bfe_u32 v41, v1, 4, 1
    v_bfe_u32 v42, v1, 1, 1
    v_bfe_u32 v43, v1, 3, 1
    v_and_b32 v44, 1, v1
    v_lshlrev_b32 v44, 3, v44
    v_add_u32 v45, 0, v42
    v_lshlrev_b32 v46, 2, v43
    v_xor_b32 v45, v45, v46
    v_lshlrev_b32 v46, 1, v41
    v_xor_b32 v45, v45, v46
    v_lshl_add_u32 v45, v45, 4, v44
    v_lshl_add_u32 v45, v40, 7, v45
    s_add_u32 m0, s40, 24576
    s_add_u32 s99, s99, 1
    s_and_b32 s99, s99, 7
    s_movk_i32 s100, 128
    s_cmp_eq_u32 s99, 0
    s_cselect_b32 s100, 0xfffffc80, s100
    buffer_load_dwordx4 v72, s[4:7], s98 offen lds
    buffer_load_dwordx4 v73, s[4:7], s98 offen offset:1024 lds
    buffer_load_dwordx4 v74, s[4:7], s98 offen offset:2048 lds
    buffer_load_dwordx4 v75, s[4:7], s98 offen offset:3072 lds
    v_add_u32 v72, s100, v72
    v_add_u32 v73, s100, v73
    v_add_u32 v74, s100, v74
    v_add_u32 v75, s100, v75
    v_lshl_add_u32 v12, v41, 11, v45
    v_add_u32 v13, 0x10000, v12
    v_add_u32 v64, 0x20000, v12
    v_add_u32 v45, 2, v42
    v_lshlrev_b32 v46, 2, v43
    v_xor_b32 v45, v45, v46
    v_lshlrev_b32 v46, 1, v41
    v_xor_b32 v45, v45, v46
    v_lshl_add_u32 v45, v45, 4, v44
    v_lshl_add_u32 v45, v40, 7, v45
    v_lshl_add_u32 v14, v41, 11, v45
    v_add_u32 v15, 0x10000, v14
    v_add_u32 v65, 0x20000, v14
    v_add_u32 v45, 4, v42
    v_lshlrev_b32 v46, 2, v43
    v_xor_b32 v45, v45, v46
    v_lshlrev_b32 v46, 1, v41
    v_xor_b32 v45, v45, v46
    v_lshl_add_u32 v45, v45, 4, v44
    v_lshl_add_u32 v45, v40, 7, v45
    v_lshl_add_u32 v16, v41, 11, v45
    v_add_u32 v17, 0x10000, v16
    v_add_u32 v66, 0x20000, v16
    v_add_u32 v45, 6, v42
    v_lshlrev_b32 v46, 2, v43
    v_xor_b32 v45, v45, v46
    v_lshlrev_b32 v46, 1, v41
    v_xor_b32 v45, v45, v46
    v_lshl_add_u32 v45, v45, 4, v44
    v_lshl_add_u32 v45, v40, 7, v45
    v_lshl_add_u32 v18, v41, 11, v45
    v_add_u32 v19, 0x10000, v18
    v_add_u32 v67, 0x20000, v18
    v_add_u32 v45, 0, v42
    v_lshlrev_b32 v46, 1, v41
    v_xor_b32 v45, v45, v46
    v_lshl_add_u32 v45, v45, 4, v44
    v_lshl_add_u32 v45, v40, 6, v45
    v_lshl_add_u32 v20, v41, 10, v45
    s_add_u32 m0, s40, 28672
    s_add_u32 s99, s99, 1
    s_and_b32 s99, s99, 7
    s_movk_i32 s100, 128
    s_cmp_eq_u32 s99, 0
    s_cselect_b32 s100, 0xfffffc80, s100
    buffer_load_dwordx4 v72, s[4:7], s98 offen lds
    buffer_load_dwordx4 v73, s[4:7], s98 offen offset:1024 lds
    buffer_load_dwordx4 v74, s[4:7], s98 offen offset:2048 lds
    buffer_load_dwordx4 v75, s[4:7], s98 offen offset:3072 lds
    v_add_u32 v21, 0x10000, v20
    v_add_u32 v68, 0x20000, v20
    v_add_u32 v45, 2, v42
    v_lshlrev_b32 v46, 1, v41
    v_xor_b32 v45, v45, v46
    v_lshl_add_u32 v45, v45, 4, v44
    v_lshl_add_u32 v45, v40, 6, v45
    v_lshl_add_u32 v22, v41, 10, v45
    v_add_u32 v23, 0x10000, v22
    v_add_u32 v69, 0x20000, v22
    v_lshl_add_u32 v45, v41, 1, v42
    v_lshlrev_b32 v46, 2, v43
    v_xor_b32 v46, 0, v46
    v_add_u32 v45, v45, v46
    v_lshl_add_u32 v45, v45, 4, v44
    v_lshl_add_u32 v8, v47, 7, v45
    v_lshl_add_u32 v45, v41, 1, v42
    v_lshlrev_b32 v46, 2, v43
    v_xor_b32 v46, 4, v46
    v_add_u32 v45, v45, v46
    v_lshl_add_u32 v45, v45, 4, v44
    v_lshl_add_u32 v9, v47, 7, v45
    v_add_u32 v10, s40, v8
    v_add_u32 v11, s40, v9
    v_add_u32 v8, s68, v8
    v_add_u32 v9, s68, v9
    v_and_b32 v40, 31, v1
    v_lshrrev_b32 v41, 5, v1
    v_bfe_u32 v42, v1, 1, 3
    v_xor_b32 v41, v41, v42
    v_lshlrev_b32 v40, 7, v40
    v_add_u32 v40, s40, v40
    v_xor_b32 v42, 0, v41
    v_lshl_add_u32 v76, v42, 4, v40
    v_xor_b32 v42, 2, v41
    v_lshl_add_u32 v77, v42, 4, v40
    v_xor_b32 v42, 4, v41
    v_lshl_add_u32 v78, v42, 4, v40
    v_xor_b32 v42, 6, v41
    v_lshl_add_u32 v79, v42, 4, v40
    s_mul_i32 s59, s36, 6144
    s_add_u32 s59, s59, 131072
    s_add_u32 m0, s59, 0
    s_cmp_eq_u32 s69, 0
    s_cselect_b32 s92, s91, s90
    buffer_load_dwordx4 v4, s[12:15], s44 offen lds
    buffer_load_dwordx4 v4, s[12:15], s45 offen offset:1024 lds
    v_add_u32 v4, s92, v4
    s_add_u32 m0, s59, 2048
    s_nop 0
    buffer_load_dwordx4 v5, s[16:19], s44 offen lds
    buffer_load_dwordx4 v5, s[16:19], s45 offen offset:1024 lds
    v_add_u32 v5, s92, v5
    s_add_u32 m0, s59, 4096
    s_nop 0
    buffer_load_dwordx4 v6, s[12:15], s46 offen lds
    v_add_u32 v6, s92, v6
    s_add_u32 m0, s59, 5120
    s_nop 0
    buffer_load_dwordx4 v7, s[16:19], s46 offen lds
    v_add_u32 v7, s92, v7
    v_and_b32 v36, 31, v1
    v_lshlrev_b32 v36, 4, v36
    s_lshr_b32 s58, s98, 6
    s_add_u32 s58, s58, 0xd00000
    s_mov_b32 s99, s58
    buffer_load_dwordx4 v[32:35], v36, s[20:23], s99 offen sc1
    s_waitcnt vmcnt(36)
    ds_read_b128 v[128:131], v76 offset:0
    ds_read_b128 v[132:135], v77 offset:0
    ds_read_b128 v[136:139], v78 offset:0
    ds_read_b128 v[140:143], v79 offset:0
    s_waitcnt vmcnt(32)
    ds_read_b128 v[144:147], v76 offset:4096
    ds_read_b128 v[148:151], v77 offset:4096
    ds_read_b128 v[152:155], v78 offset:4096
    ds_read_b128 v[156:159], v79 offset:4096
    s_waitcnt vmcnt(28)
    ds_read_b128 v[160:163], v76 offset:8192
    ds_read_b128 v[164:167], v77 offset:8192
    ds_read_b128 v[168:171], v78 offset:8192
    ds_read_b128 v[172:175], v79 offset:8192
    s_waitcnt vmcnt(24)
    ds_read_b128 v[176:179], v76 offset:12288
    ds_read_b128 v[180:183], v77 offset:12288
    ds_read_b128 v[184:187], v78 offset:12288
    ds_read_b128 v[188:191], v79 offset:12288
    s_waitcnt vmcnt(19)
    ds_read_b128 v[192:195], v76 offset:16384
    ds_read_b128 v[196:199], v77 offset:16384
    ds_read_b128 v[200:203], v78 offset:16384
    ds_read_b128 v[204:207], v79 offset:16384
    s_waitcnt vmcnt(15)
    ds_read_b128 v[208:211], v76 offset:20480
    ds_read_b128 v[212:215], v77 offset:20480
    ds_read_b128 v[216:219], v78 offset:20480
    ds_read_b128 v[220:223], v79 offset:20480
    s_waitcnt vmcnt(11)
    ds_read_b128 v[224:227], v76 offset:24576
    ds_read_b128 v[228:231], v77 offset:24576
    ds_read_b128 v[232:235], v78 offset:24576
    ds_read_b128 v[236:239], v79 offset:24576
    s_waitcnt vmcnt(7)
    ds_read_b128 v[240:243], v76 offset:28672
    ds_read_b128 v[244:247], v77 offset:28672
    ds_read_b128 v[248:251], v78 offset:28672
    ds_read_b128 v[252:255], v79 offset:28672
    s_waitcnt lgkmcnt(0)
    s_add_u32 m0, s40, 0
    s_cmp_eq_u32 s69, 1
    s_cselect_b32 s92, s91, s90
    buffer_load_dwordx4 v4, s[12:15], s44 offen lds
    buffer_load_dwordx4 v4, s[12:15], s45 offen offset:1024 lds
    v_add_u32 v4, s92, v4
    s_add_u32 m0, s40, 2048
    s_nop 0
    buffer_load_dwordx4 v5, s[16:19], s44 offen lds
    buffer_load_dwordx4 v5, s[16:19], s45 offen offset:1024 lds
    v_add_u32 v5, s92, v5
    s_add_u32 m0, s40, 4096
    s_nop 0
    buffer_load_dwordx4 v6, s[12:15], s46 offen lds
    v_add_u32 v6, s92, v6
    s_add_u32 m0, s40, 5120
    s_nop 0
    buffer_load_dwordx4 v7, s[16:19], s46 offen lds
    v_add_u32 v7, s92, v7
    s_add_u32 m0, s40, 6144
    s_cmp_eq_u32 s69, 2
    s_cselect_b32 s92, s91, s90
    buffer_load_dwordx4 v4, s[12:15], s44 offen lds
    buffer_load_dwordx4 v4, s[12:15], s45 offen offset:1024 lds
    v_add_u32 v4, s92, v4
    s_add_u32 m0, s40, 8192
    s_nop 0
    buffer_load_dwordx4 v5, s[16:19], s44 offen lds
    buffer_load_dwordx4 v5, s[16:19], s45 offen offset:1024 lds
    v_add_u32 v5, s92, v5
    s_add_u32 m0, s40, 10240
    s_nop 0
    buffer_load_dwordx4 v6, s[12:15], s46 offen lds
    v_add_u32 v6, s92, v6
    s_add_u32 m0, s40, 11264
    s_nop 0
    buffer_load_dwordx4 v7, s[16:19], s46 offen lds
    v_add_u32 v7, s92, v7
    s_waitcnt vmcnt(12)
    s_mov_b32 s3, 0
L_g10:
    v_xor_b32 v37, s60, v33
    v_xor_b32 v38, s60, v35
    v_or_b32 v37, v37, v38
    v_cmp_eq_u32 vcc, 0, v37
    s_nop 1
    s_cmp_eq_u64 vcc, -1
    s_cbranch_scc1 L_gok11
    s_sleep 2
    buffer_load_dwordx4 v[32:35], v36, s[20:23], s99 offen sc1
    s_waitcnt vmcnt(0)
    s_add_u32 s3, s3, 1
    s_cmp_lt_u32 s3, 20000
    s_cbranch_scc1 L_g10
L_gok11:
    v_mov_b32 v62, v32
    v_mov_b32 v63, v34
    v_lshlrev_b32 v24, 16, v128
    v_and_b32 v25, s96, v128
    v_lshlrev_b32 v26, 16, v129
    v_and_b32 v27, s96, v129
    v_fma_f32 v24, v24, v62, v63
    v_fma_f32 v25, v25, v62, v63
    v_fma_f32 v26, v26, v62, v63
    v_fma_f32 v27, v27, v62, v63
    v_cvt_pk_bf16_f32 v128, v24, v25
    v_cvt_pk_bf16_f32 v129, v26, v27
    v_lshlrev_b32 v28, 16, v130
    v_and_b32 v29, s96, v130
    v_lshlrev_b32 v30, 16, v131
    v_and_b32 v31, s96, v131
    v_fma_f32 v28, v28, v62, v63
    v_fma_f32 v29, v29, v62, v63
    v_fma_f32 v30, v30, v62, v63
    v_fma_f32 v31, v31, v62, v63
    v_cvt_pk_bf16_f32 v130, v28, v29
    v_cvt_pk_bf16_f32 v131, v30, v31
    s_barrier
    ds_read_b64_tr_b16 a[96:97], v64 offset:0
    ds_read_b64_tr_b16 a[98:99], v64 offset:512
    ds_read_b64_tr_b16 a[100:101], v65 offset:0
    ds_read_b64_tr_b16 a[102:103], v65 offset:512
    ds_read_b64_tr_b16 a[104:105], v66 offset:0
    ds_read_b64_tr_b16 a[106:107], v66 offset:512
    ds_read_b64_tr_b16 a[108:109], v67 offset:0
    ds_read_b64_tr_b16 a[110:111], v67 offset:512
    ds_read_b64_tr_b16 a[112:113], v68 offset:4096
    ds_read_b64_tr_b16 a[114:115], v68 offset:4352
    ds_read_b64_tr_b16 a[116:117], v69 offset:4096
    ds_read_b64_tr_b16 a[118:119], v69 offset:4352
    s_waitcnt lgkmcnt(6)
    v_mfma_f32_32x32x16_bf16 a[0:15], a[96:99], v[128:131], 0
    ds_read_b64_tr_b16 a[120:121], v64 offset:6144
    ds_read_b64_tr_b16 a[122:123], v64 offset:6656
    ds_read_b64_tr_b16 a[124:125], v65 offset:6144
    v_lshlrev_b32 v24, 16, v132
    v_and_b32 v25, s96, v132
    v_lshlrev_b32 v26, 16, v133
    v_and_b32 v27, s96, v133
    s_add_u32 m0, s40, 12288
    s_cmp_eq_u32 s69, 3
    s_cselect_b32 s92, s91, s90
    buffer_load_dwordx4 v4, s[12:15], s44 offen lds
    buffer_load_dwordx4 v4, s[12:15], s45 offen offset:1024 lds
    v_add_u32 v4, s92, v4
    v_mfma_f32_32x32x16_bf16 a[16:31], a[100:103], v[128:131], 0
    ds_read_b64_tr_b16 a[126:127], v65 offset:6656
    ds_read_b64_tr_b16 a[128:129], v66 offset:6144
    v_fma_f32 v24, v24, v62, v63
    v_fma_f32 v25, v25, v62, v63
    v_fma_f32 v26, v26, v62, v63
    v_fma_f32 v27, v27, v62, v63
    v_mfma_f32_32x32x16_bf16 a[32:47], a[104:107], v[128:131], 0
    ds_read_b64_tr_b16 a[130:131], v66 offset:6656
    ds_read_b64_tr_b16 a[132:133], v67 offset:6144
    ds_read_b64_tr_b16 a[134:135], v67 offset:6656
    v_cvt_pk_bf16_f32 v132, v24, v25
    v_cvt_pk_bf16_f32 v133, v26, v27
    v_lshlrev_b32 v28, 16, v134
    v_and_b32 v29, s96, v134
    s_add_u32 m0, s40, 14336
    s_nop 0
    buffer_load_dwordx4 v5, s[16:19], s44 offen lds
    buffer_load_dwordx4 v5, s[16:19], s45 offen offset:1024 lds
    v_add_u32 v5, s92, v5
    s_waitcnt lgkmcnt(8)
    v_mfma_f32_32x32x16_bf16 a[48:63], a[108:111], v[128:131], 0
    ds_read_b64_tr_b16 a[136:137], v68 offset:10240
    ds_read_b64_tr_b16 a[138:139], v68 offset:10496
    v_lshlrev_b32 v30, 16, v135
    v_and_b32 v31, s96, v135
    v_fma_f32 v28, v28, v62, v63
    v_fma_f32 v29, v29, v62, v63
    v_mfma_f32_32x32x16_bf16 a[64:79], a[112:115], v[128:131], 0
    ds_read_b64_tr_b16 a[140:141], v69 offset:10240
    ds_read_b64_tr_b16 a[142:143], v69 offset:10496
    v_fma_f32 v30, v30, v62, v63
    v_fma_f32 v31, v31, v62, v63
    v_cvt_pk_bf16_f32 v134, v28, v29
    v_cvt_pk_bf16_f32 v135, v30, v31
    v_mfma_f32_32x32x16_bf16 a[80:95], a[116:119], v[128:131], 0
    s_waitcnt lgkmcnt(6)
    v_mfma_f32_32x32x16_bf16 a[0:15], a[120:123], v[132:135], a[0:15]
    ds_read_b64_tr_b16 a[96:97], v64 offset:12288
    ds_read_b64_tr_b16 a[98:99], v64 offset:12800
    ds_read_b64_tr_b16 a[100:101], v65 offset:12288
    v_lshlrev_b32 v24, 16, v136
    v_and_b32 v25, s96, v136
    v_lshlrev_b32 v26, 16, v137
    v_and_b32 v27, s96, v137
    s_add_u32 m0, s40, 16384
    s_nop 0
    buffer_load_dwordx4 v6, s[12:15], s46 offen lds
    v_add_u32 v6, s92, v6
    s_add_u32 m0, s40, 17408
    s_nop 0
    buffer_load_dwordx4 v7, s[16:19], s46 offen lds
    v_add_u32 v7, s92, v7
    v_mfma_f32_32x32x16_bf16 a[16:31], a[124:127], v[132:135], a[16:31]
    ds_read_b64_tr_b16 a[102:103], v65 offset:12800
    ds_read_b64_tr_b16 a[104:105], v66 offset:12288
    v_fma_f32 v24, v24, v62, v63
    v_fma_f32 v25, v25, v62, v63
    v_fma_f32 v26, v26, v62, v63
    v_fma_f32 v27, v27, v62, v63
    v_mfma_f32_32x32x16_bf16 a[32:47], a[128:131], v[132:135], a[32:47]
    ds_read_b64_tr_b16 a[106:107], v66 offset:12800
    ds_read_b64_tr_b16 a[108:109], v67 offset:12288
    ds_read_b64_tr_b16 a[110:111], v67 offset:12800
    v_cvt_pk_bf16_f32 v136, v24, v25
    v_cvt_pk_bf16_f32 v137, v26, v27
    v_lshlrev_b32 v28, 16, v138
    v_and_b32 v29, s96, v138
    s_add_u32 m0, s40, 18432
    s_cmp_eq_u32 s69, 4
    s_cselect_b32 s92, s91, s90
    buffer_load_dwordx4 v4, s[12:15], s44 offen lds
    buffer_load_dwordx4 v4, s[12:15], s45 offen offset:1024 lds
    v_add_u32 v4, s92, v4
    s_waitcnt lgkmcnt(8)
    v_mfma_f32_32x32x16_bf16 a[48:63], a[132:135], v[132:135], a[48:63]
    ds_read_b64_tr_b16 a[112:113], v68 offset:16384
    ds_read_b64_tr_b16 a[114:115], v68 offset:16640
    v_lshlrev_b32 v30, 16, v139
    v_and_b32 v31, s96, v139
    v_fma_f32 v28, v28, v62, v63
    v_fma_f32 v29, v29, v62, v63
    v_mfma_f32_32x32x16_bf16 a[64:79], a[136:139], v[132:135], a[64:79]
    ds_read_b64_tr_b16 a[116:117], v69 offset:16384
    ds_read_b64_tr_b16 a[118:119], v69 offset:16640
    v_fma_f32 v30, v30, v62, v63
    v_fma_f32 v31, v31, v62, v63
    v_cvt_pk_bf16_f32 v138, v28, v29
    v_cvt_pk_bf16_f32 v139, v30, v31
    v_mfma_f32_32x32x16_bf16 a[80:95], a[140:143], v[132:135], a[80:95]
    s_waitcnt lgkmcnt(6)
    v_mfma_f32_32x32x16_bf16 a[0:15], a[96:99], v[136:139], a[0:15]
    ds_read_b64_tr_b16 a[120:121], v64 offset:18432
    ds_read_b64_tr_b16 a[122:123], v64 offset:18944
    ds_read_b64_tr_b16 a[124:125], v65 offset:18432
    v_lshlrev_b32 v24, 16, v140
    v_and_b32 v25, s96, v140
    v_lshlrev_b32 v26, 16, v141
    v_and_b32 v27, s96, v141
    s_add_u32 m0, s40, 20480
    s_nop 0
    buffer_load_dwordx4 v5, s[16:19], s44 offen lds
    buffer_load_dwordx4 v5, s[16:19], s45 offen offset:1024 lds
    v_add_u32 v5, s92, v5
    v_mfma_f32_32x32x16_bf16 a[16:31], a[100:103], v[136:139], a[16:31]
    ds_read_b64_tr_b16 a[126:127], v65 offset:18944
    ds_read_b64_tr_b16 a[128:129], v66 offset:18432
    v_fma_f32 v24, v24, v62, v63
    v_fma_f32 v25, v25, v62, v63
    v_fma_f32 v26, v26, v62, v63
    v_fma_f32 v27, v27, v62, v63
    v_mfma_f32_32x32x16_bf16 a[32:47], a[104:107], v[136:139], a[32:47]
    ds_read_b64_tr_b16 a[130:131], v66 offset:18944
    ds_read_b64_tr_b16 a[132:133], v67 offset:18432
    v_cvt_pk_bf16_f32 v140, v24, v25
    v_cvt_pk_bf16_f32 v141, v26, v27
    v_lshlrev_b32 v28, 16, v142
    v_and_b32 v29, s96, v142
    s_waitcnt lgkmcnt(7)
    v_mfma_f32_32x32x16_bf16 a[48:63], a[108:111], v[136:139], a[48:63]
    s_waitcnt vmcnt(16)
    s_barrier
    ds_read_b64_tr_b16 a[134:135], v67 offset:18944
    ds_read_b64_tr_b16 a[136:137], v68 offset:22528
    ds_read_b64_tr_b16 a[138:139], v68 offset:22784
    v_lshlrev_b32 v30, 16, v143
    v_and_b32 v31, s96, v143
    v_fma_f32 v28, v28, v62, v63
    v_fma_f32 v29, v29, v62, v63
    s_add_u32 m0, s40, 22528
    s_nop 0
    buffer_load_dwordx4 v6, s[12:15], s46 offen lds
    v_add_u32 v6, s92, v6
    s_add_u32 m0, s40, 23552
    s_nop 0
    buffer_load_dwordx4 v7, s[16:19], s46 offen lds
    v_add_u32 v7, s92, v7
    v_mfma_f32_32x32x16_bf16 a[64:79], a[112:115], v[136:139], a[64:79]
    ds_read_b64_tr_b16 a[140:141], v69 offset:22528
    ds_read_b64_tr_b16 a[142:143], v69 offset:22784
    v_fma_f32 v30, v30, v62, v63
    v_fma_f32 v31, v31, v62, v63
    v_cvt_pk_bf16_f32 v142, v28, v29
    v_cvt_pk_bf16_f32 v143, v30, v31
    v_mfma_f32_32x32x16_bf16 a[80:95], a[116:119], v[136:139], a[80:95]
    s_waitcnt lgkmcnt(6)
    v_mfma_f32_32x32x16_bf16 a[0:15], a[120:123], v[140:143], a[0:15]
    ds_read_b64_tr_b16 a[96:97], v12 offset:0
    ds_read_b64_tr_b16 a[98:99], v12 offset:512
    ds_read_b64_tr_b16 a[100:101], v14 offset:0
    v_lshlrev_b32 v24, 16, v144
    v_and_b32 v25, s96, v144
    v_lshlrev_b32 v26, 16, v145
    v_and_b32 v27, s96, v145
    s_add_u32 m0, s40, 24576
    s_cmp_eq_u32 s69, 5
    s_cselect_b32 s92, s91, s90
    buffer_load_dwordx4 v4, s[12:15], s44 offen lds
    buffer_load_dwordx4 v4, s[12:15], s45 offen offset:1024 lds
    v_add_u32 v4, s92, v4
    v_mfma_f32_32x32x16_bf16 a[16:31], a[124:127], v[140:143], a[16:31]
    ds_read_b64_tr_b16 a[102:103], v14 offset:512
    ds_read_b64_tr_b16 a[104:105], v16 offset:0
    v_fma_f32 v24, v24, v62, v63
    v_fma_f32 v25, v25, v62, v63
    v_fma_f32 v26, v26, v62, v63
    v_fma_f32 v27, v27, v62, v63
    v_mfma_f32_32x32x16_bf16 a[32:47], a[128:131], v[140:143], a[32:47]
    ds_read_b64_tr_b16 a[106:107], v16 offset:512
    ds_read_b64_tr_b16 a[108:109], v18 offset:0
    ds_read_b64_tr_b16 a[110:111], v18 offset:512
    v_cvt_pk_bf16_f32 v144, v24, v25
    v_cvt_pk_bf16_f32 v145, v26, v27
    v_lshlrev_b32 v28, 16, v146
    v_and_b32 v29, s96, v146
    s_add_u32 m0, s40, 30720
    s_nop 0
    buffer_load_dwordx4 v3, s[24:27], s63 offen lds
    buffer_load_dwordx4 v3, s[24:27], s64 offen offset:1024 lds
    s_waitcnt lgkmcnt(8)
    v_mfma_f32_32x32x16_bf16 a[48:63], a[132:135], v[140:143], a[48:63]
    ds_read_b64_tr_b16 a[112:113], v20 offset:4096
    ds_read_b64_tr_b16 a[114:115], v20 offset:4352
    v_lshlrev_b32 v30, 16, v147
    v_and_b32 v31, s96, v147
    v_fma_f32 v28, v28, v62, v63
    v_fma_f32 v29, v29, v62, v63
    v_mfma_f32_32x32x16_bf16 a[64:79], a[136:139], v[140:143], a[64:79]
    ds_read_b64_tr_b16 a[116:117], v22 offset:4096
    ds_read_b64_tr_b16 a[118:119], v22 offset:4352
    v_fma_f32 v30, v30, v62, v63
    v_fma_f32 v31, v31, v62, v63
    v_cvt_pk_bf16_f32 v146, v28, v29
    v_cvt_pk_bf16_f32 v147, v30, v31
    v_mfma_f32_32x32x16_bf16 a[80:95], a[140:143], v[140:143], a[80:95]
    s_waitcnt lgkmcnt(6)
    v_mfma_f32_32x32x16_bf16 a[0:15], a[96:99], v[144:147], a[0:15]
    ds_read_b64_tr_b16 a[120:121], v12 offset:32768
    ds_read_b64_tr_b16 a[122:123], v12 offset:33280
    ds_read_b64_tr_b16 a[124:125], v14 offset:32768
    v_lshlrev_b32 v24, 16, v148
    v_and_b32 v25, s96, v148
    v_lshlrev_b32 v26, 16, v149
    v_and_b32 v27, s96, v149
    s_add_u32 m0, s40, 26624
    s_nop 0
    buffer_load_dwordx4 v5, s[16:19], s44 offen lds
    buffer_load_dwordx4 v5, s[16:19], s45 offen offset:1024 lds
    v_add_u32 v5, s92, v5
    v_mfma_f32_32x32x16_bf16 a[16:31], a[100:103], v[144:147], a[16:31]
    ds_read_b64_tr_b16 a[126:127], v14 offset:33280
    ds_read_b64_tr_b16 a[128:129], v16 offset:32768
    v_fma_f32 v24, v24, v62, v63
    v_fma_f32 v25, v25, v62, v63
    v_fma_f32 v26, v26, v62, v63
    v_fma_f32 v27, v27, v62, v63
    v_mfma_f32_32x32x16_bf16 a[32:47], a[104:107], v[144:147], a[32:47]
    ds_read_b64_tr_b16 a[130:131], v16 offset:33280
    ds_read_b64_tr_b16 a[132:133], v18 offset:32768
    ds_read_b64_tr_b16 a[134:135], v18 offset:33280
    v_cvt_pk_bf16_f32 v148, v24, v25
    v_cvt_pk_bf16_f32 v149, v26, v27
    v_lshlrev_b32 v28, 16, v150
    v_and_b32 v29, s96, v150
    s_waitcnt lgkmcnt(8)
    v_mfma_f32_32x32x16_bf16 a[48:63], a[108:111], v[144:147], a[48:63]
    ds_read_b64_tr_b16 a[136:137], v20 offset:36864
    ds_read_b64_tr_b16 a[138:139], v20 offset:37120
    v_lshlrev_b32 v30, 16, v151
    v_and_b32 v31, s96, v151
    v_fma_f32 v28, v28, v62, v63
    v_fma_f32 v29, v29, v62, v63
    v_mfma_f32_32x32x16_bf16 a[64:79], a[112:115], v[144:147], a[64:79]
    ds_read_b64_tr_b16 a[140:141], v22 offset:36864
    ds_read_b64_tr_b16 a[142:143], v22 offset:37120
    v_fma_f32 v30, v30, v62, v63
    v_fma_f32 v31, v31, v62, v63
    v_cvt_pk_bf16_f32 v150, v28, v29
    v_cvt_pk_bf16_f32 v151, v30, v31
    v_mfma_f32_32x32x16_bf16 a[80:95], a[116:119], v[144:147], a[80:95]
    s_waitcnt lgkmcnt(6)
    v_mfma_f32_32x32x16_bf16 a[0:15], a[120:123], v[148:151], a[0:15]
    ds_read_b64_tr_b16 a[96:97], v13 offset:0
    ds_read_b64_tr_b16 a[98:99], v13 offset:512
    ds_read_b64_tr_b16 a[100:101], v15 offset:0
    v_lshlrev_b32 v24, 16, v152
    v_and_b32 v25, s96, v152
    v_lshlrev_b32 v26, 16, v153
    v_and_b32 v27, s96, v153
    v_fma_f32 v24, v24, v62, v63
    s_add_u32 m0, s40, 28672
    s_nop 0
    buffer_load_dwordx4 v6, s[12:15], s46 offen lds
    v_add_u32 v6, s92, v6
    s_add_u32 m0, s40, 29696
    s_nop 0
    buffer_load_dwordx4 v7, s[16:19], s46 offen lds
    v_add_u32 v7, s92, v7
    v_mfma_f32_32x32x16_bf16 a[16:31], a[124:127], v[148:151], a[16:31]
    ds_read_b64_tr_b16 a[102:103], v15 offset:512
    ds_read_b64_tr_b16 a[104:105], v17 offset:0
    v_fma_f32 v25, v25, v62, v63
    v_fma_f32 v26, v26, v62, v63
    v_fma_f32 v27, v27, v62, v63
    v_cvt_pk_bf16_f32 v152, v24, v25
    v_mfma_f32_32x32x16_bf16 a[32:47], a[128:131], v[148:151], a[32:47]
    ds_read_b64_tr_b16 a[106:107], v17 offset:512
    ds_read_b64_tr_b16 a[108:109], v19 offset:0
    ds_read_b64_tr_b16 a[110:111], v19 offset:512
    v_cvt_pk_bf16_f32 v153, v26, v27
    v_lshlrev_b32 v28, 16, v154
    v_and_b32 v29, s96, v154
    v_lshlrev_b32 v30, 16, v155
    s_waitcnt lgkmcnt(8)
    v_mfma_f32_32x32x16_bf16 a[48:63], a[132:135], v[148:151], a[48:63]
    ds_read_b64_tr_b16 a[112:113], v21 offset:4096
    ds_read_b64_tr_b16 a[114:115], v21 offset:4352
    v_and_b32 v31, s96, v155
    v_fma_f32 v28, v28, v62, v63
    v_fma_f32 v29, v29, v62, v63
    v_fma_f32 v30, v30, v62, v63
    v_mfma_f32_32x32x16_bf16 a[64:79], a[136:139], v[148:151], a[64:79]
    ds_read_b64_tr_b16 a[116:117], v23 offset:4096
    ds_read_b64_tr_b16 a[118:119], v23 offset:4352
    v_fma_f32 v31, v31, v62, v63
    v_cvt_pk_bf16_f32 v154, v28, v29
    v_cvt_pk_bf16_f32 v155, v30, v31
    s_and_b32 s57, s37, 7
    s_lshl_b32 s57, s57, 2
    s_mul_i32 s57, s57, 57344
    s_add_u32 s57, s57, s50
    v_and_b32 v54, 15, v1
    v_mul_u32_u24 v54, 3584, v54
    buffer_load_dword v55, v54, s[12:15], s57 offen
    buffer_load_dword v55, v54, s[16:19], s57 offen
    v_mfma_f32_32x32x16_bf16 a[80:95], a[140:143], v[148:151], a[80:95]
    s_waitcnt lgkmcnt(6)
    v_mfma_f32_32x32x16_bf16 a[0:15], a[96:99], v[152:155], a[0:15]
    ds_read_b64_tr_b16 a[120:121], v13 offset:32768
    ds_read_b64_tr_b16 a[122:123], v13 offset:33280
    ds_read_b64_tr_b16 a[124:125], v15 offset:32768
    v_lshlrev_b32 v24, 16, v156
    v_and_b32 v25, s96, v156
    v_lshlrev_b32 v26, 16, v157
    v_and_b32 v27, s96, v157
    v_mfma_f32_32x32x16_bf16 a[16:31], a[100:103], v[152:155], a[16:31]
    ds_read_b64_tr_b16 a[126:127], v15 offset:33280
    ds_read_b64_tr_b16 a[128:129], v17 offset:32768
    v_fma_f32 v24, v24, v62, v63
    v_fma_f32 v25, v25, v62, v63
    v_fma_f32 v26, v26, v62, v63
    v_fma_f32 v27, v27, v62, v63
    v_mfma_f32_32x32x16_bf16 a[32:47], a[104:107], v[152:155], a[32:47]
    ds_read_b64_tr_b16 a[130:131], v17 offset:33280
    ds_read_b64_tr_b16 a[132:133], v19 offset:32768
    v_cvt_pk_bf16_f32 v156, v24, v25
    v_cvt_pk_bf16_f32 v157, v26, v27
    v_lshlrev_b32 v28, 16, v158
    v_and_b32 v29, s96, v158
    s_waitcnt lgkmcnt(7)
    v_mfma_f32_32x32x16_bf16 a[48:63], a[108:111], v[152:155], a[48:63]
    s_waitcnt vmcnt(22)
    s_barrier
    ds_read_b64_tr_b16 a[134:135], v19 offset:33280
    ds_read_b64_tr_b16 a[136:137], v21 offset:36864
    ds_read_b64_tr_b16 a[138:139], v21 offset:37120
    v_lshlrev_b32 v30, 16, v159
    v_and_b32 v31, s96, v159
    v_fma_f32 v28, v28, v62, v63
    v_fma_f32 v29, v29, v62, v63
    v_mfma_f32_32x32x16_bf16 a[64:79], a[112:115], v[152:155], a[64:79]
    ds_read_b64_tr_b16 a[140:141], v23 offset:36864
    ds_read_b64_tr_b16 a[142:143], v23 offset:37120
    v_fma_f32 v30, v30, v62, v63
    v_fma_f32 v31, v31, v62, v63
    v_cvt_pk_bf16_f32 v158, v28, v29
    v_cvt_pk_bf16_f32 v159, v30, v31
    v_mfma_f32_32x32x16_bf16 a[80:95], a[116:119], v[152:155], a[80:95]
    s_waitcnt lgkmcnt(6)
    v_mfma_f32_32x32x16_bf16 a[0:15], a[120:123], v[156:159], a[0:15]
    ds_read_b64_tr_b16 a[96:97], v12 offset:6144
    ds_read_b64_tr_b16 a[98:99], v12 offset:6656
    ds_read_b64_tr_b16 a[100:101], v14 offset:6144
    v_lshlrev_b32 v24, 16, v160
    v_and_b32 v25, s96, v160
    v_lshlrev_b32 v26, 16, v161
    v_and_b32 v27, s96, v161
    s_add_u32 m0, s68, 0
    v_add_u32 v3, 0x4000, v3
    buffer_load_dwordx4 v3, s[24:27], s63 offen lds
    buffer_load_dwordx4 v3, s[24:27], s64 offen offset:1024 lds
    v_mfma_f32_32x32x16_bf16 a[16:31], a[124:127], v[156:159], a[16:31]
    ds_read_b64_tr_b16 a[102:103], v14 offset:6656
    ds_read_b64_tr_b16 a[104:105], v16 offset:6144
    v_fma_f32 v24, v24, v62, v63
    v_fma_f32 v25, v25, v62, v63
    v_fma_f32 v26, v26, v62, v63
    v_fma_f32 v27, v27, v62, v63
    v_mfma_f32_32x32x16_bf16 a[32:47], a[128:131], v[156:159], a[32:47]
    ds_read_b64_tr_b16 a[106:107], v16 offset:6656
    ds_read_b64_tr_b16 a[108:109], v18 offset:6144
    ds_read_b64_tr_b16 a[110:111], v18 offset:6656
    v_cvt_pk_bf16_f32 v160, v24, v25
    v_cvt_pk_bf16_f32 v161, v26, v27
    v_lshlrev_b32 v28, 16, v162
    v_and_b32 v29, s96, v162
    s_waitcnt lgkmcnt(8)
    v_mfma_f32_32x32x16_bf16 a[48:63], a[132:135], v[156:159], a[48:63]
    ds_read_b64_tr_b16 a[112:113], v20 offset:10240
    ds_read_b64_tr_b16 a[114:115], v20 offset:10496
    v_lshlrev_b32 v30, 16, v163
    v_and_b32 v31, s96, v163
    v_fma_f32 v28, v28, v62, v63
    v_fma_f32 v29, v29, v62, v63
    v_mfma_f32_32x32x16_bf16 a[64:79], a[136:139], v[156:159], a[64:79]
    ds_read_b64_tr_b16 a[116:117], v22 offset:10240
    ds_read_b64_tr_b16 a[118:119], v22 offset:10496
    v_fma_f32 v30, v30, v62, v63
    v_fma_f32 v31, v31, v62, v63
    v_cvt_pk_bf16_f32 v162, v28, v29
    v_cvt_pk_bf16_f32 v163, v30, v31
    v_mfma_f32_32x32x16_bf16 a[80:95], a[140:143], v[156:159], a[80:95]
    s_waitcnt lgkmcnt(6)
    v_mfma_f32_32x32x16_bf16 a[0:15], a[96:99], v[160:163], a[0:15]
    ds_read_b64_tr_b16 a[120:121], v12 offset:38912
    ds_read_b64_tr_b16 a[122:123], v12 offset:39424
    ds_read_b64_tr_b16 a[124:125], v14 offset:38912
    v_lshlrev_b32 v24, 16, v164
    v_and_b32 v25, s96, v164
    v_lshlrev_b32 v26, 16, v165
    v_and_b32 v27, s96, v165
    s_add_u32 m0, s68, 2048
    v_add_u32 v3, 0x4000, v3
    buffer_load_dwordx4 v3, s[24:27], s63 offen lds
    buffer_load_dwordx4 v3, s[24:27], s64 offen offset:1024 lds
    v_mfma_f32_32x32x16_bf16 a[16:31], a[100:103], v[160:163], a[16:31]
    ds_read_b64_tr_b16 a[126:127], v14 offset:39424
    ds_read_b64_tr_b16 a[128:129], v16 offset:38912
    v_fma_f32 v24, v24, v62, v63
    v_fma_f32 v25, v25, v62, v63
    v_fma_f32 v26, v26, v62, v63
    v_fma_f32 v27, v27, v62, v63
    v_mfma_f32_32x32x16_bf16 a[32:47], a[104:107], v[160:163], a[32:47]
    ds_read_b64_tr_b16 a[130:131], v16 offset:39424
    ds_read_b64_tr_b16 a[132:133], v18 offset:38912
    ds_read_b64_tr_b16 a[134:135], v18 offset:39424
    v_cvt_pk_bf16_f32 v164, v24, v25
    v_cvt_pk_bf16_f32 v165, v26, v27
    v_lshlrev_b32 v28, 16, v166
    v_and_b32 v29, s96, v166
    s_waitcnt lgkmcnt(8)
    v_mfma_f32_32x32x16_bf16 a[48:63], a[108:111], v[160:163], a[48:63]
    ds_read_b64_tr_b16 a[136:137], v20 offset:43008
    ds_read_b64_tr_b16 a[138:139], v20 offset:43264
    v_lshlrev_b32 v30, 16, v167
    v_and_b32 v31, s96, v167
    v_fma_f32 v28, v28, v62, v63
    v_fma_f32 v29, v29, v62, v63
    v_mfma_f32_32x32x16_bf16 a[64:79], a[112:115], v[160:163], a[64:79]
    ds_read_b64_tr_b16 a[140:141], v22 offset:43008
    ds_read_b64_tr_b16 a[142:143], v22 offset:43264
    v_fma_f32 v30, v30, v62, v63
    v_fma_f32 v31, v31, v62, v63
    v_cvt_pk_bf16_f32 v166, v28, v29
    v_cvt_pk_bf16_f32 v167, v30, v31
    v_mfma_f32_32x32x16_bf16 a[80:95], a[116:119], v[160:163], a[80:95]
    s_waitcnt lgkmcnt(6)
    v_mfma_f32_32x32x16_bf16 a[0:15], a[120:123], v[164:167], a[0:15]
    ds_read_b64_tr_b16 a[96:97], v13 offset:6144
    ds_read_b64_tr_b16 a[98:99], v13 offset:6656
    ds_read_b64_tr_b16 a[100:101], v15 offset:6144
    v_lshlrev_b32 v24, 16, v168
    v_and_b32 v25, s96, v168
    v_lshlrev_b32 v26, 16, v169
    v_and_b32 v27, s96, v169
    v_fma_f32 v24, v24, v62, v63
    s_add_u32 m0, s68, 4096
    v_add_u32 v3, 0x4000, v3
    buffer_load_dwordx4 v3, s[24:27], s63 offen lds
    buffer_load_dwordx4 v3, s[24:27], s64 offen offset:1024 lds
    v_mfma_f32_32x32x16_bf16 a[16:31], a[124:127], v[164:167], a[16:31]
    ds_read_b64_tr_b16 a[102:103], v15 offset:6656
    ds_read_b64_tr_b16 a[104:105], v17 offset:6144
    v_fma_f32 v25, v25, v62, v63
    v_fma_f32 v26, v26, v62, v63
    v_fma_f32 v27, v27, v62, v63
    v_cvt_pk_bf16_f32 v168, v24, v25
    v_mfma_f32_32x32x16_bf16 a[32:47], a[128:131], v[164:167], a[32:47]
    ds_read_b64_tr_b16 a[106:107], v17 offset:6656
    ds_read_b64_tr_b16 a[108:109], v19 offset:6144
    ds_read_b64_tr_b16 a[110:111], v19 offset:6656
    v_cvt_pk_bf16_f32 v169, v26, v27
    v_lshlrev_b32 v28, 16, v170
    v_and_b32 v29, s96, v170
    v_lshlrev_b32 v30, 16, v171
    s_waitcnt lgkmcnt(8)
    v_mfma_f32_32x32x16_bf16 a[48:63], a[132:135], v[164:167], a[48:63]
    ds_read_b64_tr_b16 a[112:113], v21 offset:10240
    ds_read_b64_tr_b16 a[114:115], v21 offset:10496
    v_and_b32 v31, s96, v171
    v_fma_f32 v28, v28, v62, v63
    v_fma_f32 v29, v29, v62, v63
    v_fma_f32 v30, v30, v62, v63
    v_mfma_f32_32x32x16_bf16 a[64:79], a[136:139], v[164:167], a[64:79]
    ds_read_b64_tr_b16 a[116:117], v23 offset:10240
    ds_read_b64_tr_b16 a[118:119], v23 offset:10496
    v_fma_f32 v31, v31, v62, v63
    v_cvt_pk_bf16_f32 v170, v28, v29
    v_cvt_pk_bf16_f32 v171, v30, v31
    s_lshr_b32 s57, s2, 3
    s_lshl_b32 s57, s57, 2
    s_add_u32 s57, s57, s36
    s_lshl_b32 s57, s57, 12
    v_and_b32 v54, 31, v1
    v_lshlrev_b32 v54, 7, v54
    buffer_load_dword v55, v54, s[28:31], s57 offen
    v_mfma_f32_32x32x16_bf16 a[80:95], a[140:143], v[164:167], a[80:95]
    s_waitcnt lgkmcnt(6)
    v_mfma_f32_32x32x16_bf16 a[0:15], a[96:99], v[168:171], a[0:15]
    ds_read_b64_tr_b16 a[120:121], v13 offset:38912
    ds_read_b64_tr_b16 a[122:123], v13 offset:39424
    ds_read_b64_tr_b16 a[124:125], v15 offset:38912
    v_lshlrev_b32 v24, 16, v172
    v_and_b32 v25, s96, v172
    v_lshlrev_b32 v26, 16, v173
    v_and_b32 v27, s96, v173
    v_mfma_f32_32x32x16_bf16 a[16:31], a[100:103], v[168:171], a[16:31]
    ds_read_b64_tr_b16 a[126:127], v15 offset:39424
    ds_read_b64_tr_b16 a[128:129], v17 offset:38912
    v_fma_f32 v24, v24, v62, v63
    v_fma_f32 v25, v25, v62, v63
    v_fma_f32 v26, v26, v62, v63
    v_fma_f32 v27, v27, v62, v63
    v_mfma_f32_32x32x16_bf16 a[32:47], a[104:107], v[168:171], a[32:47]
    ds_read_b64_tr_b16 a[130:131], v17 offset:39424
    ds_read_b64_tr_b16 a[132:133], v19 offset:38912
    v_cvt_pk_bf16_f32 v172, v24, v25
    v_cvt_pk_bf16_f32 v173, v26, v27
    v_lshlrev_b32 v28, 16, v174
    v_and_b32 v29, s96, v174
    s_waitcnt lgkmcnt(7)
    v_mfma_f32_32x32x16_bf16 a[48:63], a[108:111], v[168:171], a[48:63]
    s_waitcnt vmcnt(23)
    s_barrier
    ds_read_b64_tr_b16 a[134:135], v19 offset:39424
    ds_read_b64_tr_b16 a[136:137], v21 offset:43008
    ds_read_b64_tr_b16 a[138:139], v21 offset:43264
    v_lshlrev_b32 v30, 16, v175
    v_and_b32 v31, s96, v175
    v_fma_f32 v28, v28, v62, v63
    v_fma_f32 v29, v29, v62, v63
    s_add_u32 m0, s68, 6144
    s_mov_b32 s59, 0x4000
    s_cmp_eq_u32 s101, 4
    s_cselect_b32 s59, 0xfff94000, s59
    v_add_u32 v3, s59, v3
    buffer_load_dwordx4 v3, s[24:27], s63 offen lds
    buffer_load_dwordx4 v3, s[24:27], s64 offen offset:1024 lds
    v_mfma_f32_32x32x16_bf16 a[64:79], a[112:115], v[168:171], a[64:79]
    ds_read_b64_tr_b16 a[140:141], v23 offset:43008
    ds_read_b64_tr_b16 a[142:143], v23 offset:43264
    v_fma_f32 v30, v30, v62, v63
    v_fma_f32 v31, v31, v62, v63
    v_cvt_pk_bf16_f32 v174, v28, v29
    v_cvt_pk_bf16_f32 v175, v30, v31
    v_mfma_f32_32x32x16_bf16 a[80:95], a[116:119], v[168:171], a[80:95]
    s_waitcnt lgkmcnt(6)
    v_mfma_f32_32x32x16_bf16 a[0:15], a[120:123], v[172:175], a[0:15]
    ds_read_b64_tr_b16 a[96:97], v12 offset:12288
    ds_read_b64_tr_b16 a[98:99], v12 offset:12800
    ds_read_b64_tr_b16 a[100:101], v14 offset:12288
    v_lshlrev_b32 v24, 16, v176
    v_and_b32 v25, s96, v176
    v_lshlrev_b32 v26, 16, v177
    v_and_b32 v27, s96, v177
    s_add_u32 m0, s40, 0
    s_cmp_eq_u32 s69, 6
    s_cselect_b32 s92, s91, s90
    buffer_load_dwordx4 v4, s[12:15], s44 offen lds
    buffer_load_dwordx4 v4, s[12:15], s45 offen offset:1024 lds
    v_add_u32 v4, s92, v4
    v_mfma_f32_32x32x16_bf16 a[16:31], a[124:127], v[172:175], a[16:31]
    ds_read_b64_tr_b16 a[102:103], v14 offset:12800
    ds_read_b64_tr_b16 a[104:105], v16 offset:12288
    v_fma_f32 v24, v24, v62, v63
    v_fma_f32 v25, v25, v62, v63
    v_fma_f32 v26, v26, v62, v63
    v_fma_f32 v27, v27, v62, v63
    v_mfma_f32_32x32x16_bf16 a[32:47], a[128:131], v[172:175], a[32:47]
    ds_read_b64_tr_b16 a[106:107], v16 offset:12800
    ds_read_b64_tr_b16 a[108:109], v18 offset:12288
    ds_read_b64_tr_b16 a[110:111], v18 offset:12800
    v_cvt_pk_bf16_f32 v176, v24, v25
    v_cvt_pk_bf16_f32 v177, v26, v27
    v_lshlrev_b32 v28, 16, v178
    v_and_b32 v29, s96, v178
    s_waitcnt lgkmcnt(8)
    v_mfma_f32_32x32x16_bf16 a[48:63], a[132:135], v[172:175], a[48:63]
    ds_read_b64_tr_b16 a[112:113], v20 offset:16384
    ds_read_b64_tr_b16 a[114:115], v20 offset:16640
    v_lshlrev_b32 v30, 16, v179
    v_and_b32 v31, s96, v179
    v_fma_f32 v28, v28, v62, v63
    v_fma_f32 v29, v29, v62, v63
    v_mfma_f32_32x32x16_bf16 a[64:79], a[136:139], v[172:175], a[64:79]
    ds_read_b64_tr_b16 a[116:117], v22 offset:16384
    ds_read_b64_tr_b16 a[118:119], v22 offset:16640
    v_fma_f32 v30, v30, v62, v63
    v_fma_f32 v31, v31, v62, v63
    v_cvt_pk_bf16_f32 v178, v28, v29
    v_cvt_pk_bf16_f32 v179, v30, v31
    v_mfma_f32_32x32x16_bf16 a[80:95], a[140:143], v[172:175], a[80:95]
    s_waitcnt lgkmcnt(6)
    v_mfma_f32_32x32x16_bf16 a[0:15], a[96:99], v[176:179], a[0:15]
    ds_read_b64_tr_b16 a[120:121], v12 offset:45056
    ds_read_b64_tr_b16 a[122:123], v12 offset:45568
    ds_read_b64_tr_b16 a[124:125], v14 offset:45056
    v_lshlrev_b32 v24, 16, v180
    v_and_b32 v25, s96, v180
    v_lshlrev_b32 v26, 16, v181
    v_and_b32 v27, s96, v181
    s_add_u32 m0, s40, 2048
    s_nop 0
    buffer_load_dwordx4 v5, s[16:19], s44 offen lds
    buffer_load_dwordx4 v5, s[16:19], s45 offen offset:1024 lds
    v_add_u32 v5, s92, v5
    v_mfma_f32_32x32x16_bf16 a[16:31], a[100:103], v[176:179], a[16:31]
    ds_read_b64_tr_b16 a[126:127], v14 offset:45568
    ds_read_b64_tr_b16 a[128:129], v16 offset:45056
    v_fma_f32 v24, v24, v62, v63
    v_fma_f32 v25, v25, v62, v63
    v_fma_f32 v26, v26, v62, v63
    v_fma_f32 v27, v27, v62, v63
    v_mfma_f32_32x32x16_bf16 a[32:47], a[104:107], v[176:179], a[32:47]
    ds_read_b64_tr_b16 a[130:131], v16 offset:45568
    ds_read_b64_tr_b16 a[132:133], v18 offset:45056
    ds_read_b64_tr_b16 a[134:135], v18 offset:45568
    v_cvt_pk_bf16_f32 v180, v24, v25
    v_cvt_pk_bf16_f32 v181, v26, v27
    v_lshlrev_b32 v28, 16, v182
    v_and_b32 v29, s96, v182
    s_waitcnt lgkmcnt(8)
    v_mfma_f32_32x32x16_bf16 a[48:63], a[108:111], v[176:179], a[48:63]
    ds_read_b64_tr_b16 a[136:137], v20 offset:49152
    ds_read_b64_tr_b16 a[138:139], v20 offset:49408
    v_lshlrev_b32 v30, 16, v183
    v_and_b32 v31, s96, v183
    v_fma_f32 v28, v28, v62, v63
    v_fma_f32 v29, v29, v62, v63
    v_mfma_f32_32x32x16_bf16 a[64:79], a[112:115], v[176:179], a[64:79]
    ds_read_b64_tr_b16 a[140:141], v22 offset:49152
    ds_read_b64_tr_b16 a[142:143], v22 offset:49408
    v_fma_f32 v30, v30, v62, v63
    v_fma_f32 v31, v31, v62, v63
    v_cvt_pk_bf16_f32 v182, v28, v29
    v_cvt_pk_bf16_f32 v183, v30, v31
    v_mfma_f32_32x32x16_bf16 a[80:95], a[116:119], v[176:179], a[80:95]
    s_waitcnt lgkmcnt(6)
    v_mfma_f32_32x32x16_bf16 a[0:15], a[120:123], v[180:183], a[0:15]
    ds_read_b64_tr_b16 a[96:97], v13 offset:12288
    ds_read_b64_tr_b16 a[98:99], v13 offset:12800
    ds_read_b64_tr_b16 a[100:101], v15 offset:12288
    v_lshlrev_b32 v24, 16, v184
    v_and_b32 v25, s96, v184
    v_lshlrev_b32 v26, 16, v185
    v_and_b32 v27, s96, v185
    s_add_u32 m0, s40, 4096
    s_nop 0
    buffer_load_dwordx4 v6, s[12:15], s46 offen lds
    v_add_u32 v6, s92, v6
    s_add_u32 m0, s40, 5120
    s_nop 0
    buffer_load_dwordx4 v7, s[16:19], s46 offen lds
    v_add_u32 v7, s92, v7
    v_mfma_f32_32x32x16_bf16 a[16:31], a[124:127], v[180:183], a[16:31]
    ds_read_b64_tr_b16 a[102:103], v15 offset:12800
    ds_read_b64_tr_b16 a[104:105], v17 offset:12288
    v_fma_f32 v24, v24, v62, v63
    v_fma_f32 v25, v25, v62, v63
    v_fma_f32 v26, v26, v62, v63
    v_fma_f32 v27, v27, v62, v63
    v_mfma_f32_32x32x16_bf16 a[32:47], a[128:131], v[180:183], a[32:47]
    ds_read_b64_tr_b16 a[106:107], v17 offset:12800
    ds_read_b64_tr_b16 a[108:109], v19 offset:12288
    ds_read_b64_tr_b16 a[110:111], v19 offset:12800
    v_cvt_pk_bf16_f32 v184, v24, v25
    v_cvt_pk_bf16_f32 v185, v26, v27
    v_lshlrev_b32 v28, 16, v186
    v_and_b32 v29, s96, v186
    s_waitcnt lgkmcnt(8)
    v_mfma_f32_32x32x16_bf16 a[48:63], a[132:135], v[180:183], a[48:63]
    ds_read_b64_tr_b16 a[112:113], v21 offset:16384
    ds_read_b64_tr_b16 a[114:115], v21 offset:16640
    v_lshlrev_b32 v30, 16, v187
    v_and_b32 v31, s96, v187
    v_fma_f32 v28, v28, v62, v63
    v_fma_f32 v29, v29, v62, v63
    v_mfma_f32_32x32x16_bf16 a[64:79], a[136:139], v[180:183], a[64:79]
    ds_read_b64_tr_b16 a[116:117], v23 offset:16384
    ds_read_b64_tr_b16 a[118:119], v23 offset:16640
    v_fma_f32 v30, v30, v62, v63
    v_fma_f32 v31, v31, v62, v63
    v_cvt_pk_bf16_f32 v186, v28, v29
    v_cvt_pk_bf16_f32 v187, v30, v31
    v_mfma_f32_32x32x16_bf16 a[80:95], a[140:143], v[180:183], a[80:95]
    s_waitcnt lgkmcnt(6)
    v_mfma_f32_32x32x16_bf16 a[0:15], a[96:99], v[184:187], a[0:15]
    ds_read_b64_tr_b16 a[120:121], v13 offset:45056
    ds_read_b64_tr_b16 a[122:123], v13 offset:45568
    ds_read_b64_tr_b16 a[124:125], v15 offset:45056
    v_lshlrev_b32 v24, 16, v188
    v_and_b32 v25, s96, v188
    v_lshlrev_b32 v26, 16, v189
    v_and_b32 v27, s96, v189
    s_waitcnt vmcnt(21)
    ds_read_b64_tr_b16 a[160:161], v10 offset:30720
    v_mfma_f32_32x32x16_bf16 a[16:31], a[100:103], v[184:187], a[16:31]
    ds_read_b64_tr_b16 a[126:127], v15 offset:45568
    ds_read_b64_tr_b16 a[128:129], v17 offset:45056
    v_fma_f32 v24, v24, v62, v63
    v_fma_f32 v25, v25, v62, v63
    v_fma_f32 v26, v26, v62, v63
    v_fma_f32 v27, v27, v62, v63
    ds_read_b64_tr_b16 a[162:163], v10 offset:31744
    v_mfma_f32_32x32x16_bf16 a[32:47], a[104:107], v[184:187], a[32:47]
    ds_read_b64_tr_b16 a[130:131], v17 offset:45568
    ds_read_b64_tr_b16 a[132:133], v19 offset:45056
    v_cvt_pk_bf16_f32 v188, v24, v25
    v_cvt_pk_bf16_f32 v189, v26, v27
    v_lshlrev_b32 v28, 16, v190
    v_and_b32 v29, s96, v190
    s_waitcnt lgkmcnt(9)
    v_mfma_f32_32x32x16_bf16 a[48:63], a[108:111], v[184:187], a[48:63]
    s_barrier
    ds_read_b64_tr_b16 a[134:135], v19 offset:45568
    ds_read_b64_tr_b16 a[136:137], v21 offset:49152
    ds_read_b64_tr_b16 a[138:139], v21 offset:49408
    v_lshlrev_b32 v30, 16, v191
    v_and_b32 v31, s96, v191
    v_fma_f32 v28, v28, v62, v63
    v_fma_f32 v29, v29, v62, v63
    ds_read_b64_tr_b16 a[164:165], v11 offset:30720
    v_mfma_f32_32x32x16_bf16 a[64:79], a[112:115], v[184:187], a[64:79]
    ds_read_b64_tr_b16 a[140:141], v23 offset:49152
    ds_read_b64_tr_b16 a[142:143], v23 offset:49408
    v_fma_f32 v30, v30, v62, v63
    v_fma_f32 v31, v31, v62, v63
    v_cvt_pk_bf16_f32 v190, v28, v29
    v_cvt_pk_bf16_f32 v191, v30, v31
    ds_read_b64_tr_b16 a[166:167], v11 offset:31744
    v_mfma_f32_32x32x16_bf16 a[80:95], a[116:119], v[184:187], a[80:95]
    s_waitcnt lgkmcnt(8)
    v_mfma_f32_32x32x16_bf16 a[0:15], a[120:123], v[188:191], a[0:15]
    ds_read_b64_tr_b16 a[96:97], v12 offset:18432
    ds_read_b64_tr_b16 a[98:99], v12 offset:18944
    ds_read_b64_tr_b16 a[100:101], v14 offset:18432
    v_lshlrev_b32 v24, 16, v192
    v_and_b32 v25, s96, v192
    v_lshlrev_b32 v26, 16, v193
    v_and_b32 v27, s96, v193
    s_add_u32 m0, s40, 6144
    s_cmp_eq_u32 s69, 7
    s_cselect_b32 s92, s91, s90
    buffer_load_dwordx4 v4, s[12:15], s44 offen lds
    buffer_load_dwordx4 v4, s[12:15], s45 offen offset:1024 lds
    v_add_u32 v4, s92, v4
    v_mfma_f32_32x32x16_bf16 a[16:31], a[124:127], v[188:191], a[16:31]
    ds_read_b64_tr_b16 a[102:103], v14 offset:18944
    ds_read_b64_tr_b16 a[104:105], v16 offset:18432
    v_fma_f32 v24, v24, v62, v63
    v_fma_f32 v25, v25, v62, v63
    v_fma_f32 v26, v26, v62, v63
    v_fma_f32 v27, v27, v62, v63
    v_mfma_f32_32x32x16_bf16 a[32:47], a[128:131], v[188:191], a[32:47]
    ds_read_b64_tr_b16 a[106:107], v16 offset:18944
    ds_read_b64_tr_b16 a[108:109], v18 offset:18432
    ds_read_b64_tr_b16 a[110:111], v18 offset:18944
    v_cvt_pk_bf16_f32 v192, v24, v25
    v_cvt_pk_bf16_f32 v193, v26, v27
    v_lshlrev_b32 v28, 16, v194
    v_and_b32 v29, s96, v194
    s_waitcnt lgkmcnt(8)
    s_add_u32 m0, s40, 30720
    v_add_u32 v3, 0x4000, v3
    buffer_load_dwordx4 v3, s[24:27], s63 offen lds
    buffer_load_dwordx4 v3, s[24:27], s64 offen offset:1024 lds
    v_mfma_f32_32x32x16_bf16 a[48:63], a[132:135], v[188:191], a[48:63]
    ds_read_b64_tr_b16 a[112:113], v20 offset:22528
    ds_read_b64_tr_b16 a[114:115], v20 offset:22784
    v_lshlrev_b32 v30, 16, v195
    v_and_b32 v31, s96, v195
    v_fma_f32 v28, v28, v62, v63
    v_fma_f32 v29, v29, v62, v63
    v_mfma_f32_32x32x16_bf16 a[64:79], a[136:139], v[188:191], a[64:79]
    ds_read_b64_tr_b16 a[116:117], v22 offset:22528
    ds_read_b64_tr_b16 a[118:119], v22 offset:22784
    v_fma_f32 v30, v30, v62, v63
    v_fma_f32 v31, v31, v62, v63
    v_cvt_pk_bf16_f32 v194, v28, v29
    v_cvt_pk_bf16_f32 v195, v30, v31
    v_mfma_f32_32x32x16_bf16 a[80:95], a[140:143], v[188:191], a[80:95]
    s_waitcnt lgkmcnt(6)
    v_mfma_f32_32x32x16_bf16 a[0:15], a[96:99], v[192:195], a[0:15]
    ds_read_b64_tr_b16 a[120:121], v12 offset:51200
    ds_read_b64_tr_b16 a[122:123], v12 offset:51712
    ds_read_b64_tr_b16 a[124:125], v14 offset:51200
    v_lshlrev_b32 v24, 16, v196
    v_and_b32 v25, s96, v196
    v_lshlrev_b32 v26, 16, v197
    v_and_b32 v27, s96, v197
    s_add_u32 m0, s40, 8192
    s_nop 0
    buffer_load_dwordx4 v5, s[16:19], s44 offen lds
    buffer_load_dwordx4 v5, s[16:19], s45 offen offset:1024 lds
    v_add_u32 v5, s92, v5
    v_mfma_f32_32x32x16_bf16 a[16:31], a[100:103], v[192:195], a[16:31]
    ds_read_b64_tr_b16 a[126:127], v14 offset:51712
    ds_read_b64_tr_b16 a[128:129], v16 offset:51200
    v_fma_f32 v24, v24, v62, v63
    v_fma_f32 v25, v25, v62, v63
    v_fma_f32 v26, v26, v62, v63
    v_fma_f32 v27, v27, v62, v63
    v_mfma_f32_32x32x16_bf16 a[32:47], a[104:107], v[192:195], a[32:47]
    ds_read_b64_tr_b16 a[130:131], v16 offset:51712
    ds_read_b64_tr_b16 a[132:133], v18 offset:51200
    ds_read_b64_tr_b16 a[134:135], v18 offset:51712
    v_cvt_pk_bf16_f32 v196, v24, v25
    v_cvt_pk_bf16_f32 v197, v26, v27
    v_lshlrev_b32 v28, 16, v198
    v_and_b32 v29, s96, v198
    s_waitcnt lgkmcnt(8)
    v_mfma_f32_32x32x16_bf16 a[48:63], a[108:111], v[192:195], a[48:63]
    ds_read_b64_tr_b16 a[136:137], v20 offset:55296
    ds_read_b64_tr_b16 a[138:139], v20 offset:55552
    v_lshlrev_b32 v30, 16, v199
    v_and_b32 v31, s96, v199
    v_fma_f32 v28, v28, v62, v63
    v_fma_f32 v29, v29, v62, v63
    v_mfma_f32_32x32x16_bf16 a[64:79], a[112:115], v[192:195], a[64:79]
    ds_read_b64_tr_b16 a[140:141], v22 offset:55296
    ds_read_b64_tr_b16 a[142:143], v22 offset:55552
    v_fma_f32 v30, v30, v62, v63
    v_fma_f32 v31, v31, v62, v63
    v_cvt_pk_bf16_f32 v198, v28, v29
    v_cvt_pk_bf16_f32 v199, v30, v31
    v_mfma_f32_32x32x16_bf16 a[80:95], a[116:119], v[192:195], a[80:95]
    s_waitcnt lgkmcnt(6)
    v_mfma_f32_32x32x16_bf16 a[0:15], a[120:123], v[196:199], a[0:15]
    ds_read_b64_tr_b16 a[96:97], v13 offset:18432
    ds_read_b64_tr_b16 a[98:99], v13 offset:18944
    ds_read_b64_tr_b16 a[100:101], v15 offset:18432
    v_lshlrev_b32 v24, 16, v200
    v_and_b32 v25, s96, v200
    v_lshlrev_b32 v26, 16, v201
    v_and_b32 v27, s96, v201
    s_add_u32 m0, s40, 10240
    s_nop 0
    buffer_load_dwordx4 v6, s[12:15], s46 offen lds
    s_add_u32 m0, s40, 11264
    s_nop 0
    buffer_load_dwordx4 v7, s[16:19], s46 offen lds
    v_mfma_f32_32x32x16_bf16 a[16:31], a[124:127], v[196:199], a[16:31]
    ds_read_b64_tr_b16 a[102:103], v15 offset:18944
    ds_read_b64_tr_b16 a[104:105], v17 offset:18432
    v_fma_f32 v24, v24, v62, v63
    v_fma_f32 v25, v25, v62, v63
    v_fma_f32 v26, v26, v62, v63
    v_fma_f32 v27, v27, v62, v63
    v_mfma_f32_32x32x16_bf16 a[32:47], a[128:131], v[196:199], a[32:47]
    ds_read_b64_tr_b16 a[106:107], v17 offset:18944
    ds_read_b64_tr_b16 a[108:109], v19 offset:18432
    ds_read_b64_tr_b16 a[110:111], v19 offset:18944
    v_cvt_pk_bf16_f32 v200, v24, v25
    v_cvt_pk_bf16_f32 v201, v26, v27
    v_lshlrev_b32 v28, 16, v202
    v_and_b32 v29, s96, v202
    s_waitcnt lgkmcnt(8)
    v_mfma_f32_32x32x16_bf16 a[48:63], a[132:135], v[196:199], a[48:63]
    ds_read_b64_tr_b16 a[112:113], v21 offset:22528
    ds_read_b64_tr_b16 a[114:115], v21 offset:22784
    v_lshlrev_b32 v30, 16, v203
    v_and_b32 v31, s96, v203
    v_fma_f32 v28, v28, v62, v63
    v_fma_f32 v29, v29, v62, v63
    v_mfma_f32_32x32x16_bf16 a[64:79], a[136:139], v[196:199], a[64:79]
    ds_read_b64_tr_b16 a[116:117], v23 offset:22528
    ds_read_b64_tr_b16 a[118:119], v23 offset:22784
    v_fma_f32 v30, v30, v62, v63
    v_fma_f32 v31, v31, v62, v63
    v_cvt_pk_bf16_f32 v202, v28, v29
    v_cvt_pk_bf16_f32 v203, v30, v31
    v_mfma_f32_32x32x16_bf16 a[80:95], a[140:143], v[196:199], a[80:95]
    s_waitcnt lgkmcnt(6)
    v_mfma_f32_32x32x16_bf16 a[0:15], a[96:99], v[200:203], a[0:15]
    ds_read_b64_tr_b16 a[120:121], v13 offset:51200
    ds_read_b64_tr_b16 a[122:123], v13 offset:51712
    ds_read_b64_tr_b16 a[124:125], v15 offset:51200
    v_lshlrev_b32 v24, 16, v204
    v_and_b32 v25, s96, v204
    v_lshlrev_b32 v26, 16, v205
    v_and_b32 v27, s96, v205
    s_waitcnt vmcnt(21)
    ds_read_b64_tr_b16 a[168:169], v8 offset:0
    v_mfma_f32_32x32x16_bf16 a[16:31], a[100:103], v[200:203], a[16:31]
    ds_read_b64_tr_b16 a[126:127], v15 offset:51712
    ds_read_b64_tr_b16 a[128:129], v17 offset:51200
    v_fma_f32 v24, v24, v62, v63
    v_fma_f32 v25, v25, v62, v63
    v_fma_f32 v26, v26, v62, v63
    v_fma_f32 v27, v27, v62, v63
    ds_read_b64_tr_b16 a[170:171], v8 offset:1024
    v_mfma_f32_32x32x16_bf16 a[32:47], a[104:107], v[200:203], a[32:47]
    ds_read_b64_tr_b16 a[130:131], v17 offset:51712
    ds_read_b64_tr_b16 a[132:133], v19 offset:51200
    v_cvt_pk_bf16_f32 v204, v24, v25
    v_cvt_pk_bf16_f32 v205, v26, v27
    v_lshlrev_b32 v28, 16, v206
    v_and_b32 v29, s96, v206
    s_waitcnt lgkmcnt(9)
    v_mfma_f32_32x32x16_bf16 a[48:63], a[108:111], v[200:203], a[48:63]
    s_barrier
    ds_read_b64_tr_b16 a[134:135], v19 offset:51712
    ds_read_b64_tr_b16 a[136:137], v21 offset:55296
    ds_read_b64_tr_b16 a[138:139], v21 offset:55552
    v_lshlrev_b32 v30, 16, v207
    v_and_b32 v31, s96, v207
    v_fma_f32 v28, v28, v62, v63
    v_fma_f32 v29, v29, v62, v63
    ds_read_b64_tr_b16 a[172:173], v9 offset:0
    v_mfma_f32_32x32x16_bf16 a[64:79], a[112:115], v[200:203], a[64:79]
    ds_read_b64_tr_b16 a[140:141], v23 offset:55296
    ds_read_b64_tr_b16 a[142:143], v23 offset:55552
    v_fma_f32 v30, v30, v62, v63
    v_fma_f32 v31, v31, v62, v63
    v_cvt_pk_bf16_f32 v206, v28, v29
    v_cvt_pk_bf16_f32 v207, v30, v31
    ds_read_b64_tr_b16 a[174:175], v9 offset:1024
    v_mfma_f32_32x32x16_bf16 a[80:95], a[116:119], v[200:203], a[80:95]
    s_waitcnt lgkmcnt(8)
    v_mfma_f32_32x32x16_bf16 a[0:15], a[120:123], v[204:207], a[0:15]
    ds_read_b64_tr_b16 a[96:97], v12 offset:24576
    ds_read_b64_tr_b16 a[98:99], v12 offset:25088
    ds_read_b64_tr_b16 a[100:101], v14 offset:24576
    v_lshlrev_b32 v24, 16, v208
    v_and_b32 v25, s96, v208
    v_lshlrev_b32 v26, 16, v209
    v_and_b32 v27, s96, v209
    s_waitcnt vmcnt(19)
    ds_read_b64_tr_b16 a[176:177], v8 offset:2048
    s_add_u32 m0, s40, 12288
    s_cmp_eq_u32 s69, 0
    s_cselect_b32 s92, s91, s90
    buffer_load_dwordx4 v4, s[12:15], s50 offen lds
    buffer_load_dwordx4 v4, s[12:15], s51 offen offset:1024 lds
    v_add_u32 v4, s92, v4
    v_mfma_f32_32x32x16_bf16 a[16:31], a[124:127], v[204:207], a[16:31]
    ds_read_b64_tr_b16 a[102:103], v14 offset:25088
    ds_read_b64_tr_b16 a[104:105], v16 offset:24576
    v_fma_f32 v24, v24, v62, v63
    v_fma_f32 v25, v25, v62, v63
    v_fma_f32 v26, v26, v62, v63
    v_fma_f32 v27, v27, v62, v63
    ds_read_b64_tr_b16 a[178:179], v8 offset:3072
    v_mfma_f32_32x32x16_bf16 a[32:47], a[128:131], v[204:207], a[32:47]
    ds_read_b64_tr_b16 a[106:107], v16 offset:25088
    ds_read_b64_tr_b16 a[108:109], v18 offset:24576
    ds_read_b64_tr_b16 a[110:111], v18 offset:25088
    v_cvt_pk_bf16_f32 v208, v24, v25
    v_cvt_pk_bf16_f32 v209, v26, v27
    v_lshlrev_b32 v28, 16, v210
    v_and_b32 v29, s96, v210
    ds_read_b64_tr_b16 a[180:181], v9 offset:2048
    s_waitcnt lgkmcnt(11)
    s_add_u32 m0, s68, 0
    v_add_u32 v3, 0x4000, v3
    buffer_load_dwordx4 v3, s[24:27], s63 offen lds
    buffer_load_dwordx4 v3, s[24:27], s64 offen offset:1024 lds
    v_mfma_f32_32x32x16_bf16 a[48:63], a[132:135], v[204:207], a[48:63]
    ds_read_b64_tr_b16 a[112:113], v20 offset:28672
    ds_read_b64_tr_b16 a[114:115], v20 offset:28928
    v_lshlrev_b32 v30, 16, v211
    v_and_b32 v31, s96, v211
    v_fma_f32 v28, v28, v62, v63
    v_fma_f32 v29, v29, v62, v63
    ds_read_b64_tr_b16 a[182:183], v9 offset:3072
    v_mfma_f32_32x32x16_bf16 a[64:79], a[136:139], v[204:207], a[64:79]
    ds_read_b64_tr_b16 a[116:117], v22 offset:28672
    ds_read_b64_tr_b16 a[118:119], v22 offset:28928
    v_fma_f32 v30, v30, v62, v63
    v_fma_f32 v31, v31, v62, v63
    v_cvt_pk_bf16_f32 v210, v28, v29
    v_cvt_pk_bf16_f32 v211, v30, v31
    v_mfma_f32_32x32x16_bf16 a[80:95], a[140:143], v[204:207], a[80:95]
    s_waitcnt lgkmcnt(8)
    v_mfma_f32_32x32x16_bf16 a[0:15], a[96:99], v[208:211], a[0:15]
    ds_read_b64_tr_b16 a[120:121], v12 offset:57344
    ds_read_b64_tr_b16 a[122:123], v12 offset:57856
    ds_read_b64_tr_b16 a[124:125], v14 offset:57344
    v_lshlrev_b32 v24, 16, v212
    v_and_b32 v25, s96, v212
    v_lshlrev_b32 v26, 16, v213
    v_and_b32 v27, s96, v213
    s_waitcnt vmcnt(21)
    ds_read_b64_tr_b16 a[184:185], v8 offset:4096
    s_add_u32 m0, s40, 14336
    s_nop 0
    buffer_load_dwordx4 v5, s[16:19], s50 offen lds
    buffer_load_dwordx4 v5, s[16:19], s51 offen offset:1024 lds
    v_add_u32 v5, s92, v5
    v_mfma_f32_32x32x16_bf16 a[16:31], a[100:103], v[208:211], a[16:31]
    ds_read_b64_tr_b16 a[126:127], v14 offset:57856
    ds_read_b64_tr_b16 a[128:129], v16 offset:57344
    v_fma_f32 v24, v24, v62, v63
    v_fma_f32 v25, v25, v62, v63
    v_fma_f32 v26, v26, v62, v63
    v_fma_f32 v27, v27, v62, v63
    ds_read_b64_tr_b16 a[186:187], v8 offset:5120
    v_mfma_f32_32x32x16_bf16 a[32:47], a[104:107], v[208:211], a[32:47]
    ds_read_b64_tr_b16 a[130:131], v16 offset:57856
    ds_read_b64_tr_b16 a[132:133], v18 offset:57344
    ds_read_b64_tr_b16 a[134:135], v18 offset:57856
    v_cvt_pk_bf16_f32 v212, v24, v25
    v_cvt_pk_bf16_f32 v213, v26, v27
    v_lshlrev_b32 v28, 16, v214
    v_and_b32 v29, s96, v214
    ds_read_b64_tr_b16 a[188:189], v9 offset:4096
    s_waitcnt lgkmcnt(13)
    s_add_u32 m0, s68, 2048
    v_add_u32 v3, 0x4000, v3
    buffer_load_dwordx4 v3, s[24:27], s63 offen lds
    buffer_load_dwordx4 v3, s[24:27], s64 offen offset:1024 lds
    s_waitcnt lgkmcnt(11)
    v_mfma_f32_32x32x16_bf16 a[48:63], a[108:111], v[208:211], a[48:63]
    ds_read_b64_tr_b16 a[136:137], v20 offset:61440
    ds_read_b64_tr_b16 a[138:139], v20 offset:61696
    v_lshlrev_b32 v30, 16, v215
    v_and_b32 v31, s96, v215
    v_fma_f32 v28, v28, v62, v63
    v_fma_f32 v29, v29, v62, v63
    ds_read_b64_tr_b16 a[190:191], v9 offset:5120
    v_mfma_f32_32x32x16_bf16 a[64:79], a[112:115], v[208:211], a[64:79]
    ds_read_b64_tr_b16 a[140:141], v22 offset:61440
    ds_read_b64_tr_b16 a[142:143], v22 offset:61696
    v_fma_f32 v30, v30, v62, v63
    v_fma_f32 v31, v31, v62, v63
    v_cvt_pk_bf16_f32 v214, v28, v29
    v_cvt_pk_bf16_f32 v215, v30, v31
    v_mfma_f32_32x32x16_bf16 a[80:95], a[116:119], v[208:211], a[80:95]
    s_waitcnt lgkmcnt(8)
    v_mfma_f32_32x32x16_bf16 a[0:15], a[120:123], v[212:215], a[0:15]
    ds_read_b64_tr_b16 a[96:97], v13 offset:24576
    ds_read_b64_tr_b16 a[98:99], v13 offset:25088
    ds_read_b64_tr_b16 a[100:101], v15 offset:24576
    v_lshlrev_b32 v24, 16, v216
    v_and_b32 v25, s96, v216
    v_lshlrev_b32 v26, 16, v217
    v_and_b32 v27, s96, v217
    s_waitcnt vmcnt(22)
    ds_read_b64_tr_b16 a[192:193], v8 offset:6144
    s_waitcnt lgkmcnt(6)
    s_add_u32 m0, s68, 4096
    s_mov_b32 s59, 0x4000
    s_cmp_eq_u32 s101, 8
    s_cselect_b32 s59, 0xfff94000, s59
    v_add_u32 v3, s59, v3
    buffer_load_dwordx4 v3, s[24:27], s63 offen lds
    buffer_load_dwordx4 v3, s[24:27], s64 offen offset:1024 lds
    v_mfma_f32_32x32x16_bf16 a[16:31], a[124:127], v[212:215], a[16:31]
    ds_read_b64_tr_b16 a[102:103], v15 offset:25088
    ds_read_b64_tr_b16 a[104:105], v17 offset:24576
    v_fma_f32 v24, v24, v62, v63
    v_fma_f32 v25, v25, v62, v63
    v_fma_f32 v26, v26, v62, v63
    v_fma_f32 v27, v27, v62, v63
    ds_read_b64_tr_b16 a[194:195], v8 offset:7168
    v_mfma_f32_32x32x16_bf16 a[32:47], a[128:131], v[212:215], a[32:47]
    ds_read_b64_tr_b16 a[106:107], v17 offset:25088
    ds_read_b64_tr_b16 a[108:109], v19 offset:24576
    ds_read_b64_tr_b16 a[110:111], v19 offset:25088
    v_cvt_pk_bf16_f32 v216, v24, v25
    v_cvt_pk_bf16_f32 v217, v26, v27
    v_lshlrev_b32 v28, 16, v218
    v_and_b32 v29, s96, v218
    ds_read_b64_tr_b16 a[196:197], v9 offset:6144
    s_waitcnt lgkmcnt(11)
    v_mfma_f32_32x32x16_bf16 a[48:63], a[132:135], v[212:215], a[48:63]
    ds_read_b64_tr_b16 a[112:113], v21 offset:28672
    ds_read_b64_tr_b16 a[114:115], v21 offset:28928
    v_lshlrev_b32 v30, 16, v219
    v_and_b32 v31, s96, v219
    v_fma_f32 v28, v28, v62, v63
    v_fma_f32 v29, v29, v62, v63
    ds_read_b64_tr_b16 a[198:199], v9 offset:7168
    v_mfma_f32_32x32x16_bf16 a[64:79], a[136:139], v[212:215], a[64:79]
    ds_read_b64_tr_b16 a[116:117], v23 offset:28672
    ds_read_b64_tr_b16 a[118:119], v23 offset:28928
    v_fma_f32 v30, v30, v62, v63
    v_fma_f32 v31, v31, v62, v63
    v_cvt_pk_bf16_f32 v218, v28, v29
    v_cvt_pk_bf16_f32 v219, v30, v31
    v_mfma_f32_32x32x16_bf16 a[80:95], a[140:143], v[212:215], a[80:95]
    s_waitcnt lgkmcnt(8)
    v_mfma_f32_32x32x16_bf16 a[0:15], a[96:99], v[216:219], a[0:15]
    ds_read_b64_tr_b16 a[120:121], v13 offset:57344
    ds_read_b64_tr_b16 a[122:123], v13 offset:57856
    ds_read_b64_tr_b16 a[124:125], v15 offset:57344
    v_lshlrev_b32 v24, 16, v220
    v_and_b32 v25, s96, v220
    v_lshlrev_b32 v26, 16, v221
    v_and_b32 v27, s96, v221
    v_mfma_f32_32x32x16_bf16 a[16:31], a[100:103], v[216:219], a[16:31]
    ds_read_b64_tr_b16 a[126:127], v15 offset:57856
    ds_read_b64_tr_b16 a[128:129], v17 offset:57344
    v_fma_f32 v24, v24, v62, v63
    v_fma_f32 v25, v25, v62, v63
    v_fma_f32 v26, v26, v62, v63
    v_fma_f32 v27, v27, v62, v63
    v_mfma_f32_32x32x16_bf16 a[32:47], a[104:107], v[216:219], a[32:47]
    ds_read_b64_tr_b16 a[130:131], v17 offset:57856
    ds_read_b64_tr_b16 a[132:133], v19 offset:57344
    v_cvt_pk_bf16_f32 v220, v24, v25
    v_cvt_pk_bf16_f32 v221, v26, v27
    v_lshlrev_b32 v28, 16, v222
    v_and_b32 v29, s96, v222
    s_waitcnt lgkmcnt(7)
    v_mfma_f32_32x32x16_bf16 a[48:63], a[108:111], v[216:219], a[48:63]
    s_waitcnt vmcnt(18)
    s_barrier
    ds_read_b64_tr_b16 a[134:135], v19 offset:57856
    ds_read_b64_tr_b16 a[136:137], v21 offset:61440
    ds_read_b64_tr_b16 a[138:139], v21 offset:61696
    v_lshlrev_b32 v30, 16, v223
    v_and_b32 v31, s96, v223
    v_fma_f32 v28, v28, v62, v63
    v_fma_f32 v29, v29, v62, v63
    s_add_u32 m0, s68, 6144
    v_add_u32 v3, 0x4000, v3
    buffer_load_dwordx4 v3, s[24:27], s63 offen lds
    buffer_load_dwordx4 v3, s[24:27], s64 offen offset:1024 lds
    v_mfma_f32_32x32x16_bf16 a[64:79], a[112:115], v[216:219], a[64:79]
    ds_read_b64_tr_b16 a[140:141], v23 offset:61440
    ds_read_b64_tr_b16 a[142:143], v23 offset:61696
    v_fma_f32 v30, v30, v62, v63
    v_fma_f32 v31, v31, v62, v63
    v_cvt_pk_bf16_f32 v222, v28, v29
    v_cvt_pk_bf16_f32 v223, v30, v31
    v_mfma_f32_32x32x16_bf16 a[80:95], a[116:119], v[216:219], a[80:95]
    s_waitcnt lgkmcnt(6)
    v_mfma_f32_32x32x16_bf16 a[0:15], a[120:123], v[220:223], a[0:15]
    ds_read_b64_tr_b16 a[96:97], v12 offset:0
    ds_read_b64_tr_b16 a[98:99], v12 offset:512
    ds_read_b64_tr_b16 a[100:101], v14 offset:0
    v_lshlrev_b32 v24, 16, v224
    v_and_b32 v25, s96, v224
    v_lshlrev_b32 v26, 16, v225
    v_and_b32 v27, s96, v225
    s_add_u32 m0, s40, 18432
    s_cmp_eq_u32 s69, 1
    s_cselect_b32 s92, s91, s90
    buffer_load_dwordx4 v4, s[12:15], s50 offen lds
    buffer_load_dwordx4 v4, s[12:15], s51 offen offset:1024 lds
    v_add_u32 v4, s92, v4
    v_mfma_f32_32x32x16_bf16 a[16:31], a[124:127], v[220:223], a[16:31]
    ds_read_b64_tr_b16 a[102:103], v14 offset:512
    ds_read_b64_tr_b16 a[104:105], v16 offset:0
    v_fma_f32 v24, v24, v62, v63
    v_fma_f32 v25, v25, v62, v63
    v_fma_f32 v26, v26, v62, v63
    v_fma_f32 v27, v27, v62, v63
    v_mfma_f32_32x32x16_bf16 a[32:47], a[128:131], v[220:223], a[32:47]
    ds_read_b64_tr_b16 a[106:107], v16 offset:512
    ds_read_b64_tr_b16 a[108:109], v18 offset:0
    ds_read_b64_tr_b16 a[110:111], v18 offset:512
    v_cvt_pk_bf16_f32 v224, v24, v25
    v_cvt_pk_bf16_f32 v225, v26, v27
    v_lshlrev_b32 v28, 16, v226
    v_and_b32 v29, s96, v226
    s_waitcnt lgkmcnt(8)
    v_mfma_f32_32x32x16_bf16 a[48:63], a[132:135], v[220:223], a[48:63]
    ds_read_b64_tr_b16 a[112:113], v20 offset:4096
    ds_read_b64_tr_b16 a[114:115], v20 offset:4352
    v_lshlrev_b32 v30, 16, v227
    v_and_b32 v31, s96, v227
    v_fma_f32 v28, v28, v62, v63
    v_fma_f32 v29, v29, v62, v63
    v_mfma_f32_32x32x16_bf16 a[64:79], a[136:139], v[220:223], a[64:79]
    ds_read_b64_tr_b16 a[116:117], v22 offset:4096
    ds_read_b64_tr_b16 a[118:119], v22 offset:4352
    v_fma_f32 v30, v30, v62, v63
    v_fma_f32 v31, v31, v62, v63
    v_cvt_pk_bf16_f32 v226, v28, v29
    v_cvt_pk_bf16_f32 v227, v30, v31
    v_mfma_f32_32x32x16_bf16 a[80:95], a[140:143], v[220:223], a[80:95]
    s_waitcnt lgkmcnt(6)
    v_mfma_f32_32x32x16_bf16 a[0:15], a[96:99], v[224:227], a[0:15]
    ds_read_b64_tr_b16 a[120:121], v12 offset:32768
    ds_read_b64_tr_b16 a[122:123], v12 offset:33280
    ds_read_b64_tr_b16 a[124:125], v14 offset:32768
    v_lshlrev_b32 v24, 16, v228
    v_and_b32 v25, s96, v228
    v_lshlrev_b32 v26, 16, v229
    v_and_b32 v27, s96, v229
    s_add_u32 m0, s40, 20480
    s_nop 0
    buffer_load_dwordx4 v5, s[16:19], s50 offen lds
    buffer_load_dwordx4 v5, s[16:19], s51 offen offset:1024 lds
    v_add_u32 v5, s92, v5
    v_mfma_f32_32x32x16_bf16 a[16:31], a[100:103], v[224:227], a[16:31]
    ds_read_b64_tr_b16 a[126:127], v14 offset:33280
    ds_read_b64_tr_b16 a[128:129], v16 offset:32768
    v_fma_f32 v24, v24, v62, v63
    v_fma_f32 v25, v25, v62, v63
    v_fma_f32 v26, v26, v62, v63
    v_fma_f32 v27, v27, v62, v63
    v_mfma_f32_32x32x16_bf16 a[32:47], a[104:107], v[224:227], a[32:47]
    ds_read_b64_tr_b16 a[130:131], v16 offset:33280
    ds_read_b64_tr_b16 a[132:133], v18 offset:32768
    ds_read_b64_tr_b16 a[134:135], v18 offset:33280
    v_cvt_pk_bf16_f32 v228, v24, v25
    v_cvt_pk_bf16_f32 v229, v26, v27
    v_lshlrev_b32 v28, 16, v230
    v_and_b32 v29, s96, v230
    s_waitcnt lgkmcnt(8)
    v_mfma_f32_32x32x16_bf16 a[48:63], a[108:111], v[224:227], a[48:63]
    ds_read_b64_tr_b16 a[136:137], v20 offset:36864
    ds_read_b64_tr_b16 a[138:139], v20 offset:37120
    v_lshlrev_b32 v30, 16, v231
    v_and_b32 v31, s96, v231
    v_fma_f32 v28, v28, v62, v63
    v_fma_f32 v29, v29, v62, v63
    v_mfma_f32_32x32x16_bf16 a[64:79], a[112:115], v[224:227], a[64:79]
    ds_read_b64_tr_b16 a[140:141], v22 offset:36864
    ds_read_b64_tr_b16 a[142:143], v22 offset:37120
    v_fma_f32 v30, v30, v62, v63
    v_fma_f32 v31, v31, v62, v63
    v_cvt_pk_bf16_f32 v230, v28, v29
    v_cvt_pk_bf16_f32 v231, v30, v31
    v_mfma_f32_32x32x16_bf16 a[80:95], a[116:119], v[224:227], a[80:95]
    s_waitcnt lgkmcnt(6)
    v_mfma_f32_32x32x16_bf16 a[0:15], a[120:123], v[228:231], a[0:15]
    ds_read_b64_tr_b16 a[96:97], v13 offset:0
    ds_read_b64_tr_b16 a[98:99], v13 offset:512
    ds_read_b64_tr_b16 a[100:101], v15 offset:0
    v_lshlrev_b32 v24, 16, v232
    v_and_b32 v25, s96, v232
    v_lshlrev_b32 v26, 16, v233
    v_and_b32 v27, s96, v233
    v_mfma_f32_32x32x16_bf16 a[16:31], a[124:127], v[228:231], a[16:31]
    ds_read_b64_tr_b16 a[102:103], v15 offset:512
    ds_read_b64_tr_b16 a[104:105], v17 offset:0
    v_fma_f32 v24, v24, v62, v63
    v_fma_f32 v25, v25, v62, v63
    v_fma_f32 v26, v26, v62, v63
    v_fma_f32 v27, v27, v62, v63
    v_mfma_f32_32x32x16_bf16 a[32:47], a[128:131], v[228:231], a[32:47]
    ds_read_b64_tr_b16 a[106:107], v17 offset:512
    ds_read_b64_tr_b16 a[108:109], v19 offset:0
    ds_read_b64_tr_b16 a[110:111], v19 offset:512
    v_cvt_pk_bf16_f32 v232, v24, v25
    v_cvt_pk_bf16_f32 v233, v26, v27
    v_lshlrev_b32 v28, 16, v234
    v_and_b32 v29, s96, v234
    s_waitcnt lgkmcnt(8)
    v_mfma_f32_32x32x16_bf16 a[48:63], a[132:135], v[228:231], a[48:63]
    ds_read_b64_tr_b16 a[112:113], v21 offset:4096
    ds_read_b64_tr_b16 a[114:115], v21 offset:4352
    v_lshlrev_b32 v30, 16, v235
    v_and_b32 v31, s96, v235
    v_fma_f32 v28, v28, v62, v63
    v_fma_f32 v29, v29, v62, v63
    v_mfma_f32_32x32x16_bf16 a[64:79], a[136:139], v[228:231], a[64:79]
    ds_read_b64_tr_b16 a[116:117], v23 offset:4096
    ds_read_b64_tr_b16 a[118:119], v23 offset:4352
    v_fma_f32 v30, v30, v62, v63
    v_fma_f32 v31, v31, v62, v63
    v_cvt_pk_bf16_f32 v234, v28, v29
    v_cvt_pk_bf16_f32 v235, v30, v31
    v_mfma_f32_32x32x16_bf16 a[80:95], a[140:143], v[228:231], a[80:95]
    s_waitcnt lgkmcnt(6)
    v_mfma_f32_32x32x16_bf16 a[0:15], a[96:99], v[232:235], a[0:15]
    ds_read_b64_tr_b16 a[120:121], v13 offset:32768
    ds_read_b64_tr_b16 a[122:123], v13 offset:33280
    ds_read_b64_tr_b16 a[124:125], v15 offset:32768
    v_lshlrev_b32 v24, 16, v236
    v_and_b32 v25, s96, v236
    v_lshlrev_b32 v26, 16, v237
    v_and_b32 v27, s96, v237
    s_waitcnt vmcnt(20)
    ds_read_b64_tr_b16 a[200:201], v10 offset:30720
    v_mfma_f32_32x32x16_bf16 a[16:31], a[100:103], v[232:235], a[16:31]
    ds_read_b64_tr_b16 a[126:127], v15 offset:33280
    ds_read_b64_tr_b16 a[128:129], v17 offset:32768
    v_fma_f32 v24, v24, v62, v63
    v_fma_f32 v25, v25, v62, v63
    v_fma_f32 v26, v26, v62, v63
    v_fma_f32 v27, v27, v62, v63
    ds_read_b64_tr_b16 a[202:203], v10 offset:31744
    v_mfma_f32_32x32x16_bf16 a[32:47], a[104:107], v[232:235], a[32:47]
    ds_read_b64_tr_b16 a[130:131], v17 offset:33280
    ds_read_b64_tr_b16 a[132:133], v19 offset:32768
    v_cvt_pk_bf16_f32 v236, v24, v25
    v_cvt_pk_bf16_f32 v237, v26, v27
    v_lshlrev_b32 v28, 16, v238
    v_and_b32 v29, s96, v238
    s_waitcnt lgkmcnt(9)
    v_mfma_f32_32x32x16_bf16 a[48:63], a[108:111], v[232:235], a[48:63]
    s_waitcnt vmcnt(16)
    s_barrier
    ds_read_b64_tr_b16 a[134:135], v19 offset:33280
    ds_read_b64_tr_b16 a[136:137], v21 offset:36864
    ds_read_b64_tr_b16 a[138:139], v21 offset:37120
    v_lshlrev_b32 v30, 16, v239
    v_and_b32 v31, s96, v239
    v_fma_f32 v28, v28, v62, v63
    v_fma_f32 v29, v29, v62, v63
    ds_read_b64_tr_b16 a[204:205], v11 offset:30720
    v_mfma_f32_32x32x16_bf16 a[64:79], a[112:115], v[232:235], a[64:79]
    ds_read_b64_tr_b16 a[140:141], v23 offset:36864
    ds_read_b64_tr_b16 a[142:143], v23 offset:37120
    v_fma_f32 v30, v30, v62, v63
    v_fma_f32 v31, v31, v62, v63
    v_cvt_pk_bf16_f32 v238, v28, v29
    v_cvt_pk_bf16_f32 v239, v30, v31
    ds_read_b64_tr_b16 a[206:207], v11 offset:31744
    v_mfma_f32_32x32x16_bf16 a[80:95], a[116:119], v[232:235], a[80:95]
    s_waitcnt lgkmcnt(8)
    v_mfma_f32_32x32x16_bf16 a[0:15], a[120:123], v[236:239], a[0:15]
    ds_read_b64_tr_b16 a[96:97], v12 offset:6144
    ds_read_b64_tr_b16 a[98:99], v12 offset:6656
    ds_read_b64_tr_b16 a[100:101], v14 offset:6144
    v_lshlrev_b32 v24, 16, v240
    v_and_b32 v25, s96, v240
    v_lshlrev_b32 v26, 16, v241
    v_and_b32 v27, s96, v241
    s_add_u32 m0, s40, 24576
    s_cmp_eq_u32 s69, 2
    s_cselect_b32 s92, s91, s90
    buffer_load_dwordx4 v4, s[12:15], s50 offen lds
    buffer_load_dwordx4 v4, s[12:15], s51 offen offset:1024 lds
    v_add_u32 v4, s92, v4
    v_mfma_f32_32x32x16_bf16 a[16:31], a[124:127], v[236:239], a[16:31]
    ds_read_b64_tr_b16 a[102:103], v14 offset:6656
    ds_read_b64_tr_b16 a[104:105], v16 offset:6144
    v_fma_f32 v24, v24, v62, v63
    v_fma_f32 v25, v25, v62, v63
    v_fma_f32 v26, v26, v62, v63
    v_fma_f32 v27, v27, v62, v63
    v_mfma_f32_32x32x16_bf16 a[32:47], a[128:131], v[236:239], a[32:47]
    ds_read_b64_tr_b16 a[106:107], v16 offset:6656
    ds_read_b64_tr_b16 a[108:109], v18 offset:6144
    ds_read_b64_tr_b16 a[110:111], v18 offset:6656
    v_cvt_pk_bf16_f32 v240, v24, v25
    v_cvt_pk_bf16_f32 v241, v26, v27
    v_lshlrev_b32 v28, 16, v242
    v_and_b32 v29, s96, v242
    s_waitcnt lgkmcnt(8)
    s_add_u32 m0, s40, 30720
    v_add_u32 v3, 0x4000, v3
    buffer_load_dwordx4 v3, s[24:27], s63 offen lds
    buffer_load_dwordx4 v3, s[24:27], s64 offen offset:1024 lds
    v_mfma_f32_32x32x16_bf16 a[48:63], a[132:135], v[236:239], a[48:63]
    ds_read_b64_tr_b16 a[112:113], v20 offset:10240
    ds_read_b64_tr_b16 a[114:115], v20 offset:10496
    v_lshlrev_b32 v30, 16, v243
    v_and_b32 v31, s96, v243
    v_fma_f32 v28, v28, v62, v63
    v_fma_f32 v29, v29, v62, v63
    v_mfma_f32_32x32x16_bf16 a[64:79], a[136:139], v[236:239], a[64:79]
    ds_read_b64_tr_b16 a[116:117], v22 offset:10240
    ds_read_b64_tr_b16 a[118:119], v22 offset:10496
    v_fma_f32 v30, v30, v62, v63
    v_fma_f32 v31, v31, v62, v63
    v_cvt_pk_bf16_f32 v242, v28, v29
    v_cvt_pk_bf16_f32 v243, v30, v31
    v_mfma_f32_32x32x16_bf16 a[80:95], a[140:143], v[236:239], a[80:95]
    s_waitcnt lgkmcnt(6)
    v_mfma_f32_32x32x16_bf16 a[0:15], a[96:99], v[240:243], a[0:15]
    ds_read_b64_tr_b16 a[120:121], v12 offset:38912
    ds_read_b64_tr_b16 a[122:123], v12 offset:39424
    ds_read_b64_tr_b16 a[124:125], v14 offset:38912
    v_lshlrev_b32 v24, 16, v244
    v_and_b32 v25, s96, v244
    v_lshlrev_b32 v26, 16, v245
    v_and_b32 v27, s96, v245
    s_add_u32 m0, s40, 26624
    s_nop 0
    buffer_load_dwordx4 v5, s[16:19], s50 offen lds
    buffer_load_dwordx4 v5, s[16:19], s51 offen offset:1024 lds
    v_add_u32 v5, s92, v5
    v_mfma_f32_32x32x16_bf16 a[16:31], a[100:103], v[240:243], a[16:31]
    ds_read_b64_tr_b16 a[126:127], v14 offset:39424
    ds_read_b64_tr_b16 a[128:129], v16 offset:38912
    v_fma_f32 v24, v24, v62, v63
    v_fma_f32 v25, v25, v62, v63
    v_fma_f32 v26, v26, v62, v63
    v_fma_f32 v27, v27, v62, v63
    v_mfma_f32_32x32x16_bf16 a[32:47], a[104:107], v[240:243], a[32:47]
    ds_read_b64_tr_b16 a[130:131], v16 offset:39424
    ds_read_b64_tr_b16 a[132:133], v18 offset:38912
    ds_read_b64_tr_b16 a[134:135], v18 offset:39424
    v_cvt_pk_bf16_f32 v244, v24, v25
    v_cvt_pk_bf16_f32 v245, v26, v27
    v_lshlrev_b32 v28, 16, v246
    v_and_b32 v29, s96, v246
    s_waitcnt lgkmcnt(8)
    v_mfma_f32_32x32x16_bf16 a[48:63], a[108:111], v[240:243], a[48:63]
    ds_read_b64_tr_b16 a[136:137], v20 offset:43008
    ds_read_b64_tr_b16 a[138:139], v20 offset:43264
    v_lshlrev_b32 v30, 16, v247
    v_and_b32 v31, s96, v247
    v_fma_f32 v28, v28, v62, v63
    v_fma_f32 v29, v29, v62, v63
    v_mfma_f32_32x32x16_bf16 a[64:79], a[112:115], v[240:243], a[64:79]
    ds_read_b64_tr_b16 a[140:141], v22 offset:43008
    ds_read_b64_tr_b16 a[142:143], v22 offset:43264
    v_fma_f32 v30, v30, v62, v63
    v_fma_f32 v31, v31, v62, v63
    v_cvt_pk_bf16_f32 v246, v28, v29
    v_cvt_pk_bf16_f32 v247, v30, v31
    v_mfma_f32_32x32x16_bf16 a[80:95], a[116:119], v[240:243], a[80:95]
    s_waitcnt lgkmcnt(6)
    v_mfma_f32_32x32x16_bf16 a[0:15], a[120:123], v[244:247], a[0:15]
    ds_read_b64_tr_b16 a[96:97], v13 offset:6144
    ds_read_b64_tr_b16 a[98:99], v13 offset:6656
    ds_read_b64_tr_b16 a[100:101], v15 offset:6144
    v_lshlrev_b32 v24, 16, v248
    v_and_b32 v25, s96, v248
    v_lshlrev_b32 v26, 16, v249
    v_and_b32 v27, s96, v249
    v_mfma_f32_32x32x16_bf16 a[16:31], a[124:127], v[244:247], a[16:31]
    ds_read_b64_tr_b16 a[102:103], v15 offset:6656
    ds_read_b64_tr_b16 a[104:105], v17 offset:6144
    v_fma_f32 v24, v24, v62, v63
    v_fma_f32 v25, v25, v62, v63
    v_fma_f32 v26, v26, v62, v63
    v_fma_f32 v27, v27, v62, v63
    v_mfma_f32_32x32x16_bf16 a[32:47], a[128:131], v[244:247], a[32:47]
    ds_read_b64_tr_b16 a[106:107], v17 offset:6656
    ds_read_b64_tr_b16 a[108:109], v19 offset:6144
    ds_read_b64_tr_b16 a[110:111], v19 offset:6656
    v_cvt_pk_bf16_f32 v248, v24, v25
    v_cvt_pk_bf16_f32 v249, v26, v27
    v_lshlrev_b32 v28, 16, v250
    v_and_b32 v29, s96, v250
    s_waitcnt lgkmcnt(8)
    v_mfma_f32_32x32x16_bf16 a[48:63], a[132:135], v[244:247], a[48:63]
    ds_read_b64_tr_b16 a[112:113], v21 offset:10240
    ds_read_b64_tr_b16 a[114:115], v21 offset:10496
    v_lshlrev_b32 v30, 16, v251
    v_and_b32 v31, s96, v251
    v_fma_f32 v28, v28, v62, v63
    v_fma_f32 v29, v29, v62, v63
    v_mfma_f32_32x32x16_bf16 a[64:79], a[136:139], v[244:247], a[64:79]
    ds_read_b64_tr_b16 a[116:117], v23 offset:10240
    ds_read_b64_tr_b16 a[118:119], v23 offset:10496
    v_fma_f32 v30, v30, v62, v63
    v_fma_f32 v31, v31, v62, v63
    v_cvt_pk_bf16_f32 v250, v28, v29
    v_cvt_pk_bf16_f32 v251, v30, v31
    v_mfma_f32_32x32x16_bf16 a[80:95], a[140:143], v[244:247], a[80:95]
    s_waitcnt lgkmcnt(6)
    v_mfma_f32_32x32x16_bf16 a[0:15], a[96:99], v[248:251], a[0:15]
    ds_read_b64_tr_b16 a[120:121], v13 offset:38912
    ds_read_b64_tr_b16 a[122:123], v13 offset:39424
    ds_read_b64_tr_b16 a[124:125], v15 offset:38912
    v_lshlrev_b32 v24, 16, v252
    v_and_b32 v25, s96, v252
    v_lshlrev_b32 v26, 16, v253
    v_and_b32 v27, s96, v253
    s_waitcnt vmcnt(18)
    ds_read_b64_tr_b16 a[208:209], v8 offset:0
    v_mfma_f32_32x32x16_bf16 a[16:31], a[100:103], v[248:251], a[16:31]
    ds_read_b64_tr_b16 a[126:127], v15 offset:39424
    ds_read_b64_tr_b16 a[128:129], v17 offset:38912
    v_fma_f32 v24, v24, v62, v63
    v_fma_f32 v25, v25, v62, v63
    v_fma_f32 v26, v26, v62, v63
    v_fma_f32 v27, v27, v62, v63
    ds_read_b64_tr_b16 a[210:211], v8 offset:1024
    v_mfma_f32_32x32x16_bf16 a[32:47], a[104:107], v[248:251], a[32:47]
    ds_read_b64_tr_b16 a[130:131], v17 offset:39424
    ds_read_b64_tr_b16 a[132:133], v19 offset:38912
    v_cvt_pk_bf16_f32 v252, v24, v25
    v_cvt_pk_bf16_f32 v253, v26, v27
    v_lshlrev_b32 v28, 16, v254
    v_and_b32 v29, s96, v254
    s_waitcnt lgkmcnt(9)
    v_mfma_f32_32x32x16_bf16 a[48:63], a[108:111], v[248:251], a[48:63]
    s_waitcnt vmcnt(16)
    s_barrier
    ds_read_b64_tr_b16 a[134:135], v19 offset:39424
    ds_read_b64_tr_b16 a[136:137], v21 offset:43008
    ds_read_b64_tr_b16 a[138:139], v21 offset:43264
    v_lshlrev_b32 v30, 16, v255
    v_and_b32 v31, s96, v255
    v_fma_f32 v28, v28, v62, v63
    v_fma_f32 v29, v29, v62, v63
    ds_read_b64_tr_b16 a[212:213], v9 offset:0
    v_mfma_f32_32x32x16_bf16 a[64:79], a[112:115], v[248:251], a[64:79]
    ds_read_b64_tr_b16 a[140:141], v23 offset:43008
    ds_read_b64_tr_b16 a[142:143], v23 offset:43264
    v_fma_f32 v30, v30, v62, v63
    v_fma_f32 v31, v31, v62, v63
    v_cvt_pk_bf16_f32 v254, v28, v29
    v_cvt_pk_bf16_f32 v255, v30, v31
    ds_read_b64_tr_b16 a[214:215], v9 offset:1024
    v_mfma_f32_32x32x16_bf16 a[80:95], a[116:119], v[248:251], a[80:95]
    s_waitcnt lgkmcnt(8)
    v_mfma_f32_32x32x16_bf16 a[0:15], a[120:123], v[252:255], a[0:15]
    ds_read_b64_tr_b16 a[96:97], v12 offset:12288
    ds_read_b64_tr_b16 a[98:99], v12 offset:12800
    s_waitcnt vmcnt(14)
    ds_read_b64_tr_b16 a[216:217], v8 offset:2048
    s_add_u32 m0, s40, 0
    s_cmp_eq_u32 s69, 3
    s_cselect_b32 s92, s91, s90
    buffer_load_dwordx4 v4, s[12:15], s50 offen lds
    buffer_load_dwordx4 v4, s[12:15], s51 offen offset:1024 lds
    v_add_u32 v4, s92, v4
    v_mfma_f32_32x32x16_bf16 a[16:31], a[124:127], v[252:255], a[16:31]
    ds_read_b64_tr_b16 a[100:101], v14 offset:12288
    ds_read_b64_tr_b16 a[102:103], v14 offset:12800
    ds_read_b64_tr_b16 a[218:219], v8 offset:3072
    v_mfma_f32_32x32x16_bf16 a[32:47], a[128:131], v[252:255], a[32:47]
    ds_read_b64_tr_b16 a[104:105], v16 offset:12288
    ds_read_b64_tr_b16 a[220:221], v9 offset:2048
    s_waitcnt lgkmcnt(8)
    s_add_u32 m0, s68, 0
    v_add_u32 v3, 0x4000, v3
    buffer_load_dwordx4 v3, s[24:27], s63 offen lds
    buffer_load_dwordx4 v3, s[24:27], s64 offen offset:1024 lds
    v_mfma_f32_32x32x16_bf16 a[48:63], a[132:135], v[252:255], a[48:63]
    ds_read_b64_tr_b16 a[106:107], v16 offset:12800
    ds_read_b64_tr_b16 a[108:109], v18 offset:12288
    ds_read_b64_tr_b16 a[222:223], v9 offset:3072
    v_mfma_f32_32x32x16_bf16 a[64:79], a[136:139], v[252:255], a[64:79]
    ds_read_b64_tr_b16 a[110:111], v18 offset:12800
    v_mfma_f32_32x32x16_bf16 a[80:95], a[140:143], v[252:255], a[80:95]
    s_waitcnt lgkmcnt(7)
    v_mfma_f32_32x32x16_bf16 v[64:79], a[96:99], v[128:131], 0
    ds_read_b64_tr_b16 a[112:113], v12 offset:45056
    ds_read_b64_tr_b16 a[114:115], v12 offset:45568
    ds_read_b64_tr_b16 a[116:117], v14 offset:45056
    v_accvgpr_read_b32 v32, a0
    v_accvgpr_read_b32 v33, a1
    v_accvgpr_read_b32 v34, a2
    v_accvgpr_read_b32 v35, a3
    s_waitcnt vmcnt(16)
    ds_read_b64_tr_b16 a[224:225], v8 offset:4096
    ds_read_b64_tr_b16 a[226:227], v8 offset:5120
    s_add_u32 m0, s40, 2048
    s_nop 0
    buffer_load_dwordx4 v5, s[16:19], s50 offen lds
    buffer_load_dwordx4 v5, s[16:19], s51 offen offset:1024 lds
    v_add_u32 v5, s92, v5
    v_mfma_f32_32x32x16_bf16 v[80:95], a[100:103], v[128:131], 0
    ds_read_b64_tr_b16 a[118:119], v14 offset:45568
    ds_read_b64_tr_b16 a[120:121], v16 offset:45056
    ds_read_b64_tr_b16 a[122:123], v16 offset:45568
    v_accvgpr_read_b32 v36, a8
    v_accvgpr_read_b32 v37, a9
    v_accvgpr_read_b32 v38, a10
    v_accvgpr_read_b32 v39, a11
    ds_read_b64_tr_b16 a[228:229], v9 offset:4096
    s_waitcnt lgkmcnt(9)
    v_mfma_f32_32x32x16_bf16 v[96:111], a[104:107], v[128:131], 0
    ds_read_b64_tr_b16 a[124:125], v18 offset:45056
    ds_read_b64_tr_b16 a[126:127], v18 offset:45568
    v_max_f32 v32, 0, v32
    v_max_f32 v33, 0, v33
    v_max_f32 v34, 0, v34
    v_max_f32 v35, 0, v35
    ds_read_b64_tr_b16 a[230:231], v9 offset:5120
    v_mfma_f32_32x32x16_bf16 v[112:127], a[108:111], v[128:131], 0
    s_waitcnt lgkmcnt(6)
    v_mfma_f32_32x32x16_bf16 v[64:79], a[112:115], v[132:135], v[64:79]
    ds_read_b64_tr_b16 a[96:97], v13 offset:12288
    ds_read_b64_tr_b16 a[98:99], v13 offset:12800
    ds_read_b64_tr_b16 a[100:101], v15 offset:12288
    v_mul_f32 v32, v32, v36
    v_mul_f32 v33, v33, v37
    v_mul_f32 v34, v34, v38
    v_mul_f32 v35, v35, v39
    s_waitcnt vmcnt(16)
    ds_read_b64_tr_b16 a[232:233], v8 offset:6144
    ds_read_b64_tr_b16 a[234:235], v8 offset:7168
    s_add_u32 m0, s68, 2048
    s_mov_b32 s59, 0x4000
    s_cmp_eq_u32 s101, 12
    s_cselect_b32 s59, 0xfff94000, s59
    v_add_u32 v3, s59, v3
    buffer_load_dwordx4 v3, s[24:27], s63 offen lds
    buffer_load_dwordx4 v3, s[24:27], s64 offen offset:1024 lds
    v_mfma_f32_32x32x16_bf16 v[80:95], a[116:119], v[132:135], v[80:95]
    ds_read_b64_tr_b16 a[102:103], v15 offset:12800
    ds_read_b64_tr_b16 a[104:105], v17 offset:12288
    ds_read_b64_tr_b16 a[106:107], v17 offset:12800
    v_cvt_pk_bf16_f32 v40, v32, v33
    v_cvt_pk_bf16_f32 v41, v34, v35
    v_accvgpr_read_b32 v32, a4
    v_accvgpr_read_b32 v33, a5
    ds_read_b64_tr_b16 a[236:237], v9 offset:6144
    s_waitcnt lgkmcnt(10)
    v_mfma_f32_32x32x16_bf16 v[96:111], a[120:123], v[132:135], v[96:111]
    ds_read_b64_tr_b16 a[108:109], v19 offset:12288
    ds_read_b64_tr_b16 a[110:111], v19 offset:12800
    v_accvgpr_read_b32 v34, a6
    v_accvgpr_read_b32 v35, a7
    v_accvgpr_read_b32 v36, a12
    v_accvgpr_read_b32 v37, a13
    ds_read_b64_tr_b16 a[238:239], v9 offset:7168
    v_mfma_f32_32x32x16_bf16 v[112:127], a[124:127], v[132:135], v[112:127]
    s_waitcnt lgkmcnt(6)
    v_mfma_f32_32x32x16_bf16 v[64:79], a[96:99], v[136:139], v[64:79]
    ds_read_b64_tr_b16 a[112:113], v13 offset:45056
    ds_read_b64_tr_b16 a[114:115], v13 offset:45568
    ds_read_b64_tr_b16 a[116:117], v15 offset:45056
    v_accvgpr_read_b32 v38, a14
    v_accvgpr_read_b32 v39, a15
    v_max_f32 v32, 0, v32
    v_max_f32 v33, 0, v33
    v_mfma_f32_32x32x16_bf16 v[80:95], a[100:103], v[136:139], v[80:95]
    ds_read_b64_tr_b16 a[118:119], v15 offset:45568
    ds_read_b64_tr_b16 a[120:121], v17 offset:45056
    v_max_f32 v34, 0, v34
    v_max_f32 v35, 0, v35
    v_mul_f32 v32, v32, v36
    v_mul_f32 v33, v33, v37
    s_waitcnt lgkmcnt(6)
    v_mfma_f32_32x32x16_bf16 v[96:111], a[104:107], v[136:139], v[96:111]
    s_waitcnt vmcnt(14)
    s_barrier
    ds_read_b64_tr_b16 a[122:123], v17 offset:45568
    ds_read_b64_tr_b16 a[124:125], v19 offset:45056
    ds_read_b64_tr_b16 a[126:127], v19 offset:45568
    v_mul_f32 v34, v34, v38
    v_mul_f32 v35, v35, v39
    v_cvt_pk_bf16_f32 v42, v32, v33
    v_cvt_pk_bf16_f32 v43, v34, v35
    s_add_u32 m0, s68, 4096
    v_add_u32 v3, 0x4000, v3
    buffer_load_dwordx4 v3, s[24:27], s63 offen lds
    buffer_load_dwordx4 v3, s[24:27], s64 offen offset:1024 lds
    v_mfma_f32_32x32x16_bf16 v[112:127], a[108:111], v[136:139], v[112:127]
    s_waitcnt lgkmcnt(4)
    v_mfma_f32_32x32x16_bf16 v[64:79], a[112:115], v[140:143], v[64:79]
    ds_read_b64_tr_b16 a[96:97], v12 offset:18432
    ds_read_b64_tr_b16 a[98:99], v12 offset:18944
    ds_read_b64_tr_b16 a[100:101], v14 offset:18432
    buffer_store_dwordx4 v[40:43], v2, s[20:23], s52 offen sc1
    v_accvgpr_read_b32 v44, a16
    v_accvgpr_read_b32 v45, a17
    s_add_u32 m0, s40, 6144
    s_cmp_eq_u32 s69, 4
    s_cselect_b32 s92, s91, s90
    buffer_load_dwordx4 v4, s[12:15], s50 offen lds
    buffer_load_dwordx4 v4, s[12:15], s51 offen offset:1024 lds
    v_add_u32 v4, s92, v4
    v_mfma_f32_32x32x16_bf16 v[80:95], a[116:119], v[140:143], v[80:95]
    ds_read_b64_tr_b16 a[102:103], v14 offset:18944
    ds_read_b64_tr_b16 a[104:105], v16 offset:18432
    ds_read_b64_tr_b16 a[106:107], v16 offset:18944
    v_accvgpr_read_b32 v46, a18
    v_accvgpr_read_b32 v47, a19
    v_accvgpr_read_b32 v48, a24
    v_accvgpr_read_b32 v49, a25
    s_waitcnt lgkmcnt(6)
    v_mfma_f32_32x32x16_bf16 v[96:111], a[120:123], v[140:143], v[96:111]
    ds_read_b64_tr_b16 a[108:109], v18 offset:18432
    ds_read_b64_tr_b16 a[110:111], v18 offset:18944
    v_accvgpr_read_b32 v50, a26
    v_accvgpr_read_b32 v51, a27
    v_max_f32 v44, 0, v44
    v_max_f32 v45, 0, v45
    v_mfma_f32_32x32x16_bf16 v[112:127], a[124:127], v[140:143], v[112:127]
    s_waitcnt lgkmcnt(4)
    v_mfma_f32_32x32x16_bf16 v[64:79], a[96:99], v[144:147], v[64:79]
    ds_read_b64_tr_b16 a[112:113], v12 offset:51200
    ds_read_b64_tr_b16 a[114:115], v12 offset:51712
    ds_read_b64_tr_b16 a[116:117], v14 offset:51200
    v_max_f32 v46, 0, v46
    v_max_f32 v47, 0, v47
    v_mul_f32 v44, v44, v48
    v_mul_f32 v45, v45, v49
    s_add_u32 m0, s40, 8192
    s_nop 0
    buffer_load_dwordx4 v5, s[16:19], s50 offen lds
    buffer_load_dwordx4 v5, s[16:19], s51 offen offset:1024 lds
    v_add_u32 v5, s92, v5
    v_mfma_f32_32x32x16_bf16 v[80:95], a[100:103], v[144:147], v[80:95]
    ds_read_b64_tr_b16 a[118:119], v14 offset:51712
    ds_read_b64_tr_b16 a[120:121], v16 offset:51200
    ds_read_b64_tr_b16 a[122:123], v16 offset:51712
    v_mul_f32 v46, v46, v50
    v_mul_f32 v47, v47, v51
    v_cvt_pk_bf16_f32 v52, v44, v45
    v_cvt_pk_bf16_f32 v53, v46, v47
    s_waitcnt lgkmcnt(6)
    v_mfma_f32_32x32x16_bf16 v[96:111], a[104:107], v[144:147], v[96:111]
    ds_read_b64_tr_b16 a[124:125], v18 offset:51200
    ds_read_b64_tr_b16 a[126:127], v18 offset:51712
    v_accvgpr_read_b32 v44, a20
    v_accvgpr_read_b32 v45, a21
    v_accvgpr_read_b32 v46, a22
    v_accvgpr_read_b32 v47, a23
    v_mfma_f32_32x32x16_bf16 v[112:127], a[108:111], v[144:147], v[112:127]
    s_waitcnt lgkmcnt(4)
    v_mfma_f32_32x32x16_bf16 v[64:79], a[112:115], v[148:151], v[64:79]
    ds_read_b64_tr_b16 a[96:97], v13 offset:18432
    ds_read_b64_tr_b16 a[98:99], v13 offset:18944
    ds_read_b64_tr_b16 a[100:101], v15 offset:18432
    v_accvgpr_read_b32 v48, a28
    v_accvgpr_read_b32 v49, a29
    v_accvgpr_read_b32 v50, a30
    v_accvgpr_read_b32 v51, a31
    s_add_u32 m0, s68, 6144
    v_add_u32 v3, 0x4000, v3
    buffer_load_dwordx4 v3, s[24:27], s63 offen lds
    buffer_load_dwordx4 v3, s[24:27], s64 offen offset:1024 lds
    v_mfma_f32_32x32x16_bf16 v[80:95], a[116:119], v[148:151], v[80:95]
    ds_read_b64_tr_b16 a[102:103], v15 offset:18944
    ds_read_b64_tr_b16 a[104:105], v17 offset:18432
    ds_read_b64_tr_b16 a[106:107], v17 offset:18944
    v_max_f32 v44, 0, v44
    v_max_f32 v45, 0, v45
    v_max_f32 v46, 0, v46
    v_max_f32 v47, 0, v47
    s_waitcnt lgkmcnt(6)
    v_mfma_f32_32x32x16_bf16 v[96:111], a[120:123], v[148:151], v[96:111]
    ds_read_b64_tr_b16 a[108:109], v19 offset:18432
    ds_read_b64_tr_b16 a[110:111], v19 offset:18944
    v_mul_f32 v44, v44, v48
    v_mul_f32 v45, v45, v49
    v_mul_f32 v46, v46, v50
    v_mul_f32 v47, v47, v51
    v_mfma_f32_32x32x16_bf16 v[112:127], a[124:127], v[148:151], v[112:127]
    s_waitcnt lgkmcnt(4)
    v_mfma_f32_32x32x16_bf16 v[64:79], a[96:99], v[152:155], v[64:79]
    ds_read_b64_tr_b16 a[112:113], v13 offset:51200
    ds_read_b64_tr_b16 a[114:115], v13 offset:51712
    ds_read_b64_tr_b16 a[116:117], v15 offset:51200
    v_cvt_pk_bf16_f32 v54, v44, v45
    v_cvt_pk_bf16_f32 v55, v46, v47
    buffer_store_dwordx4 v[52:55], v2, s[20:23], s52 offen offset:1024 sc1
    v_mfma_f32_32x32x16_bf16 v[80:95], a[100:103], v[152:155], v[80:95]
    ds_read_b64_tr_b16 a[118:119], v15 offset:51712
    ds_read_b64_tr_b16 a[120:121], v17 offset:51200
    v_accvgpr_read_b32 v32, a32
    v_accvgpr_read_b32 v33, a33
    v_accvgpr_read_b32 v34, a34
    v_accvgpr_read_b32 v35, a35
    s_waitcnt lgkmcnt(5)
    v_mfma_f32_32x32x16_bf16 v[96:111], a[104:107], v[152:155], v[96:111]
    s_waitcnt vmcnt(18)
    s_barrier
    ds_read_b64_tr_b16 a[122:123], v17 offset:51712
    ds_read_b64_tr_b16 a[124:125], v19 offset:51200
    ds_read_b64_tr_b16 a[126:127], v19 offset:51712
    v_accvgpr_read_b32 v36, a40
    v_accvgpr_read_b32 v37, a41
    v_accvgpr_read_b32 v38, a42
    v_accvgpr_read_b32 v39, a43
    v_mfma_f32_32x32x16_bf16 v[112:127], a[108:111], v[152:155], v[112:127]
    s_waitcnt lgkmcnt(4)
    v_mfma_f32_32x32x16_bf16 v[64:79], a[112:115], v[156:159], v[64:79]
    ds_read_b64_tr_b16 a[96:97], v12 offset:24576
    ds_read_b64_tr_b16 a[98:99], v12 offset:25088
    ds_read_b64_tr_b16 a[100:101], v14 offset:24576
    v_max_f32 v32, 0, v32
    v_max_f32 v33, 0, v33
    v_max_f32 v34, 0, v34
    v_max_f32 v35, 0, v35
    s_add_u32 m0, s40, 12288
    s_cmp_eq_u32 s69, 5
    s_cselect_b32 s92, s91, s90
    buffer_load_dwordx4 v4, s[12:15], s50 offen lds
    buffer_load_dwordx4 v4, s[12:15], s51 offen offset:1024 lds
    v_add_u32 v4, s92, v4
    v_mfma_f32_32x32x16_bf16 v[80:95], a[116:119], v[156:159], v[80:95]
    ds_read_b64_tr_b16 a[102:103], v14 offset:25088
    ds_read_b64_tr_b16 a[104:105], v16 offset:24576
    ds_read_b64_tr_b16 a[106:107], v16 offset:25088
    v_mul_f32 v32, v32, v36
    v_mul_f32 v33, v33, v37
    v_mul_f32 v34, v34, v38
    v_mul_f32 v35, v35, v39
    s_waitcnt lgkmcnt(6)
    v_mfma_f32_32x32x16_bf16 v[96:111], a[120:123], v[156:159], v[96:111]
    ds_read_b64_tr_b16 a[108:109], v18 offset:24576
    ds_read_b64_tr_b16 a[110:111], v18 offset:25088
    v_cvt_pk_bf16_f32 v40, v32, v33
    v_cvt_pk_bf16_f32 v41, v34, v35
    v_accvgpr_read_b32 v32, a36
    v_accvgpr_read_b32 v33, a37
    v_mfma_f32_32x32x16_bf16 v[112:127], a[124:127], v[156:159], v[112:127]
    s_waitcnt lgkmcnt(4)
    v_mfma_f32_32x32x16_bf16 v[64:79], a[96:99], v[160:163], v[64:79]
    ds_read_b64_tr_b16 a[112:113], v12 offset:57344
    ds_read_b64_tr_b16 a[114:115], v12 offset:57856
    ds_read_b64_tr_b16 a[116:117], v14 offset:57344
    v_accvgpr_read_b32 v34, a38
    v_accvgpr_read_b32 v35, a39
    v_accvgpr_read_b32 v36, a44
    v_accvgpr_read_b32 v37, a45
    s_add_u32 m0, s40, 14336
    s_nop 0
    buffer_load_dwordx4 v5, s[16:19], s50 offen lds
    buffer_load_dwordx4 v5, s[16:19], s51 offen offset:1024 lds
    v_add_u32 v5, s92, v5
    v_mfma_f32_32x32x16_bf16 v[80:95], a[100:103], v[160:163], v[80:95]
    ds_read_b64_tr_b16 a[118:119], v14 offset:57856
    ds_read_b64_tr_b16 a[120:121], v16 offset:57344
    ds_read_b64_tr_b16 a[122:123], v16 offset:57856
    v_accvgpr_read_b32 v38, a46
    v_accvgpr_read_b32 v39, a47
    v_max_f32 v32, 0, v32
    v_max_f32 v33, 0, v33
    s_waitcnt lgkmcnt(6)
    v_mfma_f32_32x32x16_bf16 v[96:111], a[104:107], v[160:163], v[96:111]
    ds_read_b64_tr_b16 a[124:125], v18 offset:57344
    ds_read_b64_tr_b16 a[126:127], v18 offset:57856
    v_max_f32 v34, 0, v34
    v_max_f32 v35, 0, v35
    v_mul_f32 v32, v32, v36
    v_mul_f32 v33, v33, v37
    v_mfma_f32_32x32x16_bf16 v[112:127], a[108:111], v[160:163], v[112:127]
    s_waitcnt lgkmcnt(4)
    v_mfma_f32_32x32x16_bf16 v[64:79], a[112:115], v[164:167], v[64:79]
    ds_read_b64_tr_b16 a[96:97], v13 offset:24576
    ds_read_b64_tr_b16 a[98:99], v13 offset:25088
    ds_read_b64_tr_b16 a[100:101], v15 offset:24576
    v_mul_f32 v34, v34, v38
    v_mul_f32 v35, v35, v39
    v_cvt_pk_bf16_f32 v42, v32, v33
    v_cvt_pk_bf16_f32 v43, v34, v35
    ds_read_b64_tr_b16 a[240:241], v10 offset:30720
    ds_read_b64_tr_b16 a[242:243], v10 offset:31744
    v_mfma_f32_32x32x16_bf16 v[80:95], a[116:119], v[164:167], v[80:95]
    ds_read_b64_tr_b16 a[102:103], v15 offset:25088
    ds_read_b64_tr_b16 a[104:105], v17 offset:24576
    ds_read_b64_tr_b16 a[106:107], v17 offset:25088
    buffer_store_dwordx4 v[40:43], v2, s[20:23], s52 offen offset:2048 sc1
    v_accvgpr_read_b32 v44, a48
    v_accvgpr_read_b32 v45, a49
    ds_read_b64_tr_b16 a[244:245], v11 offset:30720
    s_waitcnt lgkmcnt(9)
    v_mfma_f32_32x32x16_bf16 v[96:111], a[120:123], v[164:167], v[96:111]
    ds_read_b64_tr_b16 a[108:109], v19 offset:24576
    ds_read_b64_tr_b16 a[110:111], v19 offset:25088
    v_accvgpr_read_b32 v46, a50
    v_accvgpr_read_b32 v47, a51
    v_accvgpr_read_b32 v48, a56
    v_accvgpr_read_b32 v49, a57
    ds_read_b64_tr_b16 a[246:247], v11 offset:31744
    v_mfma_f32_32x32x16_bf16 v[112:127], a[124:127], v[164:167], v[112:127]
    s_waitcnt lgkmcnt(6)
    v_mfma_f32_32x32x16_bf16 v[64:79], a[96:99], v[168:171], v[64:79]
    ds_read_b64_tr_b16 a[112:113], v13 offset:57344
    ds_read_b64_tr_b16 a[114:115], v13 offset:57856
    ds_read_b64_tr_b16 a[116:117], v15 offset:57344
    v_accvgpr_read_b32 v50, a58
    v_accvgpr_read_b32 v51, a59
    v_max_f32 v44, 0, v44
    v_max_f32 v45, 0, v45
    v_mfma_f32_32x32x16_bf16 v[80:95], a[100:103], v[168:171], v[80:95]
    ds_read_b64_tr_b16 a[118:119], v15 offset:57856
    ds_read_b64_tr_b16 a[120:121], v17 offset:57344
    v_max_f32 v46, 0, v46
    v_max_f32 v47, 0, v47
    v_mul_f32 v44, v44, v48
    v_mul_f32 v45, v45, v49
    s_waitcnt lgkmcnt(6)
    v_mfma_f32_32x32x16_bf16 v[96:111], a[104:107], v[168:171], v[96:111]
    s_waitcnt vmcnt(17)
    s_barrier
    ds_read_b64_tr_b16 a[122:123], v17 offset:57856
    ds_read_b64_tr_b16 a[124:125], v19 offset:57344
    ds_read_b64_tr_b16 a[126:127], v19 offset:57856
    v_mul_f32 v46, v46, v50
    v_mul_f32 v47, v47, v51
    v_cvt_pk_bf16_f32 v52, v44, v45
    v_cvt_pk_bf16_f32 v53, v46, v47
    s_waitcnt lgkmcnt(8)
    s_add_u32 m0, s40, 30720
    v_add_u32 v3, 0x4000, v3
    buffer_load_dwordx4 v3, s[24:27], s63 offen lds
    buffer_load_dwordx4 v3, s[24:27], s64 offen offset:1024 lds
    v_mfma_f32_32x32x16_bf16 v[112:127], a[108:111], v[168:171], v[112:127]
    s_waitcnt lgkmcnt(4)
    v_mfma_f32_32x32x16_bf16 v[64:79], a[112:115], v[172:175], v[64:79]
    ds_read_b64_tr_b16 a[96:97], v12 offset:0
    ds_read_b64_tr_b16 a[98:99], v12 offset:512
    ds_read_b64_tr_b16 a[100:101], v14 offset:0
    v_accvgpr_read_b32 v44, a52
    v_accvgpr_read_b32 v45, a53
    v_accvgpr_read_b32 v46, a54
    v_accvgpr_read_b32 v47, a55
    s_add_u32 m0, s40, 18432
    s_cmp_eq_u32 s69, 6
    s_cselect_b32 s92, s91, s90
    buffer_load_dwordx4 v4, s[12:15], s50 offen lds
    buffer_load_dwordx4 v4, s[12:15], s51 offen offset:1024 lds
    v_add_u32 v4, s92, v4
    v_mfma_f32_32x32x16_bf16 v[80:95], a[116:119], v[172:175], v[80:95]
    ds_read_b64_tr_b16 a[102:103], v14 offset:512
    ds_read_b64_tr_b16 a[104:105], v16 offset:0
    ds_read_b64_tr_b16 a[106:107], v16 offset:512
    v_accvgpr_read_b32 v48, a60
    v_accvgpr_read_b32 v49, a61
    v_accvgpr_read_b32 v50, a62
    v_accvgpr_read_b32 v51, a63
    s_waitcnt lgkmcnt(6)
    v_mfma_f32_32x32x16_bf16 v[96:111], a[120:123], v[172:175], v[96:111]
    ds_read_b64_tr_b16 a[108:109], v18 offset:0
    ds_read_b64_tr_b16 a[110:111], v18 offset:512
    v_max_f32 v44, 0, v44
    v_max_f32 v45, 0, v45
    v_max_f32 v46, 0, v46
    v_max_f32 v47, 0, v47
    v_mfma_f32_32x32x16_bf16 v[112:127], a[124:127], v[172:175], v[112:127]
    s_waitcnt lgkmcnt(4)
    v_mfma_f32_32x32x16_bf16 v[64:79], a[96:99], v[176:179], v[64:79]
    ds_read_b64_tr_b16 a[112:113], v12 offset:32768
    ds_read_b64_tr_b16 a[114:115], v12 offset:33280
    ds_read_b64_tr_b16 a[116:117], v14 offset:32768
    v_mul_f32 v44, v44, v48
    v_mul_f32 v45, v45, v49
    v_mul_f32 v46, v46, v50
    v_mul_f32 v47, v47, v51
    s_add_u32 m0, s40, 20480
    s_nop 0
    buffer_load_dwordx4 v5, s[16:19], s50 offen lds
    buffer_load_dwordx4 v5, s[16:19], s51 offen offset:1024 lds
    v_add_u32 v5, s92, v5
    v_mfma_f32_32x32x16_bf16 v[80:95], a[100:103], v[176:179], v[80:95]
    ds_read_b64_tr_b16 a[118:119], v14 offset:33280
    ds_read_b64_tr_b16 a[120:121], v16 offset:32768
    ds_read_b64_tr_b16 a[122:123], v16 offset:33280
    v_cvt_pk_bf16_f32 v54, v44, v45
    v_cvt_pk_bf16_f32 v55, v46, v47
    buffer_store_dwordx4 v[52:55], v2, s[20:23], s52 offen offset:3072 sc1
    s_waitcnt lgkmcnt(6)
    v_mfma_f32_32x32x16_bf16 v[96:111], a[104:107], v[176:179], v[96:111]
    ds_read_b64_tr_b16 a[124:125], v18 offset:32768
    ds_read_b64_tr_b16 a[126:127], v18 offset:33280
    v_accvgpr_read_b32 v32, a64
    v_accvgpr_read_b32 v33, a65
    v_accvgpr_read_b32 v34, a66
    v_accvgpr_read_b32 v35, a67
    v_mfma_f32_32x32x16_bf16 v[112:127], a[108:111], v[176:179], v[112:127]
    s_waitcnt lgkmcnt(4)
    v_mfma_f32_32x32x16_bf16 v[64:79], a[112:115], v[180:183], v[64:79]
    ds_read_b64_tr_b16 a[96:97], v13 offset:0
    ds_read_b64_tr_b16 a[98:99], v13 offset:512
    ds_read_b64_tr_b16 a[100:101], v15 offset:0
    v_accvgpr_read_b32 v36, a72
    v_accvgpr_read_b32 v37, a73
    v_accvgpr_read_b32 v38, a74
    v_accvgpr_read_b32 v39, a75
    v_mfma_f32_32x32x16_bf16 v[80:95], a[116:119], v[180:183], v[80:95]
    ds_read_b64_tr_b16 a[102:103], v15 offset:512
    ds_read_b64_tr_b16 a[104:105], v17 offset:0
    ds_read_b64_tr_b16 a[106:107], v17 offset:512
    v_max_f32 v32, 0, v32
    v_max_f32 v33, 0, v33
    v_max_f32 v34, 0, v34
    v_max_f32 v35, 0, v35
    s_waitcnt lgkmcnt(6)
    v_mfma_f32_32x32x16_bf16 v[96:111], a[120:123], v[180:183], v[96:111]
    ds_read_b64_tr_b16 a[108:109], v19 offset:0
    ds_read_b64_tr_b16 a[110:111], v19 offset:512
    v_mul_f32 v32, v32, v36
    v_mul_f32 v33, v33, v37
    v_mul_f32 v34, v34, v38
    v_mul_f32 v35, v35, v39
    v_mfma_f32_32x32x16_bf16 v[112:127], a[124:127], v[180:183], v[112:127]
    s_waitcnt lgkmcnt(4)
    v_mfma_f32_32x32x16_bf16 v[64:79], a[96:99], v[184:187], v[64:79]
    ds_read_b64_tr_b16 a[112:113], v13 offset:32768
    ds_read_b64_tr_b16 a[114:115], v13 offset:33280
    ds_read_b64_tr_b16 a[116:117], v15 offset:32768
    v_cvt_pk_bf16_f32 v40, v32, v33
    v_cvt_pk_bf16_f32 v41, v34, v35
    v_accvgpr_read_b32 v32, a68
    v_accvgpr_read_b32 v33, a69
    v_mfma_f32_32x32x16_bf16 v[80:95], a[100:103], v[184:187], v[80:95]
    ds_read_b64_tr_b16 a[118:119], v15 offset:33280
    ds_read_b64_tr_b16 a[120:121], v17 offset:32768
    v_accvgpr_read_b32 v34, a70
    v_accvgpr_read_b32 v35, a71
    v_accvgpr_read_b32 v36, a76
    v_accvgpr_read_b32 v37, a77
    s_waitcnt lgkmcnt(5)
    v_mfma_f32_32x32x16_bf16 v[96:111], a[104:107], v[184:187], v[96:111]
    s_waitcnt vmcnt(15)
    s_barrier
    ds_read_b64_tr_b16 a[122:123], v17 offset:33280
    ds_read_b64_tr_b16 a[124:125], v19 offset:32768
    ds_read_b64_tr_b16 a[126:127], v19 offset:33280
    v_accvgpr_read_b32 v38, a78
    v_accvgpr_read_b32 v39, a79
    v_max_f32 v32, 0, v32
    v_max_f32 v33, 0, v33
    v_mfma_f32_32x32x16_bf16 v[112:127], a[108:111], v[184:187], v[112:127]
    s_waitcnt lgkmcnt(4)
    v_mfma_f32_32x32x16_bf16 v[64:79], a[112:115], v[188:191], v[64:79]
    ds_read_b64_tr_b16 a[96:97], v12 offset:6144
    ds_read_b64_tr_b16 a[98:99], v12 offset:6656
    ds_read_b64_tr_b16 a[100:101], v14 offset:6144
    v_max_f32 v34, 0, v34
    v_max_f32 v35, 0, v35
    v_mul_f32 v32, v32, v36
    v_mul_f32 v33, v33, v37
    ds_read_b64_tr_b16 a[248:249], v8 offset:0
    ds_read_b64_tr_b16 a[250:251], v8 offset:1024
    s_add_u32 m0, s40, 24576
    s_cmp_eq_u32 s69, 7
    s_cselect_b32 s92, s91, s90
    buffer_load_dwordx4 v4, s[12:15], s50 offen lds
    buffer_load_dwordx4 v4, s[12:15], s51 offen offset:1024 lds
    v_mfma_f32_32x32x16_bf16 v[80:95], a[116:119], v[188:191], v[80:95]
    ds_read_b64_tr_b16 a[102:103], v14 offset:6656
    ds_read_b64_tr_b16 a[104:105], v16 offset:6144
    ds_read_b64_tr_b16 a[106:107], v16 offset:6656
    v_mul_f32 v34, v34, v38
    v_mul_f32 v35, v35, v39
    v_cvt_pk_bf16_f32 v42, v32, v33
    v_cvt_pk_bf16_f32 v43, v34, v35
    ds_read_b64_tr_b16 a[252:253], v9 offset:0
    s_waitcnt lgkmcnt(9)
    v_mfma_f32_32x32x16_bf16 v[96:111], a[120:123], v[188:191], v[96:111]
    ds_read_b64_tr_b16 a[108:109], v18 offset:6144
    ds_read_b64_tr_b16 a[110:111], v18 offset:6656
    buffer_store_dwordx4 v[40:43], v2, s[20:23], s53 offen sc1
    v_accvgpr_read_b32 v44, a80
    v_accvgpr_read_b32 v45, a81
    ds_read_b64_tr_b16 a[254:255], v9 offset:1024
    v_mfma_f32_32x32x16_bf16 v[112:127], a[124:127], v[188:191], v[112:127]
    s_waitcnt lgkmcnt(6)
    v_mfma_f32_32x32x16_bf16 v[64:79], a[96:99], v[192:195], v[64:79]
    ds_read_b64_tr_b16 a[112:113], v12 offset:38912
    ds_read_b64_tr_b16 a[114:115], v12 offset:39424
    ds_read_b64_tr_b16 a[116:117], v14 offset:38912
    v_accvgpr_read_b32 v46, a82
    v_accvgpr_read_b32 v47, a83
    v_accvgpr_read_b32 v48, a88
    v_accvgpr_read_b32 v49, a89
    s_add_u32 m0, s40, 26624
    s_nop 0
    buffer_load_dwordx4 v5, s[16:19], s50 offen lds
    buffer_load_dwordx4 v5, s[16:19], s51 offen offset:1024 lds
    v_mfma_f32_32x32x16_bf16 v[80:95], a[100:103], v[192:195], v[80:95]
    ds_read_b64_tr_b16 a[118:119], v14 offset:39424
    ds_read_b64_tr_b16 a[120:121], v16 offset:38912
    ds_read_b64_tr_b16 a[122:123], v16 offset:39424
    v_accvgpr_read_b32 v50, a90
    v_accvgpr_read_b32 v51, a91
    v_max_f32 v44, 0, v44
    v_max_f32 v45, 0, v45
    s_waitcnt lgkmcnt(6)
    s_add_u32 m0, s68, 0
    s_mov_b32 s59, 0x4000
    s_cmp_eq_u32 s101, 16
    s_cselect_b32 s59, 0xfff94000, s59
    v_add_u32 v3, s59, v3
    buffer_load_dwordx4 v3, s[24:27], s63 offen lds
    buffer_load_dwordx4 v3, s[24:27], s64 offen offset:1024 lds
    v_mfma_f32_32x32x16_bf16 v[96:111], a[104:107], v[192:195], v[96:111]
    ds_read_b64_tr_b16 a[124:125], v18 offset:38912
    ds_read_b64_tr_b16 a[126:127], v18 offset:39424
    v_max_f32 v46, 0, v46
    v_max_f32 v47, 0, v47
    v_mul_f32 v44, v44, v48
    v_mul_f32 v45, v45, v49
    v_mfma_f32_32x32x16_bf16 v[112:127], a[108:111], v[192:195], v[112:127]
    s_waitcnt lgkmcnt(4)
    v_mfma_f32_32x32x16_bf16 v[64:79], a[112:115], v[196:199], v[64:79]
    ds_read_b64_tr_b16 a[96:97], v13 offset:6144
    ds_read_b64_tr_b16 a[98:99], v13 offset:6656
    ds_read_b64_tr_b16 a[100:101], v15 offset:6144
    v_mul_f32 v46, v46, v50
    v_mul_f32 v47, v47, v51
    v_cvt_pk_bf16_f32 v52, v44, v45
    v_cvt_pk_bf16_f32 v53, v46, v47
    v_mfma_f32_32x32x16_bf16 v[80:95], a[116:119], v[196:199], v[80:95]
    ds_read_b64_tr_b16 a[102:103], v15 offset:6656
    ds_read_b64_tr_b16 a[104:105], v17 offset:6144
    ds_read_b64_tr_b16 a[106:107], v17 offset:6656
    v_accvgpr_read_b32 v44, a84
    v_accvgpr_read_b32 v45, a85
    v_accvgpr_read_b32 v46, a86
    v_accvgpr_read_b32 v47, a87
    s_waitcnt lgkmcnt(6)
    v_mfma_f32_32x32x16_bf16 v[96:111], a[120:123], v[196:199], v[96:111]
    ds_read_b64_tr_b16 a[108:109], v19 offset:6144
    ds_read_b64_tr_b16 a[110:111], v19 offset:6656
    v_accvgpr_read_b32 v48, a92
    v_accvgpr_read_b32 v49, a93
    v_accvgpr_read_b32 v50, a94
    v_accvgpr_read_b32 v51, a95
    v_mfma_f32_32x32x16_bf16 v[112:127], a[124:127], v[196:199], v[112:127]
    s_waitcnt lgkmcnt(4)
    v_mfma_f32_32x32x16_bf16 v[64:79], a[96:99], v[200:203], v[64:79]
    ds_read_b64_tr_b16 a[112:113], v13 offset:38912
    ds_read_b64_tr_b16 a[114:115], v13 offset:39424
    ds_read_b64_tr_b16 a[116:117], v15 offset:38912
    v_max_f32 v44, 0, v44
    v_max_f32 v45, 0, v45
    v_max_f32 v46, 0, v46
    v_max_f32 v47, 0, v47
    ds_read_b64_tr_b16 a[144:145], v8 offset:2048
    v_mfma_f32_32x32x16_bf16 v[80:95], a[100:103], v[200:203], v[80:95]
    ds_read_b64_tr_b16 a[118:119], v15 offset:39424
    ds_read_b64_tr_b16 a[120:121], v17 offset:38912
    v_mul_f32 v44, v44, v48
    v_mul_f32 v45, v45, v49
    v_mul_f32 v46, v46, v50
    v_mul_f32 v47, v47, v51
    ds_read_b64_tr_b16 a[146:147], v8 offset:3072
    s_waitcnt lgkmcnt(7)
    v_mfma_f32_32x32x16_bf16 v[96:111], a[104:107], v[200:203], v[96:111]
    s_waitcnt vmcnt(15)
    s_barrier
    ds_read_b64_tr_b16 a[122:123], v17 offset:39424
    ds_read_b64_tr_b16 a[124:125], v19 offset:38912
    ds_read_b64_tr_b16 a[126:127], v19 offset:39424
    v_cvt_pk_bf16_f32 v54, v44, v45
    v_cvt_pk_bf16_f32 v55, v46, v47
    buffer_store_dwordx4 v[52:55], v2, s[20:23], s53 offen offset:1024 sc1
    ds_read_b64_tr_b16 a[148:149], v9 offset:2048
    ds_read_b64_tr_b16 a[150:151], v9 offset:3072
    v_mfma_f32_32x32x16_bf16 v[112:127], a[108:111], v[200:203], v[112:127]
    s_waitcnt lgkmcnt(7)
    v_mfma_f32_32x32x16_bf16 v[64:79], a[112:115], v[204:207], v[64:79]
    ds_read_b64_tr_b16 a[96:97], v12 offset:12288
    ds_read_b64_tr_b16 a[98:99], v12 offset:12800
    ds_read_b64_tr_b16 a[100:101], v14 offset:12288
    ds_read_b64_tr_b16 a[152:153], v8 offset:4096
    ds_read_b64_tr_b16 a[154:155], v8 offset:5120
    s_waitcnt lgkmcnt(5)
    s_add_u32 m0, s68, 2048
    v_add_u32 v3, 0x4000, v3
    buffer_load_dwordx4 v3, s[24:27], s63 offen lds
    buffer_load_dwordx4 v3, s[24:27], s64 offen offset:1024 lds
    v_mfma_f32_32x32x16_bf16 v[80:95], a[116:119], v[204:207], v[80:95]
    ds_read_b64_tr_b16 a[102:103], v14 offset:12800
    ds_read_b64_tr_b16 a[104:105], v16 offset:12288
    ds_read_b64_tr_b16 a[106:107], v16 offset:12800
    ds_read_b64_tr_b16 a[156:157], v9 offset:4096
    v_mfma_f32_32x32x16_bf16 v[96:111], a[120:123], v[204:207], v[96:111]
    ds_read_b64_tr_b16 a[108:109], v18 offset:12288
    ds_read_b64_tr_b16 a[110:111], v18 offset:12800
    ds_read_b64_tr_b16 a[158:159], v9 offset:5120
    v_mfma_f32_32x32x16_bf16 v[112:127], a[124:127], v[204:207], v[112:127]
    s_waitcnt lgkmcnt(6)
    v_mfma_f32_32x32x16_bf16 v[64:79], a[96:99], v[208:211], v[64:79]
    ds_read_b64_tr_b16 a[112:113], v12 offset:45056
    ds_read_b64_tr_b16 a[114:115], v12 offset:45568
    ds_read_b64_tr_b16 a[116:117], v14 offset:45056
    s_waitcnt lgkmcnt(3)
    s_add_u32 m0, s68, 4096
    v_add_u32 v3, 0x4000, v3
    buffer_load_dwordx4 v3, s[24:27], s63 offen lds
    buffer_load_dwordx4 v3, s[24:27], s64 offen offset:1024 lds
    v_mfma_f32_32x32x16_bf16 v[80:95], a[100:103], v[208:211], v[80:95]
    ds_read_b64_tr_b16 a[118:119], v14 offset:45568
    ds_read_b64_tr_b16 a[120:121], v16 offset:45056
    ds_read_b64_tr_b16 a[122:123], v16 offset:45568
    v_mfma_f32_32x32x16_bf16 v[96:111], a[104:107], v[208:211], v[96:111]
    ds_read_b64_tr_b16 a[124:125], v18 offset:45056
    ds_read_b64_tr_b16 a[126:127], v18 offset:45568
    v_mfma_f32_32x32x16_bf16 v[112:127], a[108:111], v[208:211], v[112:127]
    s_waitcnt lgkmcnt(4)
    v_mfma_f32_32x32x16_bf16 v[64:79], a[112:115], v[212:215], v[64:79]
    ds_read_b64_tr_b16 a[96:97], v13 offset:12288
    ds_read_b64_tr_b16 a[98:99], v13 offset:12800
    ds_read_b64_tr_b16 a[100:101], v15 offset:12288
    s_add_u32 m0, s40, 0
    v_add_u32 v3, 0x4000, v3
    buffer_load_dwordx4 v3, s[24:27], s63 offen lds
    buffer_load_dwordx4 v3, s[24:27], s64 offen offset:1024 lds
    v_mfma_f32_32x32x16_bf16 v[80:95], a[116:119], v[212:215], v[80:95]
    ds_read_b64_tr_b16 a[102:103], v15 offset:12800
    ds_read_b64_tr_b16 a[104:105], v17 offset:12288
    ds_read_b64_tr_b16 a[106:107], v17 offset:12800
    s_waitcnt lgkmcnt(6)
    v_mfma_f32_32x32x16_bf16 v[96:111], a[120:123], v[212:215], v[96:111]
    ds_read_b64_tr_b16 a[108:109], v19 offset:12288
    ds_read_b64_tr_b16 a[110:111], v19 offset:12800
    v_mfma_f32_32x32x16_bf16 v[112:127], a[124:127], v[212:215], v[112:127]
    s_waitcnt lgkmcnt(4)
    v_mfma_f32_32x32x16_bf16 v[64:79], a[96:99], v[216:219], v[64:79]
    ds_read_b64_tr_b16 a[112:113], v13 offset:45056
    ds_read_b64_tr_b16 a[114:115], v13 offset:45568
    ds_read_b64_tr_b16 a[116:117], v15 offset:45056
    ds_read_b64_tr_b16 a[128:129], v8 offset:6144
    v_mfma_f32_32x32x16_bf16 v[80:95], a[100:103], v[216:219], v[80:95]
    ds_read_b64_tr_b16 a[118:119], v15 offset:45568
    ds_read_b64_tr_b16 a[120:121], v17 offset:45056
    ds_read_b64_tr_b16 a[130:131], v8 offset:7168
    s_waitcnt lgkmcnt(7)
    v_mfma_f32_32x32x16_bf16 v[96:111], a[104:107], v[216:219], v[96:111]
    s_waitcnt vmcnt(15)
    s_barrier
    ds_read_b64_tr_b16 a[122:123], v17 offset:45568
    ds_read_b64_tr_b16 a[124:125], v19 offset:45056
    ds_read_b64_tr_b16 a[126:127], v19 offset:45568
    ds_read_b64_tr_b16 a[132:133], v9 offset:6144
    ds_read_b64_tr_b16 a[134:135], v9 offset:7168
    s_add_u32 m0, s40, 2048
    s_mov_b32 s59, 0x4000
    s_cmp_eq_u32 s101, 20
    s_cselect_b32 s59, 0xfff94000, s59
    v_add_u32 v3, s59, v3
    buffer_load_dwordx4 v3, s[24:27], s63 offen lds
    buffer_load_dwordx4 v3, s[24:27], s64 offen offset:1024 lds
    v_mfma_f32_32x32x16_bf16 v[112:127], a[108:111], v[216:219], v[112:127]
    s_waitcnt lgkmcnt(7)
    v_mfma_f32_32x32x16_bf16 v[64:79], a[112:115], v[220:223], v[64:79]
    ds_read_b64_tr_b16 a[96:97], v12 offset:18432
    ds_read_b64_tr_b16 a[98:99], v12 offset:18944
    ds_read_b64_tr_b16 a[100:101], v14 offset:18432
    s_waitcnt lgkmcnt(3)
    s_add_u32 m0, s68, 6144
    v_add_u32 v3, 0x4000, v3
    buffer_load_dwordx4 v3, s[24:27], s63 offen lds
    buffer_load_dwordx4 v3, s[24:27], s64 offen offset:1024 lds
    v_mfma_f32_32x32x16_bf16 v[80:95], a[116:119], v[220:223], v[80:95]
    ds_read_b64_tr_b16 a[102:103], v14 offset:18944
    ds_read_b64_tr_b16 a[104:105], v16 offset:18432
    ds_read_b64_tr_b16 a[106:107], v16 offset:18944
    v_mfma_f32_32x32x16_bf16 v[96:111], a[120:123], v[220:223], v[96:111]
    ds_read_b64_tr_b16 a[108:109], v18 offset:18432
    ds_read_b64_tr_b16 a[110:111], v18 offset:18944
    v_mfma_f32_32x32x16_bf16 v[112:127], a[124:127], v[220:223], v[112:127]
    s_waitcnt lgkmcnt(4)
    v_mfma_f32_32x32x16_bf16 v[64:79], a[96:99], v[224:227], v[64:79]
    ds_read_b64_tr_b16 a[112:113], v12 offset:51200
    ds_read_b64_tr_b16 a[114:115], v12 offset:51712
    ds_read_b64_tr_b16 a[116:117], v14 offset:51200
    s_add_u32 m0, s40, 4096
    v_add_u32 v3, 0x4000, v3
    buffer_load_dwordx4 v3, s[24:27], s63 offen lds
    buffer_load_dwordx4 v3, s[24:27], s64 offen offset:1024 lds
    v_mfma_f32_32x32x16_bf16 v[80:95], a[100:103], v[224:227], v[80:95]
    ds_read_b64_tr_b16 a[118:119], v14 offset:51712
    ds_read_b64_tr_b16 a[120:121], v16 offset:51200
    ds_read_b64_tr_b16 a[122:123], v16 offset:51712
    s_waitcnt lgkmcnt(6)
    v_mfma_f32_32x32x16_bf16 v[96:111], a[104:107], v[224:227], v[96:111]
    ds_read_b64_tr_b16 a[124:125], v18 offset:51200
    ds_read_b64_tr_b16 a[126:127], v18 offset:51712
    v_mfma_f32_32x32x16_bf16 v[112:127], a[108:111], v[224:227], v[112:127]
    s_waitcnt lgkmcnt(4)
    v_mfma_f32_32x32x16_bf16 v[64:79], a[112:115], v[228:231], v[64:79]
    ds_read_b64_tr_b16 a[96:97], v13 offset:18432
    ds_read_b64_tr_b16 a[98:99], v13 offset:18944
    ds_read_b64_tr_b16 a[100:101], v15 offset:18432
    s_add_u32 m0, s40, 6144
    v_add_u32 v3, 0x4000, v3
    buffer_load_dwordx4 v3, s[24:27], s63 offen lds
    buffer_load_dwordx4 v3, s[24:27], s64 offen offset:1024 lds
    v_mfma_f32_32x32x16_bf16 v[80:95], a[116:119], v[228:231], v[80:95]
    ds_read_b64_tr_b16 a[102:103], v15 offset:18944
    ds_read_b64_tr_b16 a[104:105], v17 offset:18432
    ds_read_b64_tr_b16 a[106:107], v17 offset:18944
    s_waitcnt lgkmcnt(6)
    v_mfma_f32_32x32x16_bf16 v[96:111], a[120:123], v[228:231], v[96:111]
    ds_read_b64_tr_b16 a[108:109], v19 offset:18432
    ds_read_b64_tr_b16 a[110:111], v19 offset:18944
    v_mfma_f32_32x32x16_bf16 v[112:127], a[124:127], v[228:231], v[112:127]
    s_waitcnt lgkmcnt(4)
    v_mfma_f32_32x32x16_bf16 v[64:79], a[96:99], v[232:235], v[64:79]
    ds_read_b64_tr_b16 a[112:113], v13 offset:51200
    ds_read_b64_tr_b16 a[114:115], v13 offset:51712
    ds_read_b64_tr_b16 a[116:117], v15 offset:51200
    v_mfma_f32_32x32x16_bf16 v[80:95], a[100:103], v[232:235], v[80:95]
    ds_read_b64_tr_b16 a[118:119], v15 offset:51712
    ds_read_b64_tr_b16 a[120:121], v17 offset:51200
    s_waitcnt lgkmcnt(5)
    v_mfma_f32_32x32x16_bf16 v[96:111], a[104:107], v[232:235], v[96:111]
    s_waitcnt vmcnt(17)
    s_barrier
    ds_read_b64_tr_b16 a[122:123], v17 offset:51712
    ds_read_b64_tr_b16 a[124:125], v19 offset:51200
    ds_read_b64_tr_b16 a[126:127], v19 offset:51712
    s_add_u32 m0, s40, 8192
    s_mov_b32 s59, 0x4000
    s_cmp_eq_u32 s101, 24
    s_cselect_b32 s59, 0xfff94000, s59
    v_add_u32 v3, s59, v3
    buffer_load_dwordx4 v3, s[24:27], s63 offen lds
    buffer_load_dwordx4 v3, s[24:27], s64 offen offset:1024 lds
    v_mfma_f32_32x32x16_bf16 v[112:127], a[108:111], v[232:235], v[112:127]
    s_waitcnt lgkmcnt(4)
    v_mfma_f32_32x32x16_bf16 v[64:79], a[112:115], v[236:239], v[64:79]
    ds_read_b64_tr_b16 a[96:97], v12 offset:24576
    ds_read_b64_tr_b16 a[98:99], v12 offset:25088
    ds_read_b64_tr_b16 a[100:101], v14 offset:24576
    ds_read_b64_tr_b16 a[136:137], v10 offset:30720
    ds_read_b64_tr_b16 a[138:139], v10 offset:31744
    s_add_u32 m0, s40, 10240
    v_add_u32 v3, 0x4000, v3
    buffer_load_dwordx4 v3, s[24:27], s63 offen lds
    buffer_load_dwordx4 v3, s[24:27], s64 offen offset:1024 lds
    v_mfma_f32_32x32x16_bf16 v[80:95], a[116:119], v[236:239], v[80:95]
    ds_read_b64_tr_b16 a[102:103], v14 offset:25088
    ds_read_b64_tr_b16 a[104:105], v16 offset:24576
    ds_read_b64_tr_b16 a[106:107], v16 offset:25088
    ds_read_b64_tr_b16 a[140:141], v11 offset:30720
    s_waitcnt lgkmcnt(9)
    v_mfma_f32_32x32x16_bf16 v[96:111], a[120:123], v[236:239], v[96:111]
    ds_read_b64_tr_b16 a[108:109], v18 offset:24576
    ds_read_b64_tr_b16 a[110:111], v18 offset:25088
    ds_read_b64_tr_b16 a[142:143], v11 offset:31744
    v_mfma_f32_32x32x16_bf16 v[112:127], a[124:127], v[236:239], v[112:127]
    s_waitcnt lgkmcnt(6)
    v_mfma_f32_32x32x16_bf16 v[64:79], a[96:99], v[240:243], v[64:79]
    ds_read_b64_tr_b16 a[112:113], v12 offset:57344
    ds_read_b64_tr_b16 a[114:115], v12 offset:57856
    ds_read_b64_tr_b16 a[116:117], v14 offset:57344
    s_waitcnt lgkmcnt(3)
    s_add_u32 m0, s40, 30720
    v_add_u32 v3, 0x4000, v3
    buffer_load_dwordx4 v3, s[24:27], s63 offen lds
    buffer_load_dwordx4 v3, s[24:27], s64 offen offset:1024 lds
    v_mfma_f32_32x32x16_bf16 v[80:95], a[100:103], v[240:243], v[80:95]
    ds_read_b64_tr_b16 a[118:119], v14 offset:57856
    ds_read_b64_tr_b16 a[120:121], v16 offset:57344
    ds_read_b64_tr_b16 a[122:123], v16 offset:57856
    v_mfma_f32_32x32x16_bf16 v[96:111], a[104:107], v[240:243], v[96:111]
    ds_read_b64_tr_b16 a[124:125], v18 offset:57344
    ds_read_b64_tr_b16 a[126:127], v18 offset:57856
    v_mfma_f32_32x32x16_bf16 v[112:127], a[108:111], v[240:243], v[112:127]
    s_waitcnt lgkmcnt(4)
    v_mfma_f32_32x32x16_bf16 v[64:79], a[112:115], v[244:247], v[64:79]
    ds_read_b64_tr_b16 a[96:97], v13 offset:24576
    ds_read_b64_tr_b16 a[98:99], v13 offset:25088
    ds_read_b64_tr_b16 a[100:101], v15 offset:24576
    s_add_u32 m0, s40, 12288
    v_add_u32 v3, 0x4000, v3
    buffer_load_dwordx4 v3, s[24:27], s63 offen lds
    buffer_load_dwordx4 v3, s[24:27], s64 offen offset:1024 lds
    v_mfma_f32_32x32x16_bf16 v[80:95], a[116:119], v[244:247], v[80:95]
    ds_read_b64_tr_b16 a[102:103], v15 offset:25088
    ds_read_b64_tr_b16 a[104:105], v17 offset:24576
    ds_read_b64_tr_b16 a[106:107], v17 offset:25088
    s_waitcnt lgkmcnt(6)
    v_mfma_f32_32x32x16_bf16 v[96:111], a[120:123], v[244:247], v[96:111]
    ds_read_b64_tr_b16 a[108:109], v19 offset:24576
    ds_read_b64_tr_b16 a[110:111], v19 offset:25088
    v_mfma_f32_32x32x16_bf16 v[112:127], a[124:127], v[244:247], v[112:127]
    s_waitcnt lgkmcnt(4)
    v_mfma_f32_32x32x16_bf16 v[64:79], a[96:99], v[248:251], v[64:79]
    ds_read_b64_tr_b16 a[112:113], v13 offset:57344
    ds_read_b64_tr_b16 a[114:115], v13 offset:57856
    ds_read_b64_tr_b16 a[116:117], v15 offset:57344
    v_mfma_f32_32x32x16_bf16 v[80:95], a[100:103], v[248:251], v[80:95]
    ds_read_b64_tr_b16 a[118:119], v15 offset:57856
    ds_read_b64_tr_b16 a[120:121], v17 offset:57344
    s_waitcnt lgkmcnt(5)
    v_mfma_f32_32x32x16_bf16 v[96:111], a[104:107], v[248:251], v[96:111]
    s_barrier
    ds_read_b64_tr_b16 a[122:123], v17 offset:57856
    ds_read_b64_tr_b16 a[124:125], v19 offset:57344
    ds_read_b64_tr_b16 a[126:127], v19 offset:57856
    s_add_u32 m0, s40, 14336
    v_and_b32 v3, 0x3fff, v3
    buffer_load_dwordx4 v3, s[28:31], s65 offen lds
    buffer_load_dwordx4 v3, s[28:31], s66 offen offset:1024 lds
    v_mfma_f32_32x32x16_bf16 v[112:127], a[108:111], v[248:251], v[112:127]
    s_waitcnt lgkmcnt(4)
    v_mfma_f32_32x32x16_bf16 v[64:79], a[112:115], v[252:255], v[64:79]
    s_add_u32 m0, s40, 16384
    v_add_u32 v3, 0x4000, v3
    buffer_load_dwordx4 v3, s[28:31], s65 offen lds
    buffer_load_dwordx4 v3, s[28:31], s66 offen offset:1024 lds
    v_mfma_f32_32x32x16_bf16 v[80:95], a[116:119], v[252:255], v[80:95]
    s_waitcnt lgkmcnt(0)
    v_mfma_f32_32x32x16_bf16 v[96:111], a[120:123], v[252:255], v[96:111]
    v_mfma_f32_32x32x16_bf16 v[112:127], a[124:127], v[252:255], v[112:127]
    s_nop 7
    s_nop 3
    v_max_f32 v64, 0, v64
    v_max_f32 v65, 0, v65
    v_max_f32 v66, 0, v66
    v_max_f32 v67, 0, v67
    v_max_f32 v68, 0, v68
    v_max_f32 v69, 0, v69
    v_max_f32 v70, 0, v70
    v_max_f32 v71, 0, v71
    v_mul_f32 v64, v64, v72
    v_mul_f32 v65, v65, v73
    v_mul_f32 v66, v66, v74
    v_mul_f32 v67, v67, v75
    v_mul_f32 v68, v68, v76
    v_mul_f32 v69, v69, v77
    v_mul_f32 v70, v70, v78
    v_mul_f32 v71, v71, v79
    v_cvt_pk_bf16_f32 v32, v64, v65
    v_cvt_pk_bf16_f32 v33, v66, v67
    v_cvt_pk_bf16_f32 v34, v68, v69
    v_cvt_pk_bf16_f32 v35, v70, v71
    buffer_store_dwordx4 v[32:35], v2, s[20:23], s54 offen sc1
    v_max_f32 v80, 0, v80
    v_max_f32 v81, 0, v81
    v_max_f32 v82, 0, v82
    v_max_f32 v83, 0, v83
    v_max_f32 v84, 0, v84
    v_max_f32 v85, 0, v85
    v_max_f32 v86, 0, v86
    v_max_f32 v87, 0, v87
    v_mul_f32 v80, v80, v88
    v_mul_f32 v81, v81, v89
    v_mul_f32 v82, v82, v90
    v_mul_f32 v83, v83, v91
    v_mul_f32 v84, v84, v92
    v_mul_f32 v85, v85, v93
    v_mul_f32 v86, v86, v94
    v_mul_f32 v87, v87, v95
    v_cvt_pk_bf16_f32 v44, v80, v81
    v_cvt_pk_bf16_f32 v45, v82, v83
    v_cvt_pk_bf16_f32 v46, v84, v85
    v_cvt_pk_bf16_f32 v47, v86, v87
    buffer_store_dwordx4 v[44:47], v2, s[20:23], s54 offen offset:1024 sc1
    v_max_f32 v96, 0, v96
    v_max_f32 v97, 0, v97
    v_max_f32 v98, 0, v98
    v_max_f32 v99, 0, v99
    v_max_f32 v100, 0, v100
    v_max_f32 v101, 0, v101
    v_max_f32 v102, 0, v102
    v_max_f32 v103, 0, v103
    v_mul_f32 v96, v96, v104
    v_mul_f32 v97, v97, v105
    v_mul_f32 v98, v98, v106
    v_mul_f32 v99, v99, v107
    v_mul_f32 v100, v100, v108
    v_mul_f32 v101, v101, v109
    v_mul_f32 v102, v102, v110
    v_mul_f32 v103, v103, v111
    v_cvt_pk_bf16_f32 v32, v96, v97
    v_cvt_pk_bf16_f32 v33, v98, v99
    v_cvt_pk_bf16_f32 v34, v100, v101
    v_cvt_pk_bf16_f32 v35, v102, v103
    buffer_store_dwordx4 v[32:35], v2, s[20:23], s54 offen offset:2048 sc1
    v_max_f32 v112, 0, v112
    v_max_f32 v113, 0, v113
    v_max_f32 v114, 0, v114
    v_max_f32 v115, 0, v115
    v_max_f32 v116, 0, v116
    v_max_f32 v117, 0, v117
    v_max_f32 v118, 0, v118
    v_max_f32 v119, 0, v119
    v_mul_f32 v112, v112, v120
    v_mul_f32 v113, v113, v121
    v_mul_f32 v114, v114, v122
    v_mul_f32 v115, v115, v123
    v_mul_f32 v116, v116, v124
    v_mul_f32 v117, v117, v125
    v_mul_f32 v118, v118, v126
    v_mul_f32 v119, v119, v127
    v_cvt_pk_bf16_f32 v44, v112, v113
    v_cvt_pk_bf16_f32 v45, v114, v115
    v_cvt_pk_bf16_f32 v46, v116, v117
    v_cvt_pk_bf16_f32 v47, v118, v119
    buffer_store_dwordx4 v[44:47], v2, s[20:23], s54 offen offset:3072 sc1
    s_waitcnt vmcnt(0)
    s_barrier
    s_lshl_b32 s58, s37, 4
    s_add_u32 s58, s58, s93
    s_cmp_lg_u32 s36, 0
    s_cbranch_scc1 L_fa12
    s_lshl_b32 s57, s58, 7
    s_add_u32 s57, s57, 0xc00000
    v_mov_b32 v28, s60
    v_mov_b32 v29, 0
    s_mov_b64 s[94:95], exec
    s_mov_b64 exec, 1
    buffer_store_dword v28, v29, s[20:23], s57 offen sc1
    s_mov_b64 exec, s[94:95]
L_fa12:
    s_add_u32 m0, s40, 18432
    v_add_u32 v3, 0x4000, v3
    buffer_load_dwordx4 v3, s[28:31], s65 offen lds
    buffer_load_dwordx4 v3, s[28:31], s66 offen offset:1024 lds
    s_add_u32 m0, s40, 20480
    v_add_u32 v3, 0x4000, v3
    buffer_load_dwordx4 v3, s[28:31], s65 offen lds
    buffer_load_dwordx4 v3, s[28:31], s66 offen offset:1024 lds
    s_add_u32 m0, s40, 22528
    v_add_u32 v3, 0x4000, v3
    buffer_load_dwordx4 v3, s[28:31], s65 offen lds
    buffer_load_dwordx4 v3, s[28:31], s66 offen offset:1024 lds
    s_add_u32 m0, s40, 24576
    v_add_u32 v3, 0x4000, v3
    buffer_load_dwordx4 v3, s[28:31], s65 offen lds
    buffer_load_dwordx4 v3, s[28:31], s66 offen offset:1024 lds
    s_add_u32 m0, s40, 26624
    v_add_u32 v3, 0x4000, v3
    buffer_load_dwordx4 v3, s[28:31], s65 offen lds
    buffer_load_dwordx4 v3, s[28:31], s66 offen offset:1024 lds
    s_add_u32 m0, s40, 28672
    v_add_u32 v3, 0x4000, v3
    buffer_load_dwordx4 v3, s[28:31], s65 offen lds
    buffer_load_dwordx4 v3, s[28:31], s66 offen offset:1024 lds
    v_and_b32 v40, 3, v1
    v_lshlrev_b32 v40, 7, v40
    s_lshr_b32 s57, s61, 1
    s_lshl_b32 s57, s57, 4
    s_lshl_b32 s58, s36, 2
    s_add_u32 s57, s57, s58
    s_lshl_b32 s57, s57, 7
    s_add_u32 s50, s57, 0xc00000
    v_and_b32 v41, 31, v1
    v_lshlrev_b32 v41, 7, v41
    s_lshl_b32 s51, s36, 12
    s_add_u32 s51, s51, 0xc20000
    s_mul_i32 s44, s61, 229376
    s_mul_i32 s57, s36, 28672
    s_add_u32 s44, s44, s57
    s_and_b32 s57, s61, 3
    s_lshl_b32 s57, s57, 13
    s_add_u32 s44, s44, s57
    s_add_u32 s45, s44, 114688
    s_lshl_b32 s46, s61, 16
    s_lshl_b32 s57, s36, 13
    s_add_u32 s46, s46, s57
    s_add_u32 s46, s46, 0x800000
    s_add_u32 s47, s46, 32768
    s_add_u32 s48, s57, 0xb00000
    s_lshl_b32 s67, s39, 1
    s_add_u32 s67, s67, s38
    s_sub_u32 s67, s67, 2
    v_and_b32 v30, 15, v1
    v_lshlrev_b32 v30, 7, v30
    s_lshl_b32 s49, s67, 11
    s_add_u32 s49, s49, 0xc10000
    s_cmp_lg_u32 s36, 0
    s_cbranch_scc1 L_kp13
    s_waitcnt vmcnt(0)
    buffer_load_dword v42, v30, s[20:23], s49 offen sc1
    s_waitcnt vmcnt(0)
    v_cmp_eq_u32 vcc, s60, v42
    s_nop 1
    s_cmp_eq_u64 vcc, -1
    s_cbranch_scc1 L_pcok15
    s_mov_b32 s3, 0
L_pc14:
    buffer_load_dword v42, v30, s[20:23], s49 offen sc1
    s_waitcnt vmcnt(0)
    v_cmp_eq_u32 vcc, s60, v42
    s_nop 1
    s_cmp_eq_u64 vcc, -1
    s_cbranch_scc1 L_pcok15
    s_sleep 6
    s_add_u32 s3, s3, 1
    s_cmp_lt_u32 s3, 20000
    s_cbranch_scc1 L_pc14
L_pcok15:
L_kp13:
    s_barrier
    v_lshrrev_b32 v30, 3, v1
    v_lshlrev_b32 v30, 12, v30
    v_bfe_u32 v31, v1, 2, 1
    v_lshl_add_u32 v30, v31, 10, v30
    v_and_b32 v31, 3, v1
    v_lshl_add_u32 v30, v31, 4, v30
    s_lshl_b32 s49, s67, 2
    s_add_u32 s49, s49, s36
    s_lshl_b32 s57, s49, 15
    s_lshl_b32 s58, s37, 6
    s_add_u32 s57, s57, s58
    s_add_u32 s57, s57, 0xa00000
    buffer_load_dwordx4 v[32:35], v30, s[20:23], s57 offen sc1
    buffer_load_dwordx4 v[36:39], v30, s[20:23], s57 offen offset:2048 sc1
    s_waitcnt vmcnt(0)
    v_add_f32 v32, v32, v36
    v_add_f32 v33, v33, v37
    v_add_f32 v34, v34, v38
    v_add_f32 v35, v35, v39
    v_mov_b32 v36, v32
    v_mov_b32 v37, v33
    v_mov_b32 v38, v34
    v_mov_b32 v39, v35
    s_nop 1
    v_permlane32_swap_b32 v32, v36
    v_permlane32_swap_b32 v33, v37
    v_permlane32_swap_b32 v34, v38
    v_permlane32_swap_b32 v35, v39
    s_nop 1
    v_add_f32 v32, v32, v36
    v_add_f32 v33, v33, v37
    v_add_f32 v34, v34, v38
    v_add_f32 v35, v35, v39
    v_mov_b32 v36, v32
    v_mov_b32 v37, v33
    v_mov_b32 v38, v34
    v_mov_b32 v39, v35
    s_nop 1
    v_permlane16_swap_b32 v32, v36
    v_permlane16_swap_b32 v33, v37
    v_permlane16_swap_b32 v34, v38
    v_permlane16_swap_b32 v35, v39
    s_nop 1
    v_add_f32 v32, v32, v36
    v_add_f32 v33, v33, v37
    v_add_f32 v34, v34, v38
    v_add_f32 v35, v35, v39
    s_nop 1
    v_add_f32_dpp v36, v32, v32 row_ror:8 row_mask:0xf bank_mask:0xf
    v_add_f32_dpp v37, v33, v33 row_ror:8 row_mask:0xf bank_mask:0xf
    v_add_f32_dpp v38, v34, v34 row_ror:8 row_mask:0xf bank_mask:0xf
    v_add_f32_dpp v39, v35, v35 row_ror:8 row_mask:0xf bank_mask:0xf
    v_cvt_pk_bf16_f32 v32, v36, v37
    v_cvt_pk_bf16_f32 v33, v38, v39
    v_and_b32 v31, 3, v1
    v_lshlrev_b32 v30, 4, v31
    v_bfe_u32 v31, v1, 2, 1
    v_lshl_add_u32 v30, v31, 3, v30
    s_lshl_b32 s57, s49, 10
    s_lshl_b32 s58, s37, 6
    s_add_u32 s57, s57, s58
    s_add_u32 s57, s57, 0xb00000
    s_mov_b64 s[94:95], exec
    s_mov_b64 exec, 0xff
    buffer_store_dwordx2 v[32:33], v30, s[20:23], s57 offen sc1
    s_mov_b64 exec, s[94:95]
    s_waitcnt vmcnt(0)
    s_barrier
    s_lshl_b32 s58, s67, 4
    s_add_u32 s58, s58, s37
    s_cmp_lg_u32 s36, 0
    s_cbranch_scc1 L_fa16
    s_lshl_b32 s57, s58, 7
    s_add_u32 s57, s57, 0xc20000
    v_mov_b32 v28, s60
    v_mov_b32 v29, 0
    s_mov_b64 s[94:95], exec
    s_mov_b64 exec, 1
    buffer_store_dword v28, v29, s[20:23], s57 offen sc1
    s_mov_b64 exec, s[94:95]
L_fa16:
    buffer_load_dword v42, v40, s[20:23], s50 offen sc1
    s_waitcnt vmcnt(0)
    v_cmp_eq_u32 vcc, s60, v42
    s_nop 1
    s_cmp_eq_u64 vcc, -1
    s_cbranch_scc1 L_pcok18
    s_mov_b32 s3, 0
L_pc17:
    buffer_load_dword v42, v40, s[20:23], s50 offen sc1
    s_waitcnt vmcnt(0)
    v_cmp_eq_u32 vcc, s60, v42
    s_nop 1
    s_cmp_eq_u64 vcc, -1
    s_cbranch_scc1 L_pcok18
    s_sleep 6
    s_add_u32 s3, s3, 1
    s_cmp_lt_u32 s3, 20000
    s_cbranch_scc1 L_pc17
L_pcok18:
    buffer_load_dwordx4 v[128:131], v2, s[20:23], s44 offen sc1
    buffer_load_dwordx4 v[132:135], v2, s[20:23], s45 offen sc1
    buffer_load_dwordx4 v[136:139], v2, s[20:23], s44 offen offset:1024 sc1
    buffer_load_dwordx4 v[140:143], v2, s[20:23], s45 offen offset:1024 sc1
    buffer_load_dwordx4 v[144:147], v2, s[20:23], s44 offen offset:2048 sc1
    buffer_load_dwordx4 v[148:151], v2, s[20:23], s45 offen offset:2048 sc1
    buffer_load_dwordx4 v[152:155], v2, s[20:23], s44 offen offset:3072 sc1
    buffer_load_dwordx4 v[156:159], v2, s[20:23], s45 offen offset:3072 sc1
    s_movk_i32 s59, 4096
    s_cmp_eq_u32 s101, 4
    s_cselect_b32 s59, 0xffffa000, s59
    s_add_u32 s44, s44, s59
    s_add_u32 s45, s45, s59
    buffer_load_dwordx4 v[160:163], v2, s[20:23], s44 offen sc1
    buffer_load_dwordx4 v[164:167], v2, s[20:23], s45 offen sc1
    buffer_load_dwordx4 v[168:171], v2, s[20:23], s44 offen offset:1024 sc1
    buffer_load_dwordx4 v[172:175], v2, s[20:23], s45 offen offset:1024 sc1
    buffer_load_dwordx4 v[176:179], v2, s[20:23], s44 offen offset:2048 sc1
    buffer_load_dwordx4 v[180:183], v2, s[20:23], s45 offen offset:2048 sc1
    buffer_load_dwordx4 v[184:187], v2, s[20:23], s44 offen offset:3072 sc1
    buffer_load_dwordx4 v[188:191], v2, s[20:23], s45 offen offset:3072 sc1
    s_movk_i32 s59, 4096
    s_cmp_eq_u32 s101, 8
    s_cselect_b32 s59, 0xffffa000, s59
    s_add_u32 s44, s44, s59
    s_add_u32 s45, s45, s59
    buffer_load_dwordx4 v[192:195], v2, s[20:23], s44 offen sc1
    buffer_load_dwordx4 v[196:199], v2, s[20:23], s45 offen sc1
    buffer_load_dwordx4 v[200:203], v2, s[20:23], s44 offen offset:1024 sc1
    buffer_load_dwordx4 v[204:207], v2, s[20:23], s45 offen offset:1024 sc1
    buffer_load_dwordx4 v[208:211], v2, s[20:23], s44 offen offset:2048 sc1
    buffer_load_dwordx4 v[212:215], v2, s[20:23], s45 offen offset:2048 sc1
    buffer_load_dwordx4 v[216:219], v2, s[20:23], s44 offen offset:3072 sc1
    buffer_load_dwordx4 v[220:223], v2, s[20:23], s45 offen offset:3072 sc1
    s_movk_i32 s59, 4096
    s_cmp_eq_u32 s101, 12
    s_cselect_b32 s59, 0xffffa000, s59
    s_add_u32 s44, s44, s59
    s_add_u32 s45, s45, s59
    buffer_load_dwordx4 v[224:227], v2, s[20:23], s44 offen sc1
    buffer_load_dwordx4 v[228:231], v2, s[20:23], s45 offen sc1
    buffer_load_dwordx4 v[232:235], v2, s[20:23], s44 offen offset:1024 sc1
    buffer_load_dwordx4 v[236:239], v2, s[20:23], s45 offen offset:1024 sc1
    buffer_load_dwordx4 v[240:243], v2, s[20:23], s44 offen offset:2048 sc1
    buffer_load_dwordx4 v[244:247], v2, s[20:23], s45 offen offset:2048 sc1
    buffer_load_dwordx4 v[248:251], v2, s[20:23], s44 offen offset:3072 sc1
    buffer_load_dwordx4 v[252:255], v2, s[20:23], s45 offen offset:3072 sc1
    s_movk_i32 s59, 4096
    s_cmp_eq_u32 s101, 16
    s_cselect_b32 s59, 0xffffa000, s59
    s_add_u32 s44, s44, s59
    s_add_u32 s45, s45, s59
    ds_read_b64_tr_b16 a[0:1], v8 offset:0
    ds_read_b64_tr_b16 a[2:3], v8 offset:1024
    ds_read_b64_tr_b16 a[4:5], v9 offset:0
    ds_read_b64_tr_b16 a[6:7], v9 offset:1024
    ds_read_b64_tr_b16 a[8:9], v8 offset:2048
    ds_read_b64_tr_b16 a[10:11], v8 offset:3072
    ds_read_b64_tr_b16 a[12:13], v9 offset:2048
    ds_read_b64_tr_b16 a[14:15], v9 offset:3072
    ds_read_b64_tr_b16 a[16:17], v8 offset:4096
    ds_read_b64_tr_b16 a[18:19], v8 offset:5120
    ds_read_b64_tr_b16 a[20:21], v9 offset:4096
    ds_read_b64_tr_b16 a[22:23], v9 offset:5120
    ds_read_b64_tr_b16 a[24:25], v10 offset:0
    ds_read_b64_tr_b16 a[26:27], v10 offset:1024
    ds_read_b64_tr_b16 a[28:29], v11 offset:0
    ds_read_b64_tr_b16 a[30:31], v11 offset:1024
    ds_read_b64_tr_b16 a[32:33], v10 offset:2048
    ds_read_b64_tr_b16 a[34:35], v10 offset:3072
    ds_read_b64_tr_b16 a[36:37], v11 offset:2048
    ds_read_b64_tr_b16 a[38:39], v11 offset:3072
    ds_read_b64_tr_b16 a[40:41], v8 offset:6144
    ds_read_b64_tr_b16 a[42:43], v8 offset:7168
    ds_read_b64_tr_b16 a[44:45], v9 offset:6144
    ds_read_b64_tr_b16 a[46:47], v9 offset:7168
    ds_read_b64_tr_b16 a[48:49], v10 offset:4096
    ds_read_b64_tr_b16 a[50:51], v10 offset:5120
    ds_read_b64_tr_b16 a[52:53], v11 offset:4096
    ds_read_b64_tr_b16 a[54:55], v11 offset:5120
    ds_read_b64_tr_b16 a[56:57], v10 offset:6144
    ds_read_b64_tr_b16 a[58:59], v10 offset:7168
    ds_read_b64_tr_b16 a[60:61], v11 offset:6144
    ds_read_b64_tr_b16 a[62:63], v11 offset:7168
    ds_read_b64_tr_b16 a[64:65], v10 offset:8192
    ds_read_b64_tr_b16 a[66:67], v10 offset:9216
    ds_read_b64_tr_b16 a[68:69], v11 offset:8192
    ds_read_b64_tr_b16 a[70:71], v11 offset:9216
    ds_read_b64_tr_b16 a[72:73], v10 offset:10240
    ds_read_b64_tr_b16 a[74:75], v10 offset:11264
    ds_read_b64_tr_b16 a[76:77], v11 offset:10240
    ds_read_b64_tr_b16 a[78:79], v11 offset:11264
    ds_read_b64_tr_b16 a[80:81], v10 offset:30720
    ds_read_b64_tr_b16 a[82:83], v10 offset:31744
    ds_read_b64_tr_b16 a[84:85], v11 offset:30720
    ds_read_b64_tr_b16 a[86:87], v11 offset:31744
    ds_read_b64_tr_b16 a[88:89], v10 offset:12288
    ds_read_b64_tr_b16 a[90:91], v10 offset:13312
    ds_read_b64_tr_b16 a[92:93], v11 offset:12288
    ds_read_b64_tr_b16 a[94:95], v11 offset:13312
    s_waitcnt vmcnt(30)
    v_mfma_f32_32x32x16_bf16 v[64:79], a[160:163], v[128:131], 0
    v_mfma_f32_32x32x16_bf16 v[80:95], a[160:163], v[132:135], 0
    v_mfma_f32_32x32x16_bf16 v[96:111], a[164:167], v[128:131], 0
    v_mfma_f32_32x32x16_bf16 v[112:127], a[164:167], v[132:135], 0
    buffer_load_dwordx4 v[128:131], v2, s[20:23], s44 offen sc1
    buffer_load_dwordx4 v[132:135], v2, s[20:23], s45 offen sc1
    s_waitcnt vmcnt(30)
    v_mfma_f32_32x32x16_bf16 v[64:79], a[168:171], v[136:139], v[64:79]
    v_mfma_f32_32x32x16_bf16 v[80:95], a[168:171], v[140:143], v[80:95]
    v_mfma_f32_32x32x16_bf16 v[96:111], a[172:175], v[136:139], v[96:111]
    v_mfma_f32_32x32x16_bf16 v[112:127], a[172:175], v[140:143], v[112:127]
    buffer_load_dwordx4 v[136:139], v2, s[20:23], s44 offen offset:1024 sc1
    buffer_load_dwordx4 v[140:143], v2, s[20:23], s45 offen offset:1024 sc1
    s_waitcnt vmcnt(30)
    v_mfma_f32_32x32x16_bf16 v[64:79], a[176:179], v[144:147], v[64:79]
    v_mfma_f32_32x32x16_bf16 v[80:95], a[176:179], v[148:151], v[80:95]
    v_mfma_f32_32x32x16_bf16 v[96:111], a[180:183], v[144:147], v[96:111]
    v_mfma_f32_32x32x16_bf16 v[112:127], a[180:183], v[148:151], v[112:127]
    buffer_load_dwordx4 v[144:147], v2, s[20:23], s44 offen offset:2048 sc1
    buffer_load_dwordx4 v[148:151], v2, s[20:23], s45 offen offset:2048 sc1
    s_waitcnt vmcnt(30)
    v_mfma_f32_32x32x16_bf16 v[64:79], a[184:187], v[152:155], v[64:79]
    v_mfma_f32_32x32x16_bf16 v[80:95], a[184:187], v[156:159], v[80:95]
    v_mfma_f32_32x32x16_bf16 v[96:111], a[188:191], v[152:155], v[96:111]
    v_mfma_f32_32x32x16_bf16 v[112:127], a[188:191], v[156:159], v[112:127]
    buffer_load_dwordx4 v[152:155], v2, s[20:23], s44 offen offset:3072 sc1
    buffer_load_dwordx4 v[156:159], v2, s[20:23], s45 offen offset:3072 sc1
    s_movk_i32 s59, 4096
    s_cmp_eq_u32 s101, 20
    s_cselect_b32 s59, 0xffffa000, s59
    s_add_u32 s44, s44, s59
    s_add_u32 s45, s45, s59
    s_waitcnt vmcnt(30)
    v_mfma_f32_32x32x16_bf16 v[64:79], a[192:195], v[160:163], v[64:79]
    v_mfma_f32_32x32x16_bf16 v[80:95], a[192:195], v[164:167], v[80:95]
    v_mfma_f32_32x32x16_bf16 v[96:111], a[196:199], v[160:163], v[96:111]
    v_mfma_f32_32x32x16_bf16 v[112:127], a[196:199], v[164:167], v[112:127]
    buffer_load_dwordx4 v[160:163], v2, s[20:23], s44 offen sc1
    buffer_load_dwordx4 v[164:167], v2, s[20:23], s45 offen sc1
    s_waitcnt vmcnt(30)
    v_mfma_f32_32x32x16_bf16 v[64:79], a[200:203], v[168:171], v[64:79]
    v_mfma_f32_32x32x16_bf16 v[80:95], a[200:203], v[172:175], v[80:95]
    v_mfma_f32_32x32x16_bf16 v[96:111], a[204:207], v[168:171], v[96:111]
    v_mfma_f32_32x32x16_bf16 v[112:127], a[204:207], v[172:175], v[112:127]
    buffer_load_dwordx4 v[168:171], v2, s[20:23], s44 offen offset:1024 sc1
    buffer_load_dwordx4 v[172:175], v2, s[20:23], s45 offen offset:1024 sc1
    s_waitcnt vmcnt(30)
    v_mfma_f32_32x32x16_bf16 v[64:79], a[208:211], v[176:179], v[64:79]
    v_mfma_f32_32x32x16_bf16 v[80:95], a[208:211], v[180:183], v[80:95]
    v_mfma_f32_32x32x16_bf16 v[96:111], a[212:215], v[176:179], v[96:111]
    v_mfma_f32_32x32x16_bf16 v[112:127], a[212:215], v[180:183], v[112:127]
    buffer_load_dwordx4 v[176:179], v2, s[20:23], s44 offen offset:2048 sc1
    buffer_load_dwordx4 v[180:183], v2, s[20:23], s45 offen offset:2048 sc1
    s_waitcnt vmcnt(30)
    v_mfma_f32_32x32x16_bf16 v[64:79], a[216:219], v[184:187], v[64:79]
    v_mfma_f32_32x32x16_bf16 v[80:95], a[216:219], v[188:191], v[80:95]
    v_mfma_f32_32x32x16_bf16 v[96:111], a[220:223], v[184:187], v[96:111]
    v_mfma_f32_32x32x16_bf16 v[112:127], a[220:223], v[188:191], v[112:127]
    buffer_load_dwordx4 v[184:187], v2, s[20:23], s44 offen offset:3072 sc1
    buffer_load_dwordx4 v[188:191], v2, s[20:23], s45 offen offset:3072 sc1
    s_movk_i32 s59, 4096
    s_cmp_eq_u32 s101, 24
    s_cselect_b32 s59, 0xffffa000, s59
    s_add_u32 s44, s44, s59
    s_add_u32 s45, s45, s59
    s_waitcnt vmcnt(30)
    v_mfma_f32_32x32x16_bf16 v[64:79], a[224:227], v[192:195], v[64:79]
    v_mfma_f32_32x32x16_bf16 v[80:95], a[224:227], v[196:199], v[80:95]
    v_mfma_f32_32x32x16_bf16 v[96:111], a[228:231], v[192:195], v[96:111]
    v_mfma_f32_32x32x16_bf16 v[112:127], a[228:231], v[196:199], v[112:127]
    buffer_load_dwordx4 v[192:195], v2, s[20:23], s44 offen sc1
    buffer_load_dwordx4 v[196:199], v2, s[20:23], s45 offen sc1
    s_waitcnt vmcnt(30)
    v_mfma_f32_32x32x16_bf16 v[64:79], a[232:235], v[200:203], v[64:79]
    v_mfma_f32_32x32x16_bf16 v[80:95], a[232:235], v[204:207], v[80:95]
    v_mfma_f32_32x32x16_bf16 v[96:111], a[236:239], v[200:203], v[96:111]
    v_mfma_f32_32x32x16_bf16 v[112:127], a[236:239], v[204:207], v[112:127]
    buffer_load_dwordx4 v[200:203], v2, s[20:23], s44 offen offset:1024 sc1
    buffer_load_dwordx4 v[204:207], v2, s[20:23], s45 offen offset:1024 sc1
    s_waitcnt vmcnt(30)
    v_mfma_f32_32x32x16_bf16 v[64:79], a[240:243], v[208:211], v[64:79]
    v_mfma_f32_32x32x16_bf16 v[80:95], a[240:243], v[212:215], v[80:95]
    v_mfma_f32_32x32x16_bf16 v[96:111], a[244:247], v[208:211], v[96:111]
    v_mfma_f32_32x32x16_bf16 v[112:127], a[244:247], v[212:215], v[112:127]
    buffer_load_dwordx4 v[208:211], v2, s[20:23], s44 offen offset:2048 sc1
    buffer_load_dwordx4 v[212:215], v2, s[20:23], s45 offen offset:2048 sc1
    s_waitcnt vmcnt(30)
    v_mfma_f32_32x32x16_bf16 v[64:79], a[248:251], v[216:219], v[64:79]
    v_mfma_f32_32x32x16_bf16 v[80:95], a[248:251], v[220:223], v[80:95]
    v_mfma_f32_32x32x16_bf16 v[96:111], a[252:255], v[216:219], v[96:111]
    v_mfma_f32_32x32x16_bf16 v[112:127], a[252:255], v[220:223], v[112:127]
    buffer_load_dwordx4 v[216:219], v2, s[20:23], s44 offen offset:3072 sc1
    buffer_load_dwordx4 v[220:223], v2, s[20:23], s45 offen offset:3072 sc1
    s_waitcnt vmcnt(30)
    v_mfma_f32_32x32x16_bf16 v[64:79], a[144:147], v[224:227], v[64:79]
    v_mfma_f32_32x32x16_bf16 v[80:95], a[144:147], v[228:231], v[80:95]
    v_mfma_f32_32x32x16_bf16 v[96:111], a[148:151], v[224:227], v[96:111]
    v_mfma_f32_32x32x16_bf16 v[112:127], a[148:151], v[228:231], v[112:127]
    buffer_load_dword v42, v41, s[20:23], s51 offen sc1
    s_waitcnt vmcnt(29)
    v_mfma_f32_32x32x16_bf16 v[64:79], a[152:155], v[232:235], v[64:79]
    v_mfma_f32_32x32x16_bf16 v[80:95], a[152:155], v[236:239], v[80:95]
    v_mfma_f32_32x32x16_bf16 v[96:111], a[156:159], v[232:235], v[96:111]
    v_mfma_f32_32x32x16_bf16 v[112:127], a[156:159], v[236:239], v[112:127]
    s_waitcnt vmcnt(27)
    v_mfma_f32_32x32x16_bf16 v[64:79], a[128:131], v[240:243], v[64:79]
    v_mfma_f32_32x32x16_bf16 v[80:95], a[128:131], v[244:247], v[80:95]
    v_mfma_f32_32x32x16_bf16 v[96:111], a[132:135], v[240:243], v[96:111]
    v_mfma_f32_32x32x16_bf16 v[112:127], a[132:135], v[244:247], v[112:127]
    s_waitcnt vmcnt(25)
    v_mfma_f32_32x32x16_bf16 v[64:79], a[136:139], v[248:251], v[64:79]
    v_mfma_f32_32x32x16_bf16 v[80:95], a[136:139], v[252:255], v[80:95]
    v_mfma_f32_32x32x16_bf16 v[96:111], a[140:143], v[248:251], v[96:111]
    v_mfma_f32_32x32x16_bf16 v[112:127], a[140:143], v[252:255], v[112:127]
    s_waitcnt vmcnt(23) lgkmcnt(15)
    v_mfma_f32_32x32x16_bf16 v[64:79], a[0:3], v[128:131], v[64:79]
    v_mfma_f32_32x32x16_bf16 v[80:95], a[0:3], v[132:135], v[80:95]
    v_mfma_f32_32x32x16_bf16 v[96:111], a[4:7], v[128:131], v[96:111]
    v_mfma_f32_32x32x16_bf16 v[112:127], a[4:7], v[132:135], v[112:127]
    buffer_load_dwordx4 v[128:131], v2, s[20:23], s46 offen sc1
    buffer_load_dwordx4 v[132:135], v2, s[20:23], s47 offen sc1
    s_waitcnt vmcnt(2)
    v_cmp_eq_u32 vcc, s60, v42
    s_nop 1
    s_cmp_eq_u64 vcc, -1
    s_cbranch_scc1 L_pcok20
    s_mov_b32 s3, 0
L_pc19:
    buffer_load_dword v42, v41, s[20:23], s51 offen sc1
    s_waitcnt vmcnt(0)
    v_cmp_eq_u32 vcc, s60, v42
    s_nop 1
    s_cmp_eq_u64 vcc, -1
    s_cbranch_scc1 L_pcok20
    s_sleep 6
    s_add_u32 s3, s3, 1
    s_cmp_lt_u32 s3, 20000
    s_cbranch_scc1 L_pc19
L_pcok20:
    buffer_load_dwordx4 v[224:227], v2, s[20:23], s48 offen sc1
    buffer_load_dwordx4 v[228:231], v2, s[20:23], s48 offen offset:1024 sc1
    buffer_load_dwordx4 v[232:235], v2, s[20:23], s48 offen offset:2048 sc1
    buffer_load_dwordx4 v[236:239], v2, s[20:23], s48 offen offset:3072 sc1
    s_add_u32 s48, s48, 4096
    buffer_load_dwordx4 v[240:243], v2, s[20:23], s48 offen sc1
    buffer_load_dwordx4 v[244:247], v2, s[20:23], s48 offen offset:1024 sc1
    buffer_load_dwordx4 v[248:251], v2, s[20:23], s48 offen offset:2048 sc1
    buffer_load_dwordx4 v[252:255], v2, s[20:23], s48 offen offset:3072 sc1
    v_mfma_f32_32x32x16_bf16 v[64:79], a[8:11], v[136:139], v[64:79]
    v_mfma_f32_32x32x16_bf16 v[80:95], a[8:11], v[140:143], v[80:95]
    v_mfma_f32_32x32x16_bf16 v[96:111], a[12:15], v[136:139], v[96:111]
    v_mfma_f32_32x32x16_bf16 v[112:127], a[12:15], v[140:143], v[112:127]
    buffer_load_dwordx4 v[136:139], v2, s[20:23], s46 offen offset:1024 sc1
    buffer_load_dwordx4 v[140:143], v2, s[20:23], s47 offen offset:1024 sc1
    v_mfma_f32_32x32x16_bf16 v[64:79], a[16:19], v[144:147], v[64:79]
    v_mfma_f32_32x32x16_bf16 v[80:95], a[16:19], v[148:151], v[80:95]
    v_mfma_f32_32x32x16_bf16 v[96:111], a[20:23], v[144:147], v[96:111]
    v_mfma_f32_32x32x16_bf16 v[112:127], a[20:23], v[148:151], v[112:127]
    buffer_load_dwordx4 v[144:147], v2, s[20:23], s46 offen offset:2048 sc1
    buffer_load_dwordx4 v[148:151], v2, s[20:23], s47 offen offset:2048 sc1
    v_mfma_f32_32x32x16_bf16 v[64:79], a[24:27], v[152:155], v[64:79]
    v_mfma_f32_32x32x16_bf16 v[80:95], a[24:27], v[156:159], v[80:95]
    v_mfma_f32_32x32x16_bf16 v[96:111], a[28:31], v[152:155], v[96:111]
    v_mfma_f32_32x32x16_bf16 v[112:127], a[28:31], v[156:159], v[112:127]
    buffer_load_dwordx4 v[152:155], v2, s[20:23], s46 offen offset:3072 sc1
    buffer_load_dwordx4 v[156:159], v2, s[20:23], s47 offen offset:3072 sc1
    s_add_u32 s46, s46, 4096
    s_add_u32 s47, s47, 4096
    v_mfma_f32_32x32x16_bf16 v[64:79], a[32:35], v[160:163], v[64:79]
    v_mfma_f32_32x32x16_bf16 v[80:95], a[32:35], v[164:167], v[80:95]
    v_mfma_f32_32x32x16_bf16 v[96:111], a[36:39], v[160:163], v[96:111]
    v_mfma_f32_32x32x16_bf16 v[112:127], a[36:39], v[164:167], v[112:127]
    buffer_load_dwordx4 v[160:163], v2, s[20:23], s46 offen sc1
    buffer_load_dwordx4 v[164:167], v2, s[20:23], s47 offen sc1
    v_lshrrev_b32 v46, 3, v0
    v_lshlrev_b32 v46, 10, v46
    v_and_b32 v47, 7, v0
    v_lshl_add_u32 v46, v47, 4, v46
    s_lshl_b32 s52, s61, 16
    s_lshl_b32 s58, s62, 7
    s_add_u32 s52, s52, s58
    s_add_u32 s54, s52, 32768
    buffer_load_dwordx4 v[48:51], v46, s[4:7], s52 offen
    buffer_load_dwordx4 v[52:55], v46, s[4:7], s54 offen
    v_mfma_f32_32x32x16_bf16 v[64:79], a[40:43], v[168:171], v[64:79]
    v_mfma_f32_32x32x16_bf16 v[80:95], a[40:43], v[172:175], v[80:95]
    v_mfma_f32_32x32x16_bf16 v[96:111], a[44:47], v[168:171], v[96:111]
    v_mfma_f32_32x32x16_bf16 v[112:127], a[44:47], v[172:175], v[112:127]
    buffer_load_dwordx4 v[168:171], v2, s[20:23], s46 offen offset:1024 sc1
    buffer_load_dwordx4 v[172:175], v2, s[20:23], s47 offen offset:1024 sc1
    v_mfma_f32_32x32x16_bf16 v[64:79], a[48:51], v[176:179], v[64:79]
    v_mfma_f32_32x32x16_bf16 v[80:95], a[48:51], v[180:183], v[80:95]
    v_mfma_f32_32x32x16_bf16 v[96:111], a[52:55], v[176:179], v[96:111]
    v_mfma_f32_32x32x16_bf16 v[112:127], a[52:55], v[180:183], v[112:127]
    buffer_load_dwordx4 v[176:179], v2, s[20:23], s46 offen offset:2048 sc1
    buffer_load_dwordx4 v[180:183], v2, s[20:23], s47 offen offset:2048 sc1
    v_mfma_f32_32x32x16_bf16 v[64:79], a[56:59], v[184:187], v[64:79]
    v_mfma_f32_32x32x16_bf16 v[80:95], a[56:59], v[188:191], v[80:95]
    v_mfma_f32_32x32x16_bf16 v[96:111], a[60:63], v[184:187], v[96:111]
    v_mfma_f32_32x32x16_bf16 v[112:127], a[60:63], v[188:191], v[112:127]
    buffer_load_dwordx4 v[184:187], v2, s[20:23], s46 offen offset:3072 sc1
    buffer_load_dwordx4 v[188:191], v2, s[20:23], s47 offen offset:3072 sc1
    s_waitcnt lgkmcnt(12)
    v_mfma_f32_32x32x16_bf16 v[64:79], a[64:67], v[192:195], v[64:79]
    v_mfma_f32_32x32x16_bf16 v[80:95], a[64:67], v[196:199], v[80:95]
    v_mfma_f32_32x32x16_bf16 v[96:111], a[68:71], v[192:195], v[96:111]
    v_mfma_f32_32x32x16_bf16 v[112:127], a[68:71], v[196:199], v[112:127]
    s_waitcnt lgkmcnt(8)
    v_mfma_f32_32x32x16_bf16 v[64:79], a[72:75], v[200:203], v[64:79]
    v_mfma_f32_32x32x16_bf16 v[80:95], a[72:75], v[204:207], v[80:95]
    v_mfma_f32_32x32x16_bf16 v[96:111], a[76:79], v[200:203], v[96:111]
    v_mfma_f32_32x32x16_bf16 v[112:127], a[76:79], v[204:207], v[112:127]
    s_waitcnt lgkmcnt(4)
    v_mfma_f32_32x32x16_bf16 v[64:79], a[80:83], v[208:211], v[64:79]
    v_mfma_f32_32x32x16_bf16 v[80:95], a[80:83], v[212:215], v[80:95]
    v_mfma_f32_32x32x16_bf16 v[96:111], a[84:87], v[208:211], v[96:111]
    v_mfma_f32_32x32x16_bf16 v[112:127], a[84:87], v[212:215], v[112:127]
    s_waitcnt lgkmcnt(0)
    v_mfma_f32_32x32x16_bf16 v[64:79], a[88:91], v[216:219], v[64:79]
    v_mfma_f32_32x32x16_bf16 v[80:95], a[88:91], v[220:223], v[80:95]
    v_mfma_f32_32x32x16_bf16 v[96:111], a[92:95], v[216:219], v[96:111]
    v_mfma_f32_32x32x16_bf16 v[112:127], a[92:95], v[220:223], v[112:127]
    s_nop 3
    ds_read_b64_tr_b16 a[0:1], v10 offset:14336
    ds_read_b64_tr_b16 a[2:3], v10 offset:15360
    ds_read_b64_tr_b16 a[4:5], v11 offset:14336
    ds_read_b64_tr_b16 a[6:7], v11 offset:15360
    ds_read_b64_tr_b16 a[8:9], v10 offset:16384
    ds_read_b64_tr_b16 a[10:11], v10 offset:17408
    ds_read_b64_tr_b16 a[12:13], v11 offset:16384
    ds_read_b64_tr_b16 a[14:15], v11 offset:17408
    s_waitcnt vmcnt(23)
    v_mfma_f32_32x32x16_bf16 v[192:207], v[224:227], v[128:131], 0
    v_mfma_f32_32x32x16_bf16 v[208:223], v[224:227], v[132:135], 0
    s_nop 10
    v_add_f32 v28, s42, v200
    v_rcp_f32 v28, v28
    s_nop 0
    v_mul_f32 v192, v192, v28
    v_mul_f32 v193, v193, v28
    v_mul_f32 v194, v194, v28
    v_mul_f32 v195, v195, v28
    v_mul_f32 v196, v196, v28
    v_mul_f32 v197, v197, v28
    v_mul_f32 v198, v198, v28
    v_mul_f32 v199, v199, v28
    v_cvt_pk_bf16_f32 v24, v192, v193
    v_cvt_pk_bf16_f32 v25, v194, v195
    v_cvt_pk_bf16_f32 v26, v196, v197
    v_cvt_pk_bf16_f32 v27, v198, v199
    s_waitcnt vmcnt(15)
    v_mfma_f32_32x32x16_bf16 v[192:207], v[228:231], v[136:139], 0
    ds_read_b64_tr_b16 a[16:17], v10 offset:18432
    ds_read_b64_tr_b16 a[18:19], v10 offset:19456
    ds_read_b64_tr_b16 a[20:21], v11 offset:18432
    ds_read_b64_tr_b16 a[22:23], v11 offset:19456
    s_waitcnt lgkmcnt(8)
    v_mfma_f32_32x32x16_bf16 v[64:79], a[0:3], v[24:27], v[64:79]
    v_mfma_f32_32x32x16_bf16 v[96:111], a[4:7], v[24:27], v[96:111]
    v_add_f32 v36, s42, v216
    v_rcp_f32 v36, v36
    s_nop 0
    v_mul_f32 v208, v208, v36
    v_mul_f32 v209, v209, v36
    v_mul_f32 v210, v210, v36
    v_mul_f32 v211, v211, v36
    v_mul_f32 v212, v212, v36
    v_mul_f32 v213, v213, v36
    v_mul_f32 v214, v214, v36
    v_mul_f32 v215, v215, v36
    v_cvt_pk_bf16_f32 v32, v208, v209
    v_cvt_pk_bf16_f32 v33, v210, v211
    v_cvt_pk_bf16_f32 v34, v212, v213
    v_cvt_pk_bf16_f32 v35, v214, v215
    s_waitcnt vmcnt(14)
    v_mfma_f32_32x32x16_bf16 v[208:223], v[228:231], v[140:143], 0
    v_mfma_f32_32x32x16_bf16 v[80:95], a[0:3], v[32:35], v[80:95]
    v_mfma_f32_32x32x16_bf16 v[112:127], a[4:7], v[32:35], v[112:127]
    v_add_f32 v28, s42, v192
    v_rcp_f32 v28, v28
    s_nop 0
    v_mul_f32 v200, v200, v28
    v_mul_f32 v201, v201, v28
    v_mul_f32 v202, v202, v28
    v_mul_f32 v203, v203, v28
    v_mul_f32 v204, v204, v28
    v_mul_f32 v205, v205, v28
    v_mul_f32 v206, v206, v28
    v_mul_f32 v207, v207, v28
    v_cvt_pk_bf16_f32 v24, v200, v201
    v_cvt_pk_bf16_f32 v25, v202, v203
    v_cvt_pk_bf16_f32 v26, v204, v205
    v_cvt_pk_bf16_f32 v27, v206, v207
    s_waitcnt vmcnt(13)
    v_mfma_f32_32x32x16_bf16 v[192:207], v[232:235], v[144:147], 0
    ds_read_b64_tr_b16 a[0:1], v10 offset:20480
    ds_read_b64_tr_b16 a[2:3], v10 offset:21504
    ds_read_b64_tr_b16 a[4:5], v11 offset:20480
    ds_read_b64_tr_b16 a[6:7], v11 offset:21504
    s_waitcnt lgkmcnt(8)
    v_mfma_f32_32x32x16_bf16 v[64:79], a[8:11], v[24:27], v[64:79]
    v_mfma_f32_32x32x16_bf16 v[96:111], a[12:15], v[24:27], v[96:111]
    v_add_f32 v36, s42, v208
    v_rcp_f32 v36, v36
    s_nop 0
    v_mul_f32 v216, v216, v36
    v_mul_f32 v217, v217, v36
    v_mul_f32 v218, v218, v36
    v_mul_f32 v219, v219, v36
    v_mul_f32 v220, v220, v36
    v_mul_f32 v221, v221, v36
    v_mul_f32 v222, v222, v36
    v_mul_f32 v223, v223, v36
    v_cvt_pk_bf16_f32 v32, v216, v217
    v_cvt_pk_bf16_f32 v33, v218, v219
    v_cvt_pk_bf16_f32 v34, v220, v221
    v_cvt_pk_bf16_f32 v35, v222, v223
    s_waitcnt vmcnt(12)
    v_mfma_f32_32x32x16_bf16 v[208:223], v[232:235], v[148:151], 0
    v_mfma_f32_32x32x16_bf16 v[80:95], a[8:11], v[32:35], v[80:95]
    v_mfma_f32_32x32x16_bf16 v[112:127], a[12:15], v[32:35], v[112:127]
    v_add_f32 v28, s42, v200
    v_rcp_f32 v28, v28
    s_nop 0
    v_mul_f32 v192, v192, v28
    v_mul_f32 v193, v193, v28
    v_mul_f32 v194, v194, v28
    v_mul_f32 v195, v195, v28
    v_mul_f32 v196, v196, v28
    v_mul_f32 v197, v197, v28
    v_mul_f32 v198, v198, v28
    v_mul_f32 v199, v199, v28
    v_cvt_pk_bf16_f32 v24, v192, v193
    v_cvt_pk_bf16_f32 v25, v194, v195
    v_cvt_pk_bf16_f32 v26, v196, v197
    v_cvt_pk_bf16_f32 v27, v198, v199
    s_waitcnt vmcnt(11)
    v_mfma_f32_32x32x16_bf16 v[192:207], v[236:239], v[152:155], 0
    ds_read_b64_tr_b16 a[8:9], v10 offset:22528
    ds_read_b64_tr_b16 a[10:11], v10 offset:23552
    ds_read_b64_tr_b16 a[12:13], v11 offset:22528
    ds_read_b64_tr_b16 a[14:15], v11 offset:23552
    s_waitcnt lgkmcnt(8)
    v_mfma_f32_32x32x16_bf16 v[64:79], a[16:19], v[24:27], v[64:79]
    v_mfma_f32_32x32x16_bf16 v[96:111], a[20:23], v[24:27], v[96:111]
    v_add_f32 v36, s42, v216
    v_rcp_f32 v36, v36
    s_nop 0
    v_mul_f32 v208, v208, v36
    v_mul_f32 v209, v209, v36
    v_mul_f32 v210, v210, v36
    v_mul_f32 v211, v211, v36
    v_mul_f32 v212, v212, v36
    v_mul_f32 v213, v213, v36
    v_mul_f32 v214, v214, v36
    v_mul_f32 v215, v215, v36
    v_cvt_pk_bf16_f32 v32, v208, v209
    v_cvt_pk_bf16_f32 v33, v210, v211
    v_cvt_pk_bf16_f32 v34, v212, v213
    v_cvt_pk_bf16_f32 v35, v214, v215
    s_waitcnt vmcnt(10)
    v_mfma_f32_32x32x16_bf16 v[208:223], v[236:239], v[156:159], 0
    v_mfma_f32_32x32x16_bf16 v[80:95], a[16:19], v[32:35], v[80:95]
    v_mfma_f32_32x32x16_bf16 v[112:127], a[20:23], v[32:35], v[112:127]
    v_add_f32 v28, s42, v192
    v_rcp_f32 v28, v28
    s_nop 0
    v_mul_f32 v200, v200, v28
    v_mul_f32 v201, v201, v28
    v_mul_f32 v202, v202, v28
    v_mul_f32 v203, v203, v28
    v_mul_f32 v204, v204, v28
    v_mul_f32 v205, v205, v28
    v_mul_f32 v206, v206, v28
    v_mul_f32 v207, v207, v28
    v_cvt_pk_bf16_f32 v24, v200, v201
    v_cvt_pk_bf16_f32 v25, v202, v203
    v_cvt_pk_bf16_f32 v26, v204, v205
    v_cvt_pk_bf16_f32 v27, v206, v207
    s_waitcnt vmcnt(9)
    v_mfma_f32_32x32x16_bf16 v[192:207], v[240:243], v[160:163], 0
    ds_read_b64_tr_b16 a[16:17], v10 offset:24576
    ds_read_b64_tr_b16 a[18:19], v10 offset:25600
    ds_read_b64_tr_b16 a[20:21], v11 offset:24576
    ds_read_b64_tr_b16 a[22:23], v11 offset:25600
    s_waitcnt lgkmcnt(8)
    v_mfma_f32_32x32x16_bf16 v[64:79], a[0:3], v[24:27], v[64:79]
    v_mfma_f32_32x32x16_bf16 v[96:111], a[4:7], v[24:27], v[96:111]
    v_add_f32 v36, s42, v208
    v_rcp_f32 v36, v36
    s_nop 0
    v_mul_f32 v216, v216, v36
    v_mul_f32 v217, v217, v36
    v_mul_f32 v218, v218, v36
    v_mul_f32 v219, v219, v36
    v_mul_f32 v220, v220, v36
    v_mul_f32 v221, v221, v36
    v_mul_f32 v222, v222, v36
    v_mul_f32 v223, v223, v36
    v_cvt_pk_bf16_f32 v32, v216, v217
    v_cvt_pk_bf16_f32 v33, v218, v219
    v_cvt_pk_bf16_f32 v34, v220, v221
    v_cvt_pk_bf16_f32 v35, v222, v223
    s_waitcnt vmcnt(8)
    v_mfma_f32_32x32x16_bf16 v[208:223], v[240:243], v[164:167], 0
    v_mfma_f32_32x32x16_bf16 v[80:95], a[0:3], v[32:35], v[80:95]
    v_mfma_f32_32x32x16_bf16 v[112:127], a[4:7], v[32:35], v[112:127]
    v_add_f32 v28, s42, v200
    v_rcp_f32 v28, v28
    s_nop 0
    v_mul_f32 v192, v192, v28
    v_mul_f32 v193, v193, v28
    v_mul_f32 v194, v194, v28
    v_mul_f32 v195, v195, v28
    v_mul_f32 v196, v196, v28
    v_mul_f32 v197, v197, v28
    v_mul_f32 v198, v198, v28
    v_mul_f32 v199, v199, v28
    v_cvt_pk_bf16_f32 v24, v192, v193
    v_cvt_pk_bf16_f32 v25, v194, v195
    v_cvt_pk_bf16_f32 v26, v196, v197
    v_cvt_pk_bf16_f32 v27, v198, v199
    s_waitcnt vmcnt(5)
    v_mfma_f32_32x32x16_bf16 v[192:207], v[244:247], v[168:171], 0
    ds_read_b64_tr_b16 a[0:1], v10 offset:26624
    ds_read_b64_tr_b16 a[2:3], v10 offset:27648
    ds_read_b64_tr_b16 a[4:5], v11 offset:26624
    ds_read_b64_tr_b16 a[6:7], v11 offset:27648
    s_waitcnt lgkmcnt(8)
    v_mfma_f32_32x32x16_bf16 v[64:79], a[8:11], v[24:27], v[64:79]
    v_mfma_f32_32x32x16_bf16 v[96:111], a[12:15], v[24:27], v[96:111]
    v_add_f32 v36, s42, v216
    v_rcp_f32 v36, v36
    s_nop 0
    v_mul_f32 v208, v208, v36
    v_mul_f32 v209, v209, v36
    v_mul_f32 v210, v210, v36
    v_mul_f32 v211, v211, v36
    v_mul_f32 v212, v212, v36
    v_mul_f32 v213, v213, v36
    v_mul_f32 v214, v214, v36
    v_mul_f32 v215, v215, v36
    v_cvt_pk_bf16_f32 v32, v208, v209
    v_cvt_pk_bf16_f32 v33, v210, v211
    v_cvt_pk_bf16_f32 v34, v212, v213
    v_cvt_pk_bf16_f32 v35, v214, v215
    s_waitcnt vmcnt(4)
    v_mfma_f32_32x32x16_bf16 v[208:223], v[244:247], v[172:175], 0
    v_mfma_f32_32x32x16_bf16 v[80:95], a[8:11], v[32:35], v[80:95]
    v_mfma_f32_32x32x16_bf16 v[112:127], a[12:15], v[32:35], v[112:127]
    v_add_f32 v28, s42, v192
    v_rcp_f32 v28, v28
    s_nop 0
    v_mul_f32 v200, v200, v28
    v_mul_f32 v201, v201, v28
    v_mul_f32 v202, v202, v28
    v_mul_f32 v203, v203, v28
    v_mul_f32 v204, v204, v28
    v_mul_f32 v205, v205, v28
    v_mul_f32 v206, v206, v28
    v_mul_f32 v207, v207, v28
    v_cvt_pk_bf16_f32 v24, v200, v201
    v_cvt_pk_bf16_f32 v25, v202, v203
    v_cvt_pk_bf16_f32 v26, v204, v205
    v_cvt_pk_bf16_f32 v27, v206, v207
    s_waitcnt vmcnt(3)
    v_mfma_f32_32x32x16_bf16 v[192:207], v[248:251], v[176:179], 0
    ds_read_b64_tr_b16 a[8:9], v10 offset:28672
    ds_read_b64_tr_b16 a[10:11], v10 offset:29696
    ds_read_b64_tr_b16 a[12:13], v11 offset:28672
    ds_read_b64_tr_b16 a[14:15], v11 offset:29696
    s_waitcnt lgkmcnt(8)
    v_mfma_f32_32x32x16_bf16 v[64:79], a[16:19], v[24:27], v[64:79]
    v_mfma_f32_32x32x16_bf16 v[96:111], a[20:23], v[24:27], v[96:111]
    v_add_f32 v36, s42, v208
    v_rcp_f32 v36, v36
    s_nop 0
    v_mul_f32 v216, v216, v36
    v_mul_f32 v217, v217, v36
    v_mul_f32 v218, v218, v36
    v_mul_f32 v219, v219, v36
    v_mul_f32 v220, v220, v36
    v_mul_f32 v221, v221, v36
    v_mul_f32 v222, v222, v36
    v_mul_f32 v223, v223, v36
    v_cvt_pk_bf16_f32 v32, v216, v217
    v_cvt_pk_bf16_f32 v33, v218, v219
    v_cvt_pk_bf16_f32 v34, v220, v221
    v_cvt_pk_bf16_f32 v35, v222, v223
    s_waitcnt vmcnt(2)
    v_mfma_f32_32x32x16_bf16 v[208:223], v[248:251], v[180:183], 0
    v_mfma_f32_32x32x16_bf16 v[80:95], a[16:19], v[32:35], v[80:95]
    v_mfma_f32_32x32x16_bf16 v[112:127], a[20:23], v[32:35], v[112:127]
    v_add_f32 v28, s42, v200
    v_rcp_f32 v28, v28
    s_nop 0
    v_mul_f32 v192, v192, v28
    v_mul_f32 v193, v193, v28
    v_mul_f32 v194, v194, v28
    v_mul_f32 v195, v195, v28
    v_mul_f32 v196, v196, v28
    v_mul_f32 v197, v197, v28
    v_mul_f32 v198, v198, v28
    v_mul_f32 v199, v199, v28
    v_cvt_pk_bf16_f32 v24, v192, v193
    v_cvt_pk_bf16_f32 v25, v194, v195
    v_cvt_pk_bf16_f32 v26, v196, v197
    v_cvt_pk_bf16_f32 v27, v198, v199
    s_waitcnt vmcnt(1)
    v_mfma_f32_32x32x16_bf16 v[192:207], v[252:255], v[184:187], 0
    s_waitcnt lgkmcnt(4)
    v_mfma_f32_32x32x16_bf16 v[64:79], a[0:3], v[24:27], v[64:79]
    v_mfma_f32_32x32x16_bf16 v[96:111], a[4:7], v[24:27], v[96:111]
    v_add_f32 v36, s42, v216
    v_rcp_f32 v36, v36
    s_nop 0
    v_mul_f32 v208, v208, v36
    v_mul_f32 v209, v209, v36
    v_mul_f32 v210, v210, v36
    v_mul_f32 v211, v211, v36
    v_mul_f32 v212, v212, v36
    v_mul_f32 v213, v213, v36
    v_mul_f32 v214, v214, v36
    v_mul_f32 v215, v215, v36
    v_cvt_pk_bf16_f32 v32, v208, v209
    v_cvt_pk_bf16_f32 v33, v210, v211
    v_cvt_pk_bf16_f32 v34, v212, v213
    v_cvt_pk_bf16_f32 v35, v214, v215
    s_waitcnt vmcnt(0)
    v_mfma_f32_32x32x16_bf16 v[208:223], v[252:255], v[188:191], 0
    v_mfma_f32_32x32x16_bf16 v[80:95], a[0:3], v[32:35], v[80:95]
    v_mfma_f32_32x32x16_bf16 v[112:127], a[4:7], v[32:35], v[112:127]
    v_add_f32 v28, s42, v192
    v_rcp_f32 v28, v28
    s_nop 0
    v_mul_f32 v200, v200, v28
    v_mul_f32 v201, v201, v28
    v_mul_f32 v202, v202, v28
    v_mul_f32 v203, v203, v28
    v_mul_f32 v204, v204, v28
    v_mul_f32 v205, v205, v28
    v_mul_f32 v206, v206, v28
    v_mul_f32 v207, v207, v28
    v_cvt_pk_bf16_f32 v24, v200, v201
    v_cvt_pk_bf16_f32 v25, v202, v203
    v_cvt_pk_bf16_f32 v26, v204, v205
    v_cvt_pk_bf16_f32 v27, v206, v207
    s_waitcnt lgkmcnt(0)
    s_nop 0
    v_mfma_f32_32x32x16_bf16 v[64:79], a[8:11], v[24:27], v[64:79]
    v_mfma_f32_32x32x16_bf16 v[96:111], a[12:15], v[24:27], v[96:111]
    v_add_f32 v36, s42, v208
    v_rcp_f32 v36, v36
    s_nop 0
    v_mul_f32 v216, v216, v36
    v_mul_f32 v217, v217, v36
    v_mul_f32 v218, v218, v36
    v_mul_f32 v219, v219, v36
    v_mul_f32 v220, v220, v36
    v_mul_f32 v221, v221, v36
    v_mul_f32 v222, v222, v36
    v_mul_f32 v223, v223, v36
    v_cvt_pk_bf16_f32 v32, v216, v217
    v_cvt_pk_bf16_f32 v33, v218, v219
    v_cvt_pk_bf16_f32 v34, v220, v221
    v_cvt_pk_bf16_f32 v35, v222, v223
    s_nop 1
    v_mfma_f32_32x32x16_bf16 v[80:95], a[8:11], v[32:35], v[80:95]
    v_mfma_f32_32x32x16_bf16 v[112:127], a[12:15], v[32:35], v[112:127]
    s_waitcnt lgkmcnt(0)
    v_and_b32 v24, 31, v1
    v_mul_u32_u24 v24, 272, v24
    v_lshrrev_b32 v25, 5, v1
    v_lshl_add_u32 v24, v25, 4, v24
    v_add_u32 v24, s40, v24
    v_lshrrev_b32 v26, 3, v0
    v_mul_u32_u24 v26, 272, v26
    v_and_b32 v27, 7, v0
    v_lshl_add_u32 v26, v27, 5, v26
    v_add_u32 v27, 0x10000, v26
    s_nop 3
    ds_write_b128 v24, v[64:67] offset:0
    ds_write_b128 v24, v[68:71] offset:32
    ds_write_b128 v24, v[72:75] offset:64
    ds_write_b128 v24, v[76:79] offset:96
    ds_write_b128 v24, v[96:99] offset:128
    ds_write_b128 v24, v[100:103] offset:160
    ds_write_b128 v24, v[104:107] offset:192
    ds_write_b128 v24, v[108:111] offset:224
    ds_write_b128 v24, v[80:83] offset:8704
    ds_write_b128 v24, v[84:87] offset:8736
    ds_write_b128 v24, v[88:91] offset:8768
    ds_write_b128 v24, v[92:95] offset:8800
    ds_write_b128 v24, v[112:115] offset:8832
    ds_write_b128 v24, v[116:119] offset:8864
    ds_write_b128 v24, v[120:123] offset:8896
    ds_write_b128 v24, v[124:127] offset:8928
    s_waitcnt lgkmcnt(0)
    s_barrier
    ds_read_b128 v[128:131], v26 offset:0
    ds_read_b128 v[132:135], v26 offset:16
    ds_read_b128 v[136:139], v26 offset:32768
    ds_read_b128 v[140:143], v26 offset:32784
    ds_read_b128 v[144:147], v27 offset:0
    ds_read_b128 v[148:151], v27 offset:16
    ds_read_b128 v[152:155], v27 offset:32768
    ds_read_b128 v[156:159], v27 offset:32784
    ds_read_b128 v[160:163], v26 offset:8704
    ds_read_b128 v[164:167], v26 offset:8720
    ds_read_b128 v[168:171], v26 offset:41472
    ds_read_b128 v[172:175], v26 offset:41488
    ds_read_b128 v[176:179], v27 offset:8704
    ds_read_b128 v[180:183], v27 offset:8720
    ds_read_b128 v[184:187], v27 offset:41472
    ds_read_b128 v[188:191], v27 offset:41488
    s_waitcnt lgkmcnt(8)
    v_add_f32 v128, v128, v136
    v_add_f32 v129, v129, v137
    v_add_f32 v130, v130, v138
    v_add_f32 v131, v131, v139
    v_add_f32 v132, v132, v140
    v_add_f32 v133, v133, v141
    v_add_f32 v134, v134, v142
    v_add_f32 v135, v135, v143
    v_add_f32 v144, v144, v152
    v_add_f32 v145, v145, v153
    v_add_f32 v146, v146, v154
    v_add_f32 v147, v147, v155
    v_add_f32 v148, v148, v156
    v_add_f32 v149, v149, v157
    v_add_f32 v150, v150, v158
    v_add_f32 v151, v151, v159
    v_add_f32 v128, v128, v144
    v_add_f32 v129, v129, v145
    v_add_f32 v130, v130, v146
    v_add_f32 v131, v131, v147
    v_add_f32 v132, v132, v148
    v_add_f32 v133, v133, v149
    v_add_f32 v134, v134, v150
    v_add_f32 v135, v135, v151
    v_lshlrev_b32 v40, 16, v48
    v_and_b32 v41, 0xffff0000, v48
    v_add_f32 v128, v128, v40
    v_add_f32 v129, v129, v41
    v_cvt_pk_bf16_f32 v48, v128, v129
    v_lshlrev_b32 v40, 16, v49
    v_and_b32 v41, 0xffff0000, v49
    v_add_f32 v130, v130, v40
    v_add_f32 v131, v131, v41
    v_cvt_pk_bf16_f32 v49, v130, v131
    v_lshlrev_b32 v40, 16, v50
    v_and_b32 v41, 0xffff0000, v50
    v_add_f32 v132, v132, v40
    v_add_f32 v133, v133, v41
    v_cvt_pk_bf16_f32 v50, v132, v133
    v_lshlrev_b32 v40, 16, v51
    v_and_b32 v41, 0xffff0000, v51
    v_add_f32 v134, v134, v40
    v_add_f32 v135, v135, v41
    v_cvt_pk_bf16_f32 v51, v134, v135
    buffer_store_dwordx4 v[48:51], v46, s[32:35], s52 offen
    s_waitcnt lgkmcnt(0)
    v_add_f32 v160, v160, v168
    v_add_f32 v161, v161, v169
    v_add_f32 v162, v162, v170
    v_add_f32 v163, v163, v171
    v_add_f32 v164, v164, v172
    v_add_f32 v165, v165, v173
    v_add_f32 v166, v166, v174
    v_add_f32 v167, v167, v175
    v_add_f32 v176, v176, v184
    v_add_f32 v177, v177, v185
    v_add_f32 v178, v178, v186
    v_add_f32 v179, v179, v187
    v_add_f32 v180, v180, v188
    v_add_f32 v181, v181, v189
    v_add_f32 v182, v182, v190
    v_add_f32 v183, v183, v191
    v_add_f32 v160, v160, v176
    v_add_f32 v161, v161, v177
    v_add_f32 v162, v162, v178
    v_add_f32 v163, v163, v179
    v_add_f32 v164, v164, v180
    v_add_f32 v165, v165, v181
    v_add_f32 v166, v166, v182
    v_add_f32 v167, v167, v183
    v_lshlrev_b32 v40, 16, v52
    v_and_b32 v41, 0xffff0000, v52
    v_add_f32 v160, v160, v40
    v_add_f32 v161, v161, v41
    v_cvt_pk_bf16_f32 v52, v160, v161
    v_lshlrev_b32 v40, 16, v53
    v_and_b32 v41, 0xffff0000, v53
    v_add_f32 v162, v162, v40
    v_add_f32 v163, v163, v41
    v_cvt_pk_bf16_f32 v53, v162, v163
    v_lshlrev_b32 v40, 16, v54
    v_and_b32 v41, 0xffff0000, v54
    v_add_f32 v164, v164, v40
    v_add_f32 v165, v165, v41
    v_cvt_pk_bf16_f32 v54, v164, v165
    v_lshlrev_b32 v40, 16, v55
    v_and_b32 v41, 0xffff0000, v55
    v_add_f32 v166, v166, v40
    v_add_f32 v167, v167, v41
    v_cvt_pk_bf16_f32 v55, v166, v167
    buffer_store_dwordx4 v[52:55], v46, s[32:35], s54 offen
    s_or_b32 s58, s2, s36
    s_cmp_lg_u32 s58, 0
    s_cbranch_scc1 L_ns21
    v_mov_b32 v28, s60
    v_mov_b32 v29, 0
    s_mov_b32 s58, 0xc30000
    s_mov_b64 exec, 1
    buffer_store_dword v28, v29, s[20:23], s58 offen sc1
L_ns21:
L_end:
    s_endpgm
.section .rodata,"a"
.p2align 6
.amdhsa_kernel parallel_sum__linear_attn_block__glu_gated_reglu__prompt_kernel
  .amdhsa_next_free_vgpr 512
  .amdhsa_next_free_sgpr 102
  .amdhsa_accum_offset 256
  .amdhsa_group_segment_fixed_size 0
  .amdhsa_kernarg_size 80
  .amdhsa_user_sgpr_count 2
  .amdhsa_user_sgpr_kernarg_segment_ptr 1
  .amdhsa_system_sgpr_workgroup_id_x 1
.end_amdhsa_kernel
```
